```python
import torch

def _softmax(x, axis=-1):
    return torch.softmax(x, dim=axis)
def _gelu(x):
    return torch.nn.functional.gelu(x, approximate="tanh")
def _silu(x):
    return torch.nn.functional.silu(x)
def _sigmoid(x):
    return torch.sigmoid(x)
def _layernorm(x, axis=-1, eps=1e-5):
    m = x.mean(dim=axis, keepdim=True)
    v = x.var(dim=axis, keepdim=True, unbiased=False)
    return (x - m) / torch.sqrt(v + eps)
def _scatter_add(tgt, idx, src, axis=0):
    return tgt.clone().index_add_(axis, idx, src)
def _segment_sum(src, seg, n):
    out = torch.zeros((n,) + src.shape[1:], dtype=src.dtype)
    return out.index_add_(0, seg, src)
def _pad(x, pw):
    flat = tuple(v for pair in reversed(pw) for v in pair)
    return torch.nn.functional.pad(x, flat)

kernel_name = 'interleave_layers__spectral_gfnet__glu_gated_swiglu__prompt'

def setup_inputs():

    _w = (lambda a: (lambda t: t.to(torch.bfloat16) if t.is_floating_point() else t)(torch.as_tensor(a)))
    def _A_setup():
        B, S, D = 1, 2048, 640
        Df = D // 2 + 1
        return {
            "x": _w((lambda *s: torch.randn(*s, dtype=torch.bfloat16) * 0.05)(B, S, D)),
            "w_r": _w((lambda *s: torch.randn(*s, dtype=torch.bfloat16) * 0.4)(S, Df) * 0.02),
            "w_i": _w((lambda *s: torch.randn(*s, dtype=torch.bfloat16) * 0.4)(S, Df) * 0.02),
        }
    _A_in = _A_setup()

    def _B_setup():
        B, S, D, F = 1, 2048, 640, 1728
        return {
            "x": _w((lambda *s: torch.randn(*s, dtype=torch.bfloat16) * 0.05)(B, S, D)),
            "w1": _w((lambda *s: torch.randn(*s, dtype=torch.bfloat16) * 0.2)(D, F) * (2.0 / D) ** 0.5),
            "w3": _w((lambda *s: torch.randn(*s, dtype=torch.bfloat16) * 0.2)(D, F) * (2.0 / D) ** 0.5),
            "w2": _w((lambda *s: torch.randn(*s, dtype=torch.bfloat16) * 0.2)(F, D) * (2.0 / F) ** 0.5),
        }
    _B_in = _B_setup()

    return {
        "A_x": _A_in["x"],
        "A_w_r": _A_in["w_r"],
        "A_w_i": _A_in["w_i"],
        "B_x": _B_in["x"],
        "B_w1": _B_in["w1"],
        "B_w3": _B_in["w3"],
        "B_w2": _B_in["w2"],
    }

def reference(A_x, A_w_r, A_w_i, B_x, B_w1, B_w3, B_w2):
    def _A_ref(x, w_r, w_i):
        B, S, D = x.shape
        X = (lambda x, axes=(-2,-1): torch.fft.rfft2(x.float(), dim=axes))(x, axes=(-2, -1))
        W = w_r + 1j * w_i
        X = X * W
        y = (lambda x, s, axes=(-2,-1): torch.fft.irfft2(x, s=s, dim=axes).to(torch.bfloat16))(X, (S, D), axes=(-2, -1))
        return y

    def _B_ref(x, w1, w3, w2):
        gate = torch.einsum("bsd,df->bsf", x, w1)
        up = torch.einsum("bsd,df->bsf", x, w3)
        h = _silu(gate) * up
        out = torch.einsum("bsf,fd->bsd", h, w2)
        return out

    x = A_x
    x = x + _A_ref(_layernorm(x, axis=-1), A_w_r, A_w_i)
    x = x + _B_ref(_layernorm(x, axis=-1), B_w1, B_w3, B_w2)
    x = x + _A_ref(_layernorm(x, axis=-1), A_w_r, A_w_i)
    x = x + _B_ref(_layernorm(x, axis=-1), B_w1, B_w3, B_w2)
    return x
```

```asm
; @launch kernel=k1a_kernel grid=(256,1,1) block=(320,1,1) lds=46080
; @launch kernel=wp_kernel grid=(810,1,1) block=(256,1,1) lds=9216
; @launch kernel=k2a_kernel grid=(321,1,1) block=(256,1,1) lds=36864
; @launch kernel=k3a_kernel grid=(256,1,1) block=(320,1,1) lds=46080
; @launch kernel=g1a_kernel grid=(432,1,1) block=(256,1,1) lds=73728
; @launch kernel=g2a_kernel grid=(240,1,1) block=(256,1,1) lds=73728
; @launch kernel=fina_kernel grid=(1280,1,1) block=(256,1,1) lds=0
; @launch kernel=k1b_kernel grid=(256,1,1) block=(320,1,1) lds=46080
; @launch kernel=k2b_kernel grid=(321,1,1) block=(256,1,1) lds=36864
; @launch kernel=k3b_kernel grid=(256,1,1) block=(320,1,1) lds=46080
; @launch kernel=g1b_kernel grid=(432,1,1) block=(256,1,1) lds=73728
; @launch kernel=g2b_kernel grid=(240,1,1) block=(256,1,1) lds=73728
; @launch kernel=finb_kernel grid=(1280,1,1) block=(256,1,1) lds=0
.amdgcn_target "amdgcn-amd-amdhsa--gfx950"
.text
.globl k1a_kernel
.p2align 8
.type k1a_kernel,@function
k1a_kernel:
    s_cmp_ge_u32 s2, 256
    s_cbranch_scc1 .Lk1a_kernel_end
    s_load_dwordx2 s[4:5], s[0:1], 72
    s_load_dwordx2 s[6:7], s[0:1], 0
    s_load_dwordx4 s[28:31], s[0:1], 8
    s_mov_b32 s40, 0x3f3504f3
    s_mov_b32 s41, 0xbf3504f3
    s_mov_b32 s42, 0x3e9e377a
    s_mov_b32 s43, 0xbf4f1bbd
    s_mov_b32 s44, 0x3f737871
    s_mov_b32 s45, 0x3f167918
    s_mov_b32 s46, 0x3f4f1bbd
    s_mov_b32 s47, 0x3f167918
    s_mov_b32 s48, 0x3e9e377a
    s_mov_b32 s49, 0x3f737871
    s_mov_b32 s50, 0xbe9e377a
    s_mov_b32 s51, 0x3f737871
    s_mov_b32 s52, 0xbf4f1bbd
    s_mov_b32 s53, 0x3f167918
    s_waitcnt lgkmcnt(0)
    s_mov_b32 s8, s6
    s_mov_b32 s9, s7
    s_mov_b32 s10, 2621440
    s_mov_b32 s11, 0x00020000
    s_mov_b32 s12, s4
    s_mov_b32 s13, s5
    s_mov_b32 s14, 5259264
    s_mov_b32 s15, 0x00020000
    v_and_b32 v1, 63, v0
    v_lshrrev_b32 v2, 6, v0
    s_nop 1
    v_readfirstlane_b32 s20, v2
    s_mov_b32 s32, s28
    s_mov_b32 s33, s29
    s_mov_b32 s34, 1314816
    s_mov_b32 s35, 0x00020000
    s_mov_b32 s36, s30
    s_mov_b32 s37, s31
    s_mov_b32 s38, 1314816
    s_mov_b32 s39, 0x00020000
    s_mov_b32 s3, 6291456
    s_add_u32 s24, s4, s3
    s_addc_u32 s25, s5, 0
    s_mov_b32 s26, 5259264
    s_mov_b32 s27, 0x00020000
    s_lshr_b32 s21, s2, 5
    s_lshr_b32 s22, s2, 2
    s_and_b32 s22, s22, 7
    s_lshl_b32 s22, s22, 3
    s_add_u32 s21, s21, s22
    s_and_b32 s22, s2, 3
    s_lshl_b32 s22, s22, 7
    s_add_u32 s21, s21, s22
    s_mul_i32 s21, s21, 642
    v_lshlrev_b32 v3, 1, v0
    v_mov_b32 v4, v0
    s_add_u32 s16, s21, 0
    buffer_load_ushort v8, v3, s[32:35], s16 offen
    buffer_load_ushort v9, v3, s[36:39], s16 offen
    s_add_u32 s16, s21, 328704
    buffer_load_ushort v10, v3, s[32:35], s16 offen
    buffer_load_ushort v11, v3, s[36:39], s16 offen
    s_add_u32 s16, s21, 657408
    buffer_load_ushort v12, v3, s[32:35], s16 offen
    buffer_load_ushort v13, v3, s[36:39], s16 offen
    s_add_u32 s16, s21, 986112
    buffer_load_ushort v14, v3, s[32:35], s16 offen
    buffer_load_ushort v15, v3, s[36:39], s16 offen
    s_add_u32 s16, s21, 41088
    buffer_load_ushort v16, v3, s[32:35], s16 offen
    buffer_load_ushort v17, v3, s[36:39], s16 offen
    s_add_u32 s16, s21, 369792
    buffer_load_ushort v18, v3, s[32:35], s16 offen
    buffer_load_ushort v19, v3, s[36:39], s16 offen
    s_add_u32 s16, s21, 698496
    buffer_load_ushort v20, v3, s[32:35], s16 offen
    buffer_load_ushort v21, v3, s[36:39], s16 offen
    s_add_u32 s16, s21, 1027200
    buffer_load_ushort v22, v3, s[32:35], s16 offen
    buffer_load_ushort v23, v3, s[36:39], s16 offen
    v_lshlrev_b32 v5, 14, v4
    s_lshl_b32 s16, s2, 6
    s_waitcnt vmcnt(0)
    v_lshlrev_b32 v8, 16, v8
    v_mul_f32 v8, 0x34cccccd, v8
    v_lshlrev_b32 v9, 16, v9
    v_mul_f32 v9, 0x34cccccd, v9
    v_lshlrev_b32 v10, 16, v10
    v_mul_f32 v10, 0x34cccccd, v10
    v_lshlrev_b32 v11, 16, v11
    v_mul_f32 v11, 0x34cccccd, v11
    v_lshlrev_b32 v12, 16, v12
    v_mul_f32 v12, 0x34cccccd, v12
    v_lshlrev_b32 v13, 16, v13
    v_mul_f32 v13, 0x34cccccd, v13
    v_lshlrev_b32 v14, 16, v14
    v_mul_f32 v14, 0x34cccccd, v14
    v_lshlrev_b32 v15, 16, v15
    v_mul_f32 v15, 0x34cccccd, v15
    v_lshlrev_b32 v16, 16, v16
    v_mul_f32 v16, 0x34cccccd, v16
    v_lshlrev_b32 v17, 16, v17
    v_mul_f32 v17, 0x34cccccd, v17
    v_lshlrev_b32 v18, 16, v18
    v_mul_f32 v18, 0x34cccccd, v18
    v_lshlrev_b32 v19, 16, v19
    v_mul_f32 v19, 0x34cccccd, v19
    v_lshlrev_b32 v20, 16, v20
    v_mul_f32 v20, 0x34cccccd, v20
    v_lshlrev_b32 v21, 16, v21
    v_mul_f32 v21, 0x34cccccd, v21
    v_lshlrev_b32 v22, 16, v22
    v_mul_f32 v22, 0x34cccccd, v22
    v_lshlrev_b32 v23, 16, v23
    v_mul_f32 v23, 0x34cccccd, v23
    buffer_store_dwordx4 v[8:11], v5, s[24:27], s16 offen offset:0
    buffer_store_dwordx4 v[12:15], v5, s[24:27], s16 offen offset:16
    buffer_store_dwordx4 v[16:19], v5, s[24:27], s16 offen offset:32
    buffer_store_dwordx4 v[20:23], v5, s[24:27], s16 offen offset:48
    v_cmp_eq_u32 vcc, 0, v0
    s_and_saveexec_b64 s[22:23], vcc
    v_mov_b32 v3, 640
    v_mov_b32 v4, 320
    s_add_u32 s16, s21, 0
    buffer_load_ushort v8, v3, s[32:35], s16 offen
    buffer_load_ushort v9, v3, s[36:39], s16 offen
    s_add_u32 s16, s21, 328704
    buffer_load_ushort v10, v3, s[32:35], s16 offen
    buffer_load_ushort v11, v3, s[36:39], s16 offen
    s_add_u32 s16, s21, 657408
    buffer_load_ushort v12, v3, s[32:35], s16 offen
    buffer_load_ushort v13, v3, s[36:39], s16 offen
    s_add_u32 s16, s21, 986112
    buffer_load_ushort v14, v3, s[32:35], s16 offen
    buffer_load_ushort v15, v3, s[36:39], s16 offen
    s_add_u32 s16, s21, 41088
    buffer_load_ushort v16, v3, s[32:35], s16 offen
    buffer_load_ushort v17, v3, s[36:39], s16 offen
    s_add_u32 s16, s21, 369792
    buffer_load_ushort v18, v3, s[32:35], s16 offen
    buffer_load_ushort v19, v3, s[36:39], s16 offen
    s_add_u32 s16, s21, 698496
    buffer_load_ushort v20, v3, s[32:35], s16 offen
    buffer_load_ushort v21, v3, s[36:39], s16 offen
    s_add_u32 s16, s21, 1027200
    buffer_load_ushort v22, v3, s[32:35], s16 offen
    buffer_load_ushort v23, v3, s[36:39], s16 offen
    v_lshlrev_b32 v5, 14, v4
    s_lshl_b32 s16, s2, 6
    s_waitcnt vmcnt(0)
    v_lshlrev_b32 v8, 16, v8
    v_mul_f32 v8, 0x34cccccd, v8
    v_lshlrev_b32 v9, 16, v9
    v_mul_f32 v9, 0x34cccccd, v9
    v_lshlrev_b32 v10, 16, v10
    v_mul_f32 v10, 0x34cccccd, v10
    v_lshlrev_b32 v11, 16, v11
    v_mul_f32 v11, 0x34cccccd, v11
    v_lshlrev_b32 v12, 16, v12
    v_mul_f32 v12, 0x34cccccd, v12
    v_lshlrev_b32 v13, 16, v13
    v_mul_f32 v13, 0x34cccccd, v13
    v_lshlrev_b32 v14, 16, v14
    v_mul_f32 v14, 0x34cccccd, v14
    v_lshlrev_b32 v15, 16, v15
    v_mul_f32 v15, 0x34cccccd, v15
    v_lshlrev_b32 v16, 16, v16
    v_mul_f32 v16, 0x34cccccd, v16
    v_lshlrev_b32 v17, 16, v17
    v_mul_f32 v17, 0x34cccccd, v17
    v_lshlrev_b32 v18, 16, v18
    v_mul_f32 v18, 0x34cccccd, v18
    v_lshlrev_b32 v19, 16, v19
    v_mul_f32 v19, 0x34cccccd, v19
    v_lshlrev_b32 v20, 16, v20
    v_mul_f32 v20, 0x34cccccd, v20
    v_lshlrev_b32 v21, 16, v21
    v_mul_f32 v21, 0x34cccccd, v21
    v_lshlrev_b32 v22, 16, v22
    v_mul_f32 v22, 0x34cccccd, v22
    v_lshlrev_b32 v23, 16, v23
    v_mul_f32 v23, 0x34cccccd, v23
    buffer_store_dwordx4 v[8:11], v5, s[24:27], s16 offen offset:0
    buffer_store_dwordx4 v[12:15], v5, s[24:27], s16 offen offset:16
    buffer_store_dwordx4 v[16:19], v5, s[24:27], s16 offen offset:32
    buffer_store_dwordx4 v[20:23], v5, s[24:27], s16 offen offset:48
    s_mov_b64 exec, s[22:23]
    s_cmp_ge_u32 s20, 4
    s_cbranch_scc1 .Lk1a_kernel_skipln
    s_lshl_b32 s21, s2, 3
    s_lshl_b32 s22, s20, 1
    s_add_u32 s21, s21, s22
    s_mul_i32 s21, s21, 1280
    v_lshlrev_b32 v3, 2, v1
    buffer_load_dword v4, v3, s[8:11], s21 offen offset:0
    buffer_load_dword v5, v3, s[8:11], s21 offen offset:256
    buffer_load_dword v6, v3, s[8:11], s21 offen offset:512
    buffer_load_dword v7, v3, s[8:11], s21 offen offset:768
    buffer_load_dword v8, v3, s[8:11], s21 offen offset:1024
    buffer_load_dword v9, v3, s[8:11], s21 offen offset:1280
    buffer_load_dword v10, v3, s[8:11], s21 offen offset:1536
    buffer_load_dword v11, v3, s[8:11], s21 offen offset:1792
    buffer_load_dword v12, v3, s[8:11], s21 offen offset:2048
    buffer_load_dword v13, v3, s[8:11], s21 offen offset:2304
    s_waitcnt vmcnt(0)
    v_lshlrev_b32 v20, 16, v4
    v_and_b32 v21, 0xffff0000, v4
    v_lshlrev_b32 v22, 16, v5
    v_and_b32 v23, 0xffff0000, v5
    v_lshlrev_b32 v24, 16, v6
    v_and_b32 v25, 0xffff0000, v6
    v_lshlrev_b32 v26, 16, v7
    v_and_b32 v27, 0xffff0000, v7
    v_lshlrev_b32 v28, 16, v8
    v_and_b32 v29, 0xffff0000, v8
    v_lshlrev_b32 v30, 16, v9
    v_and_b32 v31, 0xffff0000, v9
    v_lshlrev_b32 v32, 16, v10
    v_and_b32 v33, 0xffff0000, v10
    v_lshlrev_b32 v34, 16, v11
    v_and_b32 v35, 0xffff0000, v11
    v_lshlrev_b32 v36, 16, v12
    v_and_b32 v37, 0xffff0000, v12
    v_lshlrev_b32 v38, 16, v13
    v_and_b32 v39, 0xffff0000, v13
    v_add_f32 v40, v20, v21
    v_add_f32 v40, v40, v22
    v_add_f32 v40, v40, v23
    v_add_f32 v40, v40, v24
    v_add_f32 v40, v40, v25
    v_add_f32 v40, v40, v26
    v_add_f32 v40, v40, v27
    v_add_f32 v40, v40, v28
    v_add_f32 v40, v40, v29
    v_add_f32 v41, v30, v31
    v_add_f32 v41, v41, v32
    v_add_f32 v41, v41, v33
    v_add_f32 v41, v41, v34
    v_add_f32 v41, v41, v35
    v_add_f32 v41, v41, v36
    v_add_f32 v41, v41, v37
    v_add_f32 v41, v41, v38
    v_add_f32 v41, v41, v39
    s_nop 1
    v_add_f32_dpp v40, v40, v40 quad_perm:[1,0,3,2] row_mask:0xf bank_mask:0xf
    v_add_f32_dpp v41, v41, v41 quad_perm:[1,0,3,2] row_mask:0xf bank_mask:0xf
    s_nop 1
    v_add_f32_dpp v40, v40, v40 quad_perm:[2,3,0,1] row_mask:0xf bank_mask:0xf
    v_add_f32_dpp v41, v41, v41 quad_perm:[2,3,0,1] row_mask:0xf bank_mask:0xf
    s_nop 1
    v_add_f32_dpp v40, v40, v40 row_half_mirror row_mask:0xf bank_mask:0xf
    v_add_f32_dpp v41, v41, v41 row_half_mirror row_mask:0xf bank_mask:0xf
    s_nop 1
    v_add_f32_dpp v40, v40, v40 row_mirror row_mask:0xf bank_mask:0xf
    v_add_f32_dpp v41, v41, v41 row_mirror row_mask:0xf bank_mask:0xf
    v_mov_b32 v44, v40
    v_mov_b32 v45, v41
    s_nop 1
    v_permlane16_swap_b32 v40, v44
    v_permlane16_swap_b32 v41, v45
    s_nop 1
    v_add_f32 v40, v40, v44
    v_add_f32 v41, v41, v45
    v_mov_b32 v44, v40
    v_mov_b32 v45, v41
    s_nop 1
    v_permlane32_swap_b32 v40, v44
    v_permlane32_swap_b32 v41, v45
    s_nop 1
    v_add_f32 v40, v40, v44
    v_add_f32 v41, v41, v45
    v_mul_f32 v40, 0x3acccccd, v40
    v_mul_f32 v41, 0x3acccccd, v41
    v_sub_f32 v44, v20, v40
    v_mul_f32 v42, v44, v44
    v_sub_f32 v44, v21, v40
    v_fma_f32 v42, v44, v44, v42
    v_sub_f32 v44, v22, v40
    v_fma_f32 v42, v44, v44, v42
    v_sub_f32 v44, v23, v40
    v_fma_f32 v42, v44, v44, v42
    v_sub_f32 v44, v24, v40
    v_fma_f32 v42, v44, v44, v42
    v_sub_f32 v44, v25, v40
    v_fma_f32 v42, v44, v44, v42
    v_sub_f32 v44, v26, v40
    v_fma_f32 v42, v44, v44, v42
    v_sub_f32 v44, v27, v40
    v_fma_f32 v42, v44, v44, v42
    v_sub_f32 v44, v28, v40
    v_fma_f32 v42, v44, v44, v42
    v_sub_f32 v44, v29, v40
    v_fma_f32 v42, v44, v44, v42
    v_sub_f32 v44, v30, v41
    v_mul_f32 v43, v44, v44
    v_sub_f32 v44, v31, v41
    v_fma_f32 v43, v44, v44, v43
    v_sub_f32 v44, v32, v41
    v_fma_f32 v43, v44, v44, v43
    v_sub_f32 v44, v33, v41
    v_fma_f32 v43, v44, v44, v43
    v_sub_f32 v44, v34, v41
    v_fma_f32 v43, v44, v44, v43
    v_sub_f32 v44, v35, v41
    v_fma_f32 v43, v44, v44, v43
    v_sub_f32 v44, v36, v41
    v_fma_f32 v43, v44, v44, v43
    v_sub_f32 v44, v37, v41
    v_fma_f32 v43, v44, v44, v43
    v_sub_f32 v44, v38, v41
    v_fma_f32 v43, v44, v44, v43
    v_sub_f32 v44, v39, v41
    v_fma_f32 v43, v44, v44, v43
    s_nop 1
    v_add_f32_dpp v42, v42, v42 quad_perm:[1,0,3,2] row_mask:0xf bank_mask:0xf
    v_add_f32_dpp v43, v43, v43 quad_perm:[1,0,3,2] row_mask:0xf bank_mask:0xf
    s_nop 1
    v_add_f32_dpp v42, v42, v42 quad_perm:[2,3,0,1] row_mask:0xf bank_mask:0xf
    v_add_f32_dpp v43, v43, v43 quad_perm:[2,3,0,1] row_mask:0xf bank_mask:0xf
    s_nop 1
    v_add_f32_dpp v42, v42, v42 row_half_mirror row_mask:0xf bank_mask:0xf
    v_add_f32_dpp v43, v43, v43 row_half_mirror row_mask:0xf bank_mask:0xf
    s_nop 1
    v_add_f32_dpp v42, v42, v42 row_mirror row_mask:0xf bank_mask:0xf
    v_add_f32_dpp v43, v43, v43 row_mirror row_mask:0xf bank_mask:0xf
    v_mov_b32 v44, v42
    v_mov_b32 v45, v43
    s_nop 1
    v_permlane16_swap_b32 v42, v44
    v_permlane16_swap_b32 v43, v45
    s_nop 1
    v_add_f32 v42, v42, v44
    v_add_f32 v43, v43, v45
    v_mov_b32 v44, v42
    v_mov_b32 v45, v43
    s_nop 1
    v_permlane32_swap_b32 v42, v44
    v_permlane32_swap_b32 v43, v45
    s_nop 1
    v_add_f32 v42, v42, v44
    v_add_f32 v43, v43, v45
    v_mul_f32 v42, 0x3acccccd, v42
    v_cvt_pk_bf16_f32 v42, v42, v42
    v_lshlrev_b32 v42, 16, v42
    v_add_f32 v42, 0x3727c5ac, v42
    v_cvt_pk_bf16_f32 v42, v42, v42
    v_lshlrev_b32 v42, 16, v42
    v_sqrt_f32 v42, v42
    s_nop 0
    v_cvt_pk_bf16_f32 v42, v42, v42
    v_lshlrev_b32 v42, 16, v42
    v_rcp_f32 v44, v42
    v_cvt_pk_bf16_f32 v40, v40, v40
    v_lshlrev_b32 v40, 16, v40
    v_mul_f32 v43, 0x3acccccd, v43
    v_cvt_pk_bf16_f32 v43, v43, v43
    v_lshlrev_b32 v43, 16, v43
    v_add_f32 v43, 0x3727c5ac, v43
    v_cvt_pk_bf16_f32 v43, v43, v43
    v_lshlrev_b32 v43, 16, v43
    v_sqrt_f32 v43, v43
    s_nop 0
    v_cvt_pk_bf16_f32 v43, v43, v43
    v_lshlrev_b32 v43, 16, v43
    v_rcp_f32 v45, v43
    v_cvt_pk_bf16_f32 v41, v41, v41
    v_lshlrev_b32 v41, 16, v41
    v_sub_f32 v20, v20, v40
    v_cvt_pk_bf16_f32 v20, v20, v20
    v_lshlrev_b32 v20, 16, v20
    v_mul_f32 v46, v20, v44
    v_fma_f32 v47, -v46, v42, v20
    v_fma_f32 v20, v47, v44, v46
    v_cvt_pk_bf16_f32 v20, v20, v20
    v_lshlrev_b32 v20, 16, v20
    v_sub_f32 v21, v21, v40
    v_cvt_pk_bf16_f32 v21, v21, v21
    v_lshlrev_b32 v21, 16, v21
    v_mul_f32 v46, v21, v44
    v_fma_f32 v47, -v46, v42, v21
    v_fma_f32 v21, v47, v44, v46
    v_cvt_pk_bf16_f32 v21, v21, v21
    v_lshlrev_b32 v21, 16, v21
    v_sub_f32 v22, v22, v40
    v_cvt_pk_bf16_f32 v22, v22, v22
    v_lshlrev_b32 v22, 16, v22
    v_mul_f32 v46, v22, v44
    v_fma_f32 v47, -v46, v42, v22
    v_fma_f32 v22, v47, v44, v46
    v_cvt_pk_bf16_f32 v22, v22, v22
    v_lshlrev_b32 v22, 16, v22
    v_sub_f32 v23, v23, v40
    v_cvt_pk_bf16_f32 v23, v23, v23
    v_lshlrev_b32 v23, 16, v23
    v_mul_f32 v46, v23, v44
    v_fma_f32 v47, -v46, v42, v23
    v_fma_f32 v23, v47, v44, v46
    v_cvt_pk_bf16_f32 v23, v23, v23
    v_lshlrev_b32 v23, 16, v23
    v_sub_f32 v24, v24, v40
    v_cvt_pk_bf16_f32 v24, v24, v24
    v_lshlrev_b32 v24, 16, v24
    v_mul_f32 v46, v24, v44
    v_fma_f32 v47, -v46, v42, v24
    v_fma_f32 v24, v47, v44, v46
    v_cvt_pk_bf16_f32 v24, v24, v24
    v_lshlrev_b32 v24, 16, v24
    v_sub_f32 v25, v25, v40
    v_cvt_pk_bf16_f32 v25, v25, v25
    v_lshlrev_b32 v25, 16, v25
    v_mul_f32 v46, v25, v44
    v_fma_f32 v47, -v46, v42, v25
    v_fma_f32 v25, v47, v44, v46
    v_cvt_pk_bf16_f32 v25, v25, v25
    v_lshlrev_b32 v25, 16, v25
    v_sub_f32 v26, v26, v40
    v_cvt_pk_bf16_f32 v26, v26, v26
    v_lshlrev_b32 v26, 16, v26
    v_mul_f32 v46, v26, v44
    v_fma_f32 v47, -v46, v42, v26
    v_fma_f32 v26, v47, v44, v46
    v_cvt_pk_bf16_f32 v26, v26, v26
    v_lshlrev_b32 v26, 16, v26
    v_sub_f32 v27, v27, v40
    v_cvt_pk_bf16_f32 v27, v27, v27
    v_lshlrev_b32 v27, 16, v27
    v_mul_f32 v46, v27, v44
    v_fma_f32 v47, -v46, v42, v27
    v_fma_f32 v27, v47, v44, v46
    v_cvt_pk_bf16_f32 v27, v27, v27
    v_lshlrev_b32 v27, 16, v27
    v_sub_f32 v28, v28, v40
    v_cvt_pk_bf16_f32 v28, v28, v28
    v_lshlrev_b32 v28, 16, v28
    v_mul_f32 v46, v28, v44
    v_fma_f32 v47, -v46, v42, v28
    v_fma_f32 v28, v47, v44, v46
    v_cvt_pk_bf16_f32 v28, v28, v28
    v_lshlrev_b32 v28, 16, v28
    v_sub_f32 v29, v29, v40
    v_cvt_pk_bf16_f32 v29, v29, v29
    v_lshlrev_b32 v29, 16, v29
    v_mul_f32 v46, v29, v44
    v_fma_f32 v47, -v46, v42, v29
    v_fma_f32 v29, v47, v44, v46
    v_cvt_pk_bf16_f32 v29, v29, v29
    v_lshlrev_b32 v29, 16, v29
    v_sub_f32 v30, v30, v41
    v_cvt_pk_bf16_f32 v30, v30, v30
    v_lshlrev_b32 v30, 16, v30
    v_mul_f32 v46, v30, v45
    v_fma_f32 v47, -v46, v43, v30
    v_fma_f32 v30, v47, v45, v46
    v_cvt_pk_bf16_f32 v30, v30, v30
    v_lshlrev_b32 v30, 16, v30
    v_sub_f32 v31, v31, v41
    v_cvt_pk_bf16_f32 v31, v31, v31
    v_lshlrev_b32 v31, 16, v31
    v_mul_f32 v46, v31, v45
    v_fma_f32 v47, -v46, v43, v31
    v_fma_f32 v31, v47, v45, v46
    v_cvt_pk_bf16_f32 v31, v31, v31
    v_lshlrev_b32 v31, 16, v31
    v_sub_f32 v32, v32, v41
    v_cvt_pk_bf16_f32 v32, v32, v32
    v_lshlrev_b32 v32, 16, v32
    v_mul_f32 v46, v32, v45
    v_fma_f32 v47, -v46, v43, v32
    v_fma_f32 v32, v47, v45, v46
    v_cvt_pk_bf16_f32 v32, v32, v32
    v_lshlrev_b32 v32, 16, v32
    v_sub_f32 v33, v33, v41
    v_cvt_pk_bf16_f32 v33, v33, v33
    v_lshlrev_b32 v33, 16, v33
    v_mul_f32 v46, v33, v45
    v_fma_f32 v47, -v46, v43, v33
    v_fma_f32 v33, v47, v45, v46
    v_cvt_pk_bf16_f32 v33, v33, v33
    v_lshlrev_b32 v33, 16, v33
    v_sub_f32 v34, v34, v41
    v_cvt_pk_bf16_f32 v34, v34, v34
    v_lshlrev_b32 v34, 16, v34
    v_mul_f32 v46, v34, v45
    v_fma_f32 v47, -v46, v43, v34
    v_fma_f32 v34, v47, v45, v46
    v_cvt_pk_bf16_f32 v34, v34, v34
    v_lshlrev_b32 v34, 16, v34
    v_sub_f32 v35, v35, v41
    v_cvt_pk_bf16_f32 v35, v35, v35
    v_lshlrev_b32 v35, 16, v35
    v_mul_f32 v46, v35, v45
    v_fma_f32 v47, -v46, v43, v35
    v_fma_f32 v35, v47, v45, v46
    v_cvt_pk_bf16_f32 v35, v35, v35
    v_lshlrev_b32 v35, 16, v35
    v_sub_f32 v36, v36, v41
    v_cvt_pk_bf16_f32 v36, v36, v36
    v_lshlrev_b32 v36, 16, v36
    v_mul_f32 v46, v36, v45
    v_fma_f32 v47, -v46, v43, v36
    v_fma_f32 v36, v47, v45, v46
    v_cvt_pk_bf16_f32 v36, v36, v36
    v_lshlrev_b32 v36, 16, v36
    v_sub_f32 v37, v37, v41
    v_cvt_pk_bf16_f32 v37, v37, v37
    v_lshlrev_b32 v37, 16, v37
    v_mul_f32 v46, v37, v45
    v_fma_f32 v47, -v46, v43, v37
    v_fma_f32 v37, v47, v45, v46
    v_cvt_pk_bf16_f32 v37, v37, v37
    v_lshlrev_b32 v37, 16, v37
    v_sub_f32 v38, v38, v41
    v_cvt_pk_bf16_f32 v38, v38, v38
    v_lshlrev_b32 v38, 16, v38
    v_mul_f32 v46, v38, v45
    v_fma_f32 v47, -v46, v43, v38
    v_fma_f32 v38, v47, v45, v46
    v_cvt_pk_bf16_f32 v38, v38, v38
    v_lshlrev_b32 v38, 16, v38
    v_sub_f32 v39, v39, v41
    v_cvt_pk_bf16_f32 v39, v39, v39
    v_lshlrev_b32 v39, 16, v39
    v_mul_f32 v46, v39, v45
    v_fma_f32 v47, -v46, v43, v39
    v_fma_f32 v39, v47, v45, v46
    v_cvt_pk_bf16_f32 v39, v39, v39
    v_lshlrev_b32 v39, 16, v39
    s_mul_i32 s21, s20, 5120
    v_lshlrev_b32 v3, 4, v1
    v_add_u32 v3, s21, v3
    v_mov_b32 v4, v20
    v_mov_b32 v5, v30
    v_mov_b32 v6, v21
    v_mov_b32 v7, v31
    ds_write_b128 v3, v[4:7] offset:0
    v_mov_b32 v4, v22
    v_mov_b32 v5, v32
    v_mov_b32 v6, v23
    v_mov_b32 v7, v33
    ds_write_b128 v3, v[4:7] offset:1024
    v_mov_b32 v4, v24
    v_mov_b32 v5, v34
    v_mov_b32 v6, v25
    v_mov_b32 v7, v35
    ds_write_b128 v3, v[4:7] offset:2048
    v_mov_b32 v4, v26
    v_mov_b32 v5, v36
    v_mov_b32 v6, v27
    v_mov_b32 v7, v37
    ds_write_b128 v3, v[4:7] offset:3072
    v_mov_b32 v4, v28
    v_mov_b32 v5, v38
    v_mov_b32 v6, v29
    v_mov_b32 v7, v39
    ds_write_b128 v3, v[4:7] offset:4096
    v_cvt_f32_u32 v40, v1
    v_mul_f32 v20, 0xbacccccd, v40
    v_fract_f32 v20, v20
    v_sin_f32 v21, v20
    v_cos_f32 v20, v20
    v_mul_f32 v22, 0xbb4ccccd, v40
    v_fract_f32 v22, v22
    v_sin_f32 v23, v22
    v_cos_f32 v22, v22
    v_mul_f32 v24, 0xbb99999a, v40
    v_fract_f32 v24, v24
    v_sin_f32 v25, v24
    v_cos_f32 v24, v24
    v_mul_f32 v26, 0xbbcccccd, v40
    v_fract_f32 v26, v26
    v_sin_f32 v27, v26
    v_cos_f32 v26, v26
    v_mul_f32 v28, 0xbc000000, v40
    v_fract_f32 v28, v28
    v_sin_f32 v29, v28
    v_cos_f32 v28, v28
    v_mul_f32 v30, 0xbc19999a, v40
    v_fract_f32 v30, v30
    v_sin_f32 v31, v30
    v_cos_f32 v30, v30
    v_mul_f32 v32, 0xbc333333, v40
    v_fract_f32 v32, v32
    v_sin_f32 v33, v32
    v_cos_f32 v32, v32
    v_mul_f32 v34, 0xbc4ccccd, v40
    v_fract_f32 v34, v34
    v_sin_f32 v35, v34
    v_cos_f32 v34, v34
    v_mul_f32 v36, 0xbc666666, v40
    v_fract_f32 v36, v36
    v_sin_f32 v37, v36
    v_cos_f32 v36, v36
    s_nop 0
    v_lshlrev_b32 v3, 3, v1
    v_add_u32 v3, s21, v3
    s_waitcnt lgkmcnt(0)
    ds_read_b64 v[64:65], v3 offset:0
    ds_read_b64 v[66:67], v3 offset:512
    ds_read_b64 v[68:69], v3 offset:1024
    ds_read_b64 v[70:71], v3 offset:1536
    ds_read_b64 v[72:73], v3 offset:2048
    ds_read_b64 v[74:75], v3 offset:2560
    ds_read_b64 v[76:77], v3 offset:3072
    ds_read_b64 v[78:79], v3 offset:3584
    ds_read_b64 v[80:81], v3 offset:4096
    ds_read_b64 v[82:83], v3 offset:4608
    s_waitcnt lgkmcnt(0)
    v_add_f32 v84, v64, v74
    v_add_f32 v85, v65, v75
    v_sub_f32 v86, v64, v74
    v_sub_f32 v87, v65, v75
    v_add_f32 v88, v66, v76
    v_add_f32 v89, v67, v77
    v_sub_f32 v90, v66, v76
    v_sub_f32 v91, v67, v77
    v_add_f32 v92, v68, v78
    v_add_f32 v93, v69, v79
    v_sub_f32 v94, v68, v78
    v_sub_f32 v95, v69, v79
    v_add_f32 v96, v70, v80
    v_add_f32 v97, v71, v81
    v_sub_f32 v98, v70, v80
    v_sub_f32 v99, v71, v81
    v_add_f32 v100, v72, v82
    v_add_f32 v101, v73, v83
    v_sub_f32 v102, v72, v82
    v_sub_f32 v103, v73, v83
    v_mul_f32 v104, s47, v91
    v_fma_f32 v104, s46, v90, v104
    v_mul_f32 v105, s47, v90
    v_fma_f32 v105, s46, v91, -v105
    v_mul_f32 v106, s49, v95
    v_fma_f32 v106, s48, v94, v106
    v_mul_f32 v107, s49, v94
    v_fma_f32 v107, s48, v95, -v107
    v_mul_f32 v108, s51, v99
    v_fma_f32 v108, s50, v98, v108
    v_mul_f32 v109, s51, v98
    v_fma_f32 v109, s50, v99, -v109
    v_mul_f32 v110, s53, v103
    v_fma_f32 v110, s52, v102, v110
    v_mul_f32 v111, s53, v102
    v_fma_f32 v111, s52, v103, -v111
    v_add_f32 v64, v88, v100
    v_add_f32 v65, v89, v101
    v_add_f32 v74, v92, v96
    v_add_f32 v75, v93, v97
    v_sub_f32 v66, v88, v100
    v_sub_f32 v67, v89, v101
    v_sub_f32 v76, v92, v96
    v_sub_f32 v77, v93, v97
    v_add_f32 v68, v84, v64
    v_add_f32 v68, v68, v74
    v_fma_f32 v78, s42, v64, v84
    v_fma_f32 v78, s43, v74, v78
    v_fma_f32 v70, s43, v64, v84
    v_fma_f32 v70, s42, v74, v70
    v_add_f32 v69, v85, v65
    v_add_f32 v69, v69, v75
    v_fma_f32 v79, s42, v65, v85
    v_fma_f32 v79, s43, v75, v79
    v_fma_f32 v71, s43, v65, v85
    v_fma_f32 v71, s42, v75, v71
    v_mul_f32 v80, s44, v66
    v_fma_f32 v80, s45, v76, v80
    v_mul_f32 v72, s45, v66
    v_fma_f32 v72, -s44, v76, v72
    v_mul_f32 v81, s44, v67
    v_fma_f32 v81, s45, v77, v81
    v_mul_f32 v73, s45, v67
    v_fma_f32 v73, -s44, v77, v73
    v_add_f32 v82, v78, v81
    v_sub_f32 v83, v79, v80
    v_sub_f32 v90, v78, v81
    v_add_f32 v91, v79, v80
    v_add_f32 v94, v70, v73
    v_sub_f32 v95, v71, v72
    v_sub_f32 v98, v70, v73
    v_add_f32 v99, v71, v72
    v_add_f32 v102, v104, v110
    v_add_f32 v103, v105, v111
    v_add_f32 v88, v106, v108
    v_add_f32 v89, v107, v109
    v_sub_f32 v92, v104, v110
    v_sub_f32 v93, v105, v111
    v_sub_f32 v96, v106, v108
    v_sub_f32 v97, v107, v109
    v_add_f32 v100, v86, v102
    v_add_f32 v100, v100, v88
    v_fma_f32 v84, s42, v102, v86
    v_fma_f32 v84, s43, v88, v84
    v_fma_f32 v64, s43, v102, v86
    v_fma_f32 v64, s42, v88, v64
    v_add_f32 v101, v87, v103
    v_add_f32 v101, v101, v89
    v_fma_f32 v85, s42, v103, v87
    v_fma_f32 v85, s43, v89, v85
    v_fma_f32 v65, s43, v103, v87
    v_fma_f32 v65, s42, v89, v65
    v_mul_f32 v74, s44, v92
    v_fma_f32 v74, s45, v96, v74
    v_mul_f32 v66, s45, v92
    v_fma_f32 v66, -s44, v96, v66
    v_mul_f32 v75, s44, v93
    v_fma_f32 v75, s45, v97, v75
    v_mul_f32 v67, s45, v93
    v_fma_f32 v67, -s44, v97, v67
    v_add_f32 v76, v84, v75
    v_sub_f32 v77, v85, v74
    v_sub_f32 v78, v84, v75
    v_add_f32 v79, v85, v74
    v_add_f32 v80, v64, v67
    v_sub_f32 v81, v65, v66
    v_sub_f32 v70, v64, v67
    v_add_f32 v71, v65, v66
    v_mul_f32 v72, v101, v21
    v_fma_f32 v72, v100, v20, -v72
    v_mul_f32 v73, v100, v21
    v_fma_f32 v73, v101, v20, v73
    v_mul_f32 v104, v83, v23
    v_fma_f32 v104, v82, v22, -v104
    v_mul_f32 v105, v82, v23
    v_fma_f32 v105, v83, v22, v105
    v_mul_f32 v106, v77, v25
    v_fma_f32 v106, v76, v24, -v106
    v_mul_f32 v107, v76, v25
    v_fma_f32 v107, v77, v24, v107
    v_mul_f32 v108, v95, v27
    v_fma_f32 v108, v94, v26, -v108
    v_mul_f32 v109, v94, v27
    v_fma_f32 v109, v95, v26, v109
    v_mul_f32 v110, v81, v29
    v_fma_f32 v110, v80, v28, -v110
    v_mul_f32 v111, v80, v29
    v_fma_f32 v111, v81, v28, v111
    v_mul_f32 v86, v99, v31
    v_fma_f32 v86, v98, v30, -v86
    v_mul_f32 v87, v98, v31
    v_fma_f32 v87, v99, v30, v87
    v_mul_f32 v102, v71, v33
    v_fma_f32 v102, v70, v32, -v102
    v_mul_f32 v103, v70, v33
    v_fma_f32 v103, v71, v32, v103
    v_mul_f32 v88, v91, v35
    v_fma_f32 v88, v90, v34, -v88
    v_mul_f32 v89, v90, v35
    v_fma_f32 v89, v91, v34, v89
    v_mul_f32 v92, v79, v37
    v_fma_f32 v92, v78, v36, -v92
    v_mul_f32 v93, v78, v37
    v_fma_f32 v93, v79, v36, v93
    s_mul_i32 s21, s20, 5760
    v_lshlrev_b32 v3, 3, v1
    v_add_u32 v3, s21, v3
    ds_write_b64 v3, v[68:69] offset:23040
    ds_write_b64 v3, v[72:73] offset:23616
    ds_write_b64 v3, v[104:105] offset:24192
    ds_write_b64 v3, v[106:107] offset:24768
    ds_write_b64 v3, v[108:109] offset:25344
    ds_write_b64 v3, v[110:111] offset:25920
    ds_write_b64 v3, v[86:87] offset:26496
    ds_write_b64 v3, v[102:103] offset:27072
    ds_write_b64 v3, v[88:89] offset:27648
    ds_write_b64 v3, v[92:93] offset:28224
.Lk1a_kernel_skipln:
    s_waitcnt lgkmcnt(0)
    s_barrier
    v_lshrrev_b32 v4, 3, v0
    v_and_b32 v5, 7, v0
    v_cvt_f32_u32 v40, v5
    v_mul_f32 v20, 0xbc800000, v40
    v_fract_f32 v20, v20
    v_sin_f32 v21, v20
    v_cos_f32 v20, v20
    v_mul_f32 v22, 0xbd000000, v40
    v_fract_f32 v22, v22
    v_sin_f32 v23, v22
    v_cos_f32 v22, v22
    v_mul_f32 v24, 0xbd400000, v40
    v_fract_f32 v24, v24
    v_sin_f32 v25, v24
    v_cos_f32 v24, v24
    v_mul_f32 v26, 0xbd800000, v40
    v_fract_f32 v26, v26
    v_sin_f32 v27, v26
    v_cos_f32 v26, v26
    v_mul_f32 v28, 0xbda00000, v40
    v_fract_f32 v28, v28
    v_sin_f32 v29, v28
    v_cos_f32 v28, v28
    v_mul_f32 v30, 0xbdc00000, v40
    v_fract_f32 v30, v30
    v_sin_f32 v31, v30
    v_cos_f32 v30, v30
    v_mul_f32 v32, 0xbde00000, v40
    v_fract_f32 v32, v32
    v_sin_f32 v33, v32
    v_cos_f32 v32, v32
    s_nop 0
    v_mul_u32_u24 v3, 576, v4
    v_lshl_add_u32 v3, v5, 3, v3
    ds_read_b64 v[96:97], v3 offset:23040
    ds_read_b64 v[84:85], v3 offset:23104
    ds_read_b64 v[74:75], v3 offset:23168
    ds_read_b64 v[64:65], v3 offset:23232
    ds_read_b64 v[66:67], v3 offset:23296
    ds_read_b64 v[100:101], v3 offset:23360
    ds_read_b64 v[82:83], v3 offset:23424
    ds_read_b64 v[76:77], v3 offset:23488
    s_waitcnt lgkmcnt(0)
    v_add_f32 v94, v96, v66
    v_add_f32 v95, v97, v67
    v_sub_f32 v80, v96, v66
    v_sub_f32 v81, v97, v67
    v_add_f32 v98, v84, v100
    v_add_f32 v99, v85, v101
    v_sub_f32 v70, v84, v100
    v_sub_f32 v71, v85, v101
    v_add_f32 v90, v74, v82
    v_add_f32 v91, v75, v83
    v_sub_f32 v78, v74, v82
    v_sub_f32 v79, v75, v83
    v_add_f32 v68, v64, v76
    v_add_f32 v69, v65, v77
    v_sub_f32 v72, v64, v76
    v_sub_f32 v73, v65, v77
    v_add_f32 v104, v70, v71
    v_sub_f32 v105, v71, v70
    v_mul_f32 v104, s40, v104
    v_mul_f32 v105, s40, v105
    v_sub_f32 v106, v73, v72
    v_add_f32 v107, v72, v73
    v_mul_f32 v106, s40, v106
    v_mul_f32 v107, s41, v107
    v_mov_b32 v108, v79
    v_sub_f32 v109, 0, v78
    v_add_f32 v110, v94, v90
    v_add_f32 v111, v95, v91
    v_sub_f32 v86, v94, v90
    v_sub_f32 v87, v95, v91
    v_add_f32 v102, v98, v68
    v_add_f32 v103, v99, v69
    v_sub_f32 v88, v98, v68
    v_sub_f32 v89, v99, v69
    v_add_f32 v92, v110, v102
    v_add_f32 v93, v111, v103
    v_sub_f32 v96, v110, v102
    v_sub_f32 v97, v111, v103
    v_add_f32 v66, v86, v89
    v_sub_f32 v67, v87, v88
    v_sub_f32 v84, v86, v89
    v_add_f32 v85, v87, v88
    v_add_f32 v100, v80, v108
    v_add_f32 v101, v81, v109
    v_sub_f32 v74, v80, v108
    v_sub_f32 v75, v81, v109
    v_add_f32 v82, v104, v106
    v_add_f32 v83, v105, v107
    v_sub_f32 v64, v104, v106
    v_sub_f32 v65, v105, v107
    v_add_f32 v76, v100, v82
    v_add_f32 v77, v101, v83
    v_sub_f32 v70, v100, v82
    v_sub_f32 v71, v101, v83
    v_add_f32 v72, v74, v65
    v_sub_f32 v73, v75, v64
    v_sub_f32 v78, v74, v65
    v_add_f32 v79, v75, v64
    v_mul_f32 v94, v77, v21
    v_fma_f32 v94, v76, v20, -v94
    v_mul_f32 v95, v76, v21
    v_fma_f32 v95, v77, v20, v95
    v_mul_f32 v98, v67, v23
    v_fma_f32 v98, v66, v22, -v98
    v_mul_f32 v99, v66, v23
    v_fma_f32 v99, v67, v22, v99
    v_mul_f32 v90, v73, v25
    v_fma_f32 v90, v72, v24, -v90
    v_mul_f32 v91, v72, v25
    v_fma_f32 v91, v73, v24, v91
    v_mul_f32 v68, v97, v27
    v_fma_f32 v68, v96, v26, -v68
    v_mul_f32 v69, v96, v27
    v_fma_f32 v69, v97, v26, v69
    v_mul_f32 v110, v71, v29
    v_fma_f32 v110, v70, v28, -v110
    v_mul_f32 v111, v70, v29
    v_fma_f32 v111, v71, v28, v111
    v_mul_f32 v102, v85, v31
    v_fma_f32 v102, v84, v30, -v102
    v_mul_f32 v103, v84, v31
    v_fma_f32 v103, v85, v30, v103
    v_mul_f32 v86, v79, v33
    v_fma_f32 v86, v78, v32, -v86
    v_mul_f32 v87, v78, v33
    v_fma_f32 v87, v79, v32, v87
    v_mul_u32_u24 v3, 576, v4
    v_lshl_add_u32 v3, v5, 3, v3
    ds_write_b64 v3, v[92:93] offset:0
    ds_write_b64 v3, v[94:95] offset:72
    ds_write_b64 v3, v[98:99] offset:144
    ds_write_b64 v3, v[90:91] offset:216
    ds_write_b64 v3, v[68:69] offset:288
    ds_write_b64 v3, v[110:111] offset:360
    ds_write_b64 v3, v[102:103] offset:432
    ds_write_b64 v3, v[86:87] offset:504
    s_waitcnt lgkmcnt(0)
    s_barrier
    v_mul_u32_u24 v3, 72, v0
    ds_read_b64 v[88:89], v3 offset:0
    ds_read_b64 v[80:81], v3 offset:8
    ds_read_b64 v[104:105], v3 offset:16
    ds_read_b64 v[108:109], v3 offset:24
    ds_read_b64 v[106:107], v3 offset:32
    ds_read_b64 v[100:101], v3 offset:40
    ds_read_b64 v[82:83], v3 offset:48
    ds_read_b64 v[74:75], v3 offset:56
    s_waitcnt lgkmcnt(0)
    v_add_f32 v64, v88, v106
    v_add_f32 v65, v89, v107
    v_sub_f32 v76, v88, v106
    v_sub_f32 v77, v89, v107
    v_add_f32 v66, v80, v100
    v_add_f32 v67, v81, v101
    v_sub_f32 v72, v80, v100
    v_sub_f32 v73, v81, v101
    v_add_f32 v96, v104, v82
    v_add_f32 v97, v105, v83
    v_sub_f32 v70, v104, v82
    v_sub_f32 v71, v105, v83
    v_add_f32 v84, v108, v74
    v_add_f32 v85, v109, v75
    v_sub_f32 v78, v108, v74
    v_sub_f32 v79, v109, v75
    v_add_f32 v92, v72, v73
    v_sub_f32 v93, v73, v72
    v_mul_f32 v92, s40, v92
    v_mul_f32 v93, s40, v93
    v_sub_f32 v94, v79, v78
    v_add_f32 v95, v78, v79
    v_mul_f32 v94, s40, v94
    v_mul_f32 v95, s41, v95
    v_mov_b32 v98, v71
    v_sub_f32 v99, 0, v70
    v_add_f32 v90, v64, v96
    v_add_f32 v91, v65, v97
    v_sub_f32 v68, v64, v96
    v_sub_f32 v69, v65, v97
    v_add_f32 v110, v66, v84
    v_add_f32 v111, v67, v85
    v_sub_f32 v102, v66, v84
    v_sub_f32 v103, v67, v85
    v_add_f32 v86, v90, v110
    v_add_f32 v87, v91, v111
    v_sub_f32 v88, v90, v110
    v_sub_f32 v89, v91, v111
    v_add_f32 v106, v68, v103
    v_sub_f32 v107, v69, v102
    v_sub_f32 v80, v68, v103
    v_add_f32 v81, v69, v102
    v_add_f32 v100, v76, v98
    v_add_f32 v101, v77, v99
    v_sub_f32 v104, v76, v98
    v_sub_f32 v105, v77, v99
    v_add_f32 v82, v92, v94
    v_add_f32 v83, v93, v95
    v_sub_f32 v108, v92, v94
    v_sub_f32 v109, v93, v95
    v_add_f32 v74, v100, v82
    v_add_f32 v75, v101, v83
    v_sub_f32 v72, v100, v82
    v_sub_f32 v73, v101, v83
    v_add_f32 v78, v104, v109
    v_sub_f32 v79, v105, v108
    v_sub_f32 v70, v104, v109
    v_add_f32 v71, v105, v108
    v_mul_u32_u24 v6, 205, v4
    v_lshrrev_b32 v6, 11, v6
    v_mul_u32_u24 v7, 10, v6
    v_sub_u32 v7, v4, v7
    v_mul_u32_u24 v3, 10, v5
    v_add_u32 v7, v7, v3
    v_mul_u32_u24 v3, 648, v6
    v_add_u32 v3, v3, v7
    v_lshlrev_b32 v3, 3, v3
    ds_write_b64 v3, v[86:87] offset:23040
    ds_write_b64 v3, v[74:75] offset:23680
    ds_write_b64 v3, v[106:107] offset:24320
    ds_write_b64 v3, v[78:79] offset:24960
    ds_write_b64 v3, v[88:89] offset:25600
    ds_write_b64 v3, v[72:73] offset:26240
    ds_write_b64 v3, v[80:81] offset:26880
    ds_write_b64 v3, v[70:71] offset:27520
    s_waitcnt lgkmcnt(0)
    s_barrier
    v_and_b32 v4, 3, v0
    v_lshrrev_b32 v5, 2, v0
    v_mul_u32_u24 v6, 5184, v4
    s_lshl_b32 s21, s2, 6
    v_lshlrev_b32 v7, 4, v4
    v_add_u32 v7, s21, v7
    v_lshl_add_u32 v8, v5, 3, v6
    v_sub_u32 v9, 640, v5
    v_cmp_eq_u32 vcc, 0, v5
    s_nop 1
    v_cndmask_b32 v9, v9, 0, vcc
    v_lshl_add_u32 v9, v9, 3, v6
    ds_read_b64 v[10:11], v8 offset:23040
    ds_read_b64 v[12:13], v9 offset:23040
    v_lshl_add_u32 v14, v5, 14, v7
    s_waitcnt lgkmcnt(0)
    v_add_f32 v16, v10, v12
    v_sub_f32 v17, v11, v13
    v_add_f32 v18, v11, v13
    v_sub_f32 v19, v12, v10
    buffer_store_dwordx4 v[16:19], v14, s[12:15], 0 offen
    v_add_u32 v5, 80, v5
    v_lshl_add_u32 v8, v5, 3, v6
    v_sub_u32 v9, 640, v5
    v_cmp_eq_u32 vcc, 0, v5
    s_nop 1
    v_cndmask_b32 v9, v9, 0, vcc
    v_lshl_add_u32 v9, v9, 3, v6
    ds_read_b64 v[10:11], v8 offset:23040
    ds_read_b64 v[12:13], v9 offset:23040
    v_lshl_add_u32 v14, v5, 14, v7
    s_waitcnt lgkmcnt(0)
    v_add_f32 v16, v10, v12
    v_sub_f32 v17, v11, v13
    v_add_f32 v18, v11, v13
    v_sub_f32 v19, v12, v10
    buffer_store_dwordx4 v[16:19], v14, s[12:15], 0 offen
    v_add_u32 v5, 80, v5
    v_lshl_add_u32 v8, v5, 3, v6
    v_sub_u32 v9, 640, v5
    v_cmp_eq_u32 vcc, 0, v5
    s_nop 1
    v_cndmask_b32 v9, v9, 0, vcc
    v_lshl_add_u32 v9, v9, 3, v6
    ds_read_b64 v[10:11], v8 offset:23040
    ds_read_b64 v[12:13], v9 offset:23040
    v_lshl_add_u32 v14, v5, 14, v7
    s_waitcnt lgkmcnt(0)
    v_add_f32 v16, v10, v12
    v_sub_f32 v17, v11, v13
    v_add_f32 v18, v11, v13
    v_sub_f32 v19, v12, v10
    buffer_store_dwordx4 v[16:19], v14, s[12:15], 0 offen
    v_add_u32 v5, 80, v5
    v_lshl_add_u32 v8, v5, 3, v6
    v_sub_u32 v9, 640, v5
    v_cmp_eq_u32 vcc, 0, v5
    s_nop 1
    v_cndmask_b32 v9, v9, 0, vcc
    v_lshl_add_u32 v9, v9, 3, v6
    ds_read_b64 v[10:11], v8 offset:23040
    ds_read_b64 v[12:13], v9 offset:23040
    v_lshl_add_u32 v14, v5, 14, v7
    s_waitcnt lgkmcnt(0)
    v_add_f32 v16, v10, v12
    v_sub_f32 v17, v11, v13
    v_add_f32 v18, v11, v13
    v_sub_f32 v19, v12, v10
    buffer_store_dwordx4 v[16:19], v14, s[12:15], 0 offen
    v_add_u32 v5, 80, v5
    v_cmp_ge_u32 vcc, 320, v5
    s_and_saveexec_b64 s[22:23], vcc
    v_lshl_add_u32 v8, v5, 3, v6
    v_sub_u32 v9, 640, v5
    v_cmp_eq_u32 vcc, 0, v5
    s_nop 1
    v_cndmask_b32 v9, v9, 0, vcc
    v_lshl_add_u32 v9, v9, 3, v6
    ds_read_b64 v[10:11], v8 offset:23040
    ds_read_b64 v[12:13], v9 offset:23040
    v_lshl_add_u32 v14, v5, 14, v7
    s_waitcnt lgkmcnt(0)
    v_add_f32 v16, v10, v12
    v_sub_f32 v17, v11, v13
    v_add_f32 v18, v11, v13
    v_sub_f32 v19, v12, v10
    buffer_store_dwordx4 v[16:19], v14, s[12:15], 0 offen
    s_mov_b64 exec, s[22:23]
.Lk1a_kernel_end:
    s_endpgm
.globl wp_kernel
.p2align 8
.type wp_kernel,@function
wp_kernel:
    s_cmp_ge_u32 s2, 810
    s_cbranch_scc1 .Lwp_kernel_end
    s_load_dwordx2 s[4:5], s[0:1], 72
    s_load_dwordx4 s[24:27], s[0:1], 32
    s_load_dwordx2 s[28:29], s[0:1], 48
    s_waitcnt lgkmcnt(0)
    s_cmp_ge_u32 s2, 540
    s_cbranch_scc1 .Lwp_kernel_w2
    s_cmp_ge_u32 s2, 270
    s_cselect_b32 s20, 1, 0
    s_cselect_b32 s6, s26, s24
    s_cselect_b32 s7, s27, s25
    s_mul_i32 s21, s20, 270
    s_sub_u32 s21, s2, s21
    s_mul_i32 s22, s21, 6554
    s_lshr_b32 s22, s22, 16
    s_mul_i32 s23, s22, 10
    s_sub_u32 s23, s21, s23
    s_mov_b32 s8, s6
    s_mov_b32 s9, s7
    s_mov_b32 s10, 2211840
    s_mov_b32 s11, 0x00020000
    s_mul_i32 s16, s23, 221184
    s_lshl_b32 s17, s22, 7
    s_add_u32 s16, s16, s17
    s_mov_b32 s18, 3456
    s_lshl_b32 s17, s22, 7
    s_lshl_b32 s19, s20, 6
    s_add_u32 s17, s17, s19
    s_mul_i32 s17, s17, 1280
    s_lshl_b32 s19, s23, 7
    s_add_u32 s17, s17, s19
    s_add_u32 s17, s17, 44040192
    s_mov_b32 s19, 1280
    s_branch .Lwp_kernel_go
.Lwp_kernel_w2:
    s_sub_u32 s21, s2, 540
    s_mul_i32 s22, s21, 2428
    s_lshr_b32 s22, s22, 16
    s_mul_i32 s23, s22, 27
    s_sub_u32 s23, s21, s23
    s_mov_b32 s8, s28
    s_mov_b32 s9, s29
    s_mov_b32 s10, 2211840
    s_mov_b32 s11, 0x00020000
    s_mul_i32 s16, s23, 81920
    s_lshl_b32 s17, s22, 7
    s_add_u32 s16, s16, s17
    s_mov_b32 s18, 1280
    s_mul_i32 s17, s22, 221184
    s_lshl_b32 s19, s23, 7
    s_add_u32 s17, s17, s19
    s_add_u32 s17, s17, 49283072
    s_mov_b32 s19, 3456
.Lwp_kernel_go:
    s_mov_b32 s12, s4
    s_mov_b32 s13, s5
    s_mov_b32 s14, 268435456
    s_mov_b32 s15, 0x00020000
    v_lshrrev_b32 v1, 2, v0
    v_and_b32 v2, 3, v0
    v_mul_lo_u32 v3, v1, s18
    v_lshl_add_u32 v3, v2, 5, v3
    buffer_load_dwordx4 v[4:7], v3, s[8:11], s16 offen
    buffer_load_dwordx4 v[8:11], v3, s[8:11], s16 offen offset:16
    v_lshlrev_b32 v12, 4, v2
    v_mul_u32_u24 v12, 144, v12
    v_lshl_add_u32 v12, v1, 1, v12
    s_waitcnt vmcnt(0)
    ds_write_b16 v12, v4 offset:0
    ds_write_b16_d16_hi v12, v4 offset:144
    ds_write_b16 v12, v5 offset:288
    ds_write_b16_d16_hi v12, v5 offset:432
    ds_write_b16 v12, v6 offset:576
    ds_write_b16_d16_hi v12, v6 offset:720
    ds_write_b16 v12, v7 offset:864
    ds_write_b16_d16_hi v12, v7 offset:1008
    ds_write_b16 v12, v8 offset:1152
    ds_write_b16_d16_hi v12, v8 offset:1296
    ds_write_b16 v12, v9 offset:1440
    ds_write_b16_d16_hi v12, v9 offset:1584
    ds_write_b16 v12, v10 offset:1728
    ds_write_b16_d16_hi v12, v10 offset:1872
    ds_write_b16 v12, v11 offset:2016
    ds_write_b16_d16_hi v12, v11 offset:2160
    s_waitcnt lgkmcnt(0)
    s_barrier
    v_mul_u32_u24 v12, 144, v1
    v_lshl_add_u32 v12, v2, 5, v12
    ds_read_b128 v[4:7], v12
    ds_read_b128 v[8:11], v12 offset:16
    v_mul_lo_u32 v3, v1, s19
    v_lshl_add_u32 v3, v2, 5, v3
    s_waitcnt lgkmcnt(0)
    buffer_store_dwordx4 v[4:7], v3, s[12:15], s17 offen
    buffer_store_dwordx4 v[8:11], v3, s[12:15], s17 offen offset:16
.Lwp_kernel_end:
    s_endpgm
.globl k2a_kernel
.p2align 8
.type k2a_kernel,@function
k2a_kernel:
    s_cmp_ge_u32 s2, 321
    s_cbranch_scc1 .Lk2a_kernel_end
    s_load_dwordx2 s[4:5], s[0:1], 72
    s_lshl_b32 s3, s2, 14
    s_add_u32 s6, s3, 6291456
    s_waitcnt lgkmcnt(0)
    s_add_u32 s8, s4, s3
    s_addc_u32 s9, s5, 0
    s_mov_b32 s10, 16384
    s_mov_b32 s11, 0x00020000
    s_add_u32 s12, s4, s6
    s_addc_u32 s13, s5, 0
    s_mov_b32 s14, 16384
    s_mov_b32 s15, 0x00020000
    s_mov_b32 s16, 0x3f3504f3
    s_mov_b32 s17, 0xbf3504f3
    s_mov_b32 s18, 4096
    s_mov_b32 s19, 8192
    s_mov_b32 s20, 12288
    v_lshlrev_b32 v1, 3, v0
    buffer_load_dwordx2 v[66:67], v1, s[8:11], 0 offen offset:0
    buffer_load_dwordx2 v[68:69], v1, s[8:11], 0 offen offset:2048
    buffer_load_dwordx2 v[70:71], v1, s[8:11], s18 offen offset:0
    buffer_load_dwordx2 v[72:73], v1, s[8:11], s18 offen offset:2048
    buffer_load_dwordx2 v[74:75], v1, s[8:11], s19 offen offset:0
    buffer_load_dwordx2 v[76:77], v1, s[8:11], s19 offen offset:2048
    buffer_load_dwordx2 v[78:79], v1, s[8:11], s20 offen offset:0
    buffer_load_dwordx2 v[80:81], v1, s[8:11], s20 offen offset:2048
    v_lshlrev_b32 v6, 6, v0
    buffer_load_dwordx4 v[50:53], v6, s[12:15], 0 offen offset:0
    buffer_load_dwordx4 v[54:57], v6, s[12:15], 0 offen offset:16
    buffer_load_dwordx4 v[58:61], v6, s[12:15], 0 offen offset:32
    buffer_load_dwordx4 v[62:65], v6, s[12:15], 0 offen offset:48
    v_lshrrev_b32 v6, 5, v0
    v_and_b32 v2, 31, v0
    v_lshlrev_b32 v3, 3, v2
    v_lshl_add_u32 v2, v6, 11, v3
    v_mul_u32_u24 v6, 2304, v6
    v_add_u32 v3, v6, v3
    v_lshrrev_b32 v6, 2, v0
    v_mul_u32_u24 v4, 288, v6
    v_and_b32 v6, 3, v0
    v_lshl_add_u32 v4, v6, 3, v4
    v_lshrrev_b32 v5, 2, v0
    v_mul_u32_u24 v5, 288, v5
    v_lshl_add_u32 v5, v6, 6, v5
    v_cvt_f32_u32 v6, v0
    v_mul_f32 v8, 0xba000000, v6
    v_fract_f32 v8, v8
    v_sin_f32 v9, v8
    v_cos_f32 v8, v8
    v_mul_f32 v10, 0xba800000, v6
    v_fract_f32 v10, v10
    v_sin_f32 v11, v10
    v_cos_f32 v10, v10
    v_mul_f32 v12, 0xbac00000, v6
    v_fract_f32 v12, v12
    v_sin_f32 v13, v12
    v_cos_f32 v12, v12
    v_mul_f32 v14, 0xbb000000, v6
    v_fract_f32 v14, v14
    v_sin_f32 v15, v14
    v_cos_f32 v14, v14
    v_mul_f32 v16, 0xbb200000, v6
    v_fract_f32 v16, v16
    v_sin_f32 v17, v16
    v_cos_f32 v16, v16
    v_mul_f32 v18, 0xbb400000, v6
    v_fract_f32 v18, v18
    v_sin_f32 v19, v18
    v_cos_f32 v18, v18
    v_mul_f32 v20, 0xbb600000, v6
    v_fract_f32 v20, v20
    v_sin_f32 v21, v20
    v_cos_f32 v20, v20
    s_nop 0
    v_and_b32 v7, 31, v0
    v_cvt_f32_u32 v6, v7
    v_mul_f32 v22, 0xbb800000, v6
    v_fract_f32 v22, v22
    v_sin_f32 v23, v22
    v_cos_f32 v22, v22
    v_mul_f32 v24, 0xbc000000, v6
    v_fract_f32 v24, v24
    v_sin_f32 v25, v24
    v_cos_f32 v24, v24
    v_mul_f32 v26, 0xbc400000, v6
    v_fract_f32 v26, v26
    v_sin_f32 v27, v26
    v_cos_f32 v26, v26
    v_mul_f32 v28, 0xbc800000, v6
    v_fract_f32 v28, v28
    v_sin_f32 v29, v28
    v_cos_f32 v28, v28
    v_mul_f32 v30, 0xbca00000, v6
    v_fract_f32 v30, v30
    v_sin_f32 v31, v30
    v_cos_f32 v30, v30
    v_mul_f32 v32, 0xbcc00000, v6
    v_fract_f32 v32, v32
    v_sin_f32 v33, v32
    v_cos_f32 v32, v32
    v_mul_f32 v34, 0xbce00000, v6
    v_fract_f32 v34, v34
    v_sin_f32 v35, v34
    v_cos_f32 v34, v34
    s_nop 0
    v_and_b32 v7, 3, v0
    v_cvt_f32_u32 v6, v7
    v_mul_f32 v36, 0xbd000000, v6
    v_fract_f32 v36, v36
    v_sin_f32 v37, v36
    v_cos_f32 v36, v36
    v_mul_f32 v38, 0xbd800000, v6
    v_fract_f32 v38, v38
    v_sin_f32 v39, v38
    v_cos_f32 v38, v38
    v_mul_f32 v40, 0xbdc00000, v6
    v_fract_f32 v40, v40
    v_sin_f32 v41, v40
    v_cos_f32 v40, v40
    v_mul_f32 v42, 0xbe000000, v6
    v_fract_f32 v42, v42
    v_sin_f32 v43, v42
    v_cos_f32 v42, v42
    v_mul_f32 v44, 0xbe200000, v6
    v_fract_f32 v44, v44
    v_sin_f32 v45, v44
    v_cos_f32 v44, v44
    v_mul_f32 v46, 0xbe400000, v6
    v_fract_f32 v46, v46
    v_sin_f32 v47, v46
    v_cos_f32 v46, v46
    v_mul_f32 v48, 0xbe600000, v6
    v_fract_f32 v48, v48
    v_sin_f32 v49, v48
    v_cos_f32 v48, v48
    s_nop 0
    s_waitcnt vmcnt(4)
    v_add_f32 v82, v66, v74
    v_add_f32 v83, v67, v75
    v_sub_f32 v84, v66, v74
    v_sub_f32 v85, v67, v75
    v_add_f32 v86, v68, v76
    v_add_f32 v87, v69, v77
    v_sub_f32 v88, v68, v76
    v_sub_f32 v89, v69, v77
    v_add_f32 v90, v70, v78
    v_add_f32 v91, v71, v79
    v_sub_f32 v92, v70, v78
    v_sub_f32 v93, v71, v79
    v_add_f32 v94, v72, v80
    v_add_f32 v95, v73, v81
    v_sub_f32 v96, v72, v80
    v_sub_f32 v97, v73, v81
    v_add_f32 v98, v88, v89
    v_sub_f32 v99, v89, v88
    v_mul_f32 v98, s16, v98
    v_mul_f32 v99, s16, v99
    v_sub_f32 v100, v97, v96
    v_add_f32 v101, v96, v97
    v_mul_f32 v100, s16, v100
    v_mul_f32 v101, s17, v101
    v_mov_b32 v102, v93
    v_sub_f32 v103, 0, v92
    v_add_f32 v104, v82, v90
    v_add_f32 v105, v83, v91
    v_sub_f32 v66, v82, v90
    v_sub_f32 v67, v83, v91
    v_add_f32 v74, v86, v94
    v_add_f32 v75, v87, v95
    v_sub_f32 v68, v86, v94
    v_sub_f32 v69, v87, v95
    v_add_f32 v76, v104, v74
    v_add_f32 v77, v105, v75
    v_sub_f32 v70, v104, v74
    v_sub_f32 v71, v105, v75
    v_add_f32 v78, v66, v69
    v_sub_f32 v79, v67, v68
    v_sub_f32 v72, v66, v69
    v_add_f32 v73, v67, v68
    v_add_f32 v80, v84, v102
    v_add_f32 v81, v85, v103
    v_sub_f32 v88, v84, v102
    v_sub_f32 v89, v85, v103
    v_add_f32 v96, v98, v100
    v_add_f32 v97, v99, v101
    v_sub_f32 v92, v98, v100
    v_sub_f32 v93, v99, v101
    v_add_f32 v82, v80, v96
    v_add_f32 v83, v81, v97
    v_sub_f32 v86, v80, v96
    v_sub_f32 v87, v81, v97
    v_add_f32 v90, v88, v93
    v_sub_f32 v91, v89, v92
    v_sub_f32 v94, v88, v93
    v_add_f32 v95, v89, v92
    v_mul_f32 v104, v83, v9
    v_fma_f32 v104, v82, v8, -v104
    v_mul_f32 v105, v82, v9
    v_fma_f32 v105, v83, v8, v105
    v_mul_f32 v74, v79, v11
    v_fma_f32 v74, v78, v10, -v74
    v_mul_f32 v75, v78, v11
    v_fma_f32 v75, v79, v10, v75
    v_mul_f32 v66, v91, v13
    v_fma_f32 v66, v90, v12, -v66
    v_mul_f32 v67, v90, v13
    v_fma_f32 v67, v91, v12, v67
    v_mul_f32 v68, v71, v15
    v_fma_f32 v68, v70, v14, -v68
    v_mul_f32 v69, v70, v15
    v_fma_f32 v69, v71, v14, v69
    v_mul_f32 v84, v87, v17
    v_fma_f32 v84, v86, v16, -v84
    v_mul_f32 v85, v86, v17
    v_fma_f32 v85, v87, v16, v85
    v_mul_f32 v98, v73, v19
    v_fma_f32 v98, v72, v18, -v98
    v_mul_f32 v99, v72, v19
    v_fma_f32 v99, v73, v18, v99
    v_mul_f32 v102, v95, v21
    v_fma_f32 v102, v94, v20, -v102
    v_mul_f32 v103, v94, v21
    v_fma_f32 v103, v95, v20, v103
    ds_write_b64 v1, v[76:77] offset:0
    ds_write_b64 v1, v[104:105] offset:2048
    ds_write_b64 v1, v[74:75] offset:4096
    ds_write_b64 v1, v[66:67] offset:6144
    ds_write_b64 v1, v[68:69] offset:8192
    ds_write_b64 v1, v[84:85] offset:10240
    ds_write_b64 v1, v[98:99] offset:12288
    ds_write_b64 v1, v[102:103] offset:14336
    s_waitcnt lgkmcnt(0)
    s_barrier
    ds_read_b64 v[76:77], v2 offset:0
    ds_read_b64 v[104:105], v2 offset:256
    ds_read_b64 v[74:75], v2 offset:512
    ds_read_b64 v[66:67], v2 offset:768
    ds_read_b64 v[68:69], v2 offset:1024
    ds_read_b64 v[84:85], v2 offset:1280
    ds_read_b64 v[98:99], v2 offset:1536
    ds_read_b64 v[102:103], v2 offset:1792
    s_waitcnt lgkmcnt(0)
    v_add_f32 v100, v76, v68
    v_add_f32 v101, v77, v69
    v_sub_f32 v80, v76, v68
    v_sub_f32 v81, v77, v69
    v_add_f32 v96, v104, v84
    v_add_f32 v97, v105, v85
    v_sub_f32 v88, v104, v84
    v_sub_f32 v89, v105, v85
    v_add_f32 v92, v74, v98
    v_add_f32 v93, v75, v99
    v_sub_f32 v82, v74, v98
    v_sub_f32 v83, v75, v99
    v_add_f32 v78, v66, v102
    v_add_f32 v79, v67, v103
    v_sub_f32 v90, v66, v102
    v_sub_f32 v91, v67, v103
    v_add_f32 v70, v88, v89
    v_sub_f32 v71, v89, v88
    v_mul_f32 v70, s16, v70
    v_mul_f32 v71, s16, v71
    v_sub_f32 v86, v91, v90
    v_add_f32 v87, v90, v91
    v_mul_f32 v86, s16, v86
    v_mul_f32 v87, s17, v87
    v_mov_b32 v72, v83
    v_sub_f32 v73, 0, v82
    v_add_f32 v94, v100, v92
    v_add_f32 v95, v101, v93
    v_sub_f32 v76, v100, v92
    v_sub_f32 v77, v101, v93
    v_add_f32 v68, v96, v78
    v_add_f32 v69, v97, v79
    v_sub_f32 v104, v96, v78
    v_sub_f32 v105, v97, v79
    v_add_f32 v84, v94, v68
    v_add_f32 v85, v95, v69
    v_sub_f32 v74, v94, v68
    v_sub_f32 v75, v95, v69
    v_add_f32 v98, v76, v105
    v_sub_f32 v99, v77, v104
    v_sub_f32 v66, v76, v105
    v_add_f32 v67, v77, v104
    v_add_f32 v102, v80, v72
    v_add_f32 v103, v81, v73
    v_sub_f32 v88, v80, v72
    v_sub_f32 v89, v81, v73
    v_add_f32 v90, v70, v86
    v_add_f32 v91, v71, v87
    v_sub_f32 v82, v70, v86
    v_sub_f32 v83, v71, v87
    v_add_f32 v100, v102, v90
    v_add_f32 v101, v103, v91
    v_sub_f32 v96, v102, v90
    v_sub_f32 v97, v103, v91
    v_add_f32 v92, v88, v83
    v_sub_f32 v93, v89, v82
    v_sub_f32 v78, v88, v83
    v_add_f32 v79, v89, v82
    v_mul_f32 v94, v101, v23
    v_fma_f32 v94, v100, v22, -v94
    v_mul_f32 v95, v100, v23
    v_fma_f32 v95, v101, v22, v95
    v_mul_f32 v68, v99, v25
    v_fma_f32 v68, v98, v24, -v68
    v_mul_f32 v69, v98, v25
    v_fma_f32 v69, v99, v24, v69
    v_mul_f32 v76, v93, v27
    v_fma_f32 v76, v92, v26, -v76
    v_mul_f32 v77, v92, v27
    v_fma_f32 v77, v93, v26, v77
    v_mul_f32 v104, v75, v29
    v_fma_f32 v104, v74, v28, -v104
    v_mul_f32 v105, v74, v29
    v_fma_f32 v105, v75, v28, v105
    v_mul_f32 v80, v97, v31
    v_fma_f32 v80, v96, v30, -v80
    v_mul_f32 v81, v96, v31
    v_fma_f32 v81, v97, v30, v81
    v_mul_f32 v70, v67, v33
    v_fma_f32 v70, v66, v32, -v70
    v_mul_f32 v71, v66, v33
    v_fma_f32 v71, v67, v32, v71
    v_mul_f32 v72, v79, v35
    v_fma_f32 v72, v78, v34, -v72
    v_mul_f32 v73, v78, v35
    v_fma_f32 v73, v79, v34, v73
    ds_write_b64 v3, v[84:85] offset:18432
    ds_write_b64 v3, v[94:95] offset:18720
    ds_write_b64 v3, v[68:69] offset:19008
    ds_write_b64 v3, v[76:77] offset:19296
    ds_write_b64 v3, v[104:105] offset:19584
    ds_write_b64 v3, v[80:81] offset:19872
    ds_write_b64 v3, v[70:71] offset:20160
    ds_write_b64 v3, v[72:73] offset:20448
    s_waitcnt lgkmcnt(0)
    s_barrier
    ds_read_b64 v[84:85], v4 offset:18432
    ds_read_b64 v[94:95], v4 offset:18464
    ds_read_b64 v[68:69], v4 offset:18496
    ds_read_b64 v[76:77], v4 offset:18528
    ds_read_b64 v[104:105], v4 offset:18560
    ds_read_b64 v[80:81], v4 offset:18592
    ds_read_b64 v[70:71], v4 offset:18624
    ds_read_b64 v[72:73], v4 offset:18656
    s_waitcnt lgkmcnt(0)
    v_add_f32 v86, v84, v104
    v_add_f32 v87, v85, v105
    v_sub_f32 v102, v84, v104
    v_sub_f32 v103, v85, v105
    v_add_f32 v90, v94, v80
    v_add_f32 v91, v95, v81
    v_sub_f32 v88, v94, v80
    v_sub_f32 v89, v95, v81
    v_add_f32 v82, v68, v70
    v_add_f32 v83, v69, v71
    v_sub_f32 v100, v68, v70
    v_sub_f32 v101, v69, v71
    v_add_f32 v98, v76, v72
    v_add_f32 v99, v77, v73
    v_sub_f32 v92, v76, v72
    v_sub_f32 v93, v77, v73
    v_add_f32 v74, v88, v89
    v_sub_f32 v75, v89, v88
    v_mul_f32 v74, s16, v74
    v_mul_f32 v75, s16, v75
    v_sub_f32 v96, v93, v92
    v_add_f32 v97, v92, v93
    v_mul_f32 v96, s16, v96
    v_mul_f32 v97, s17, v97
    v_mov_b32 v66, v101
    v_sub_f32 v67, 0, v100
    v_add_f32 v78, v86, v82
    v_add_f32 v79, v87, v83
    v_sub_f32 v84, v86, v82
    v_sub_f32 v85, v87, v83
    v_add_f32 v104, v90, v98
    v_add_f32 v105, v91, v99
    v_sub_f32 v94, v90, v98
    v_sub_f32 v95, v91, v99
    v_add_f32 v80, v78, v104
    v_add_f32 v81, v79, v105
    v_sub_f32 v68, v78, v104
    v_sub_f32 v69, v79, v105
    v_add_f32 v70, v84, v95
    v_sub_f32 v71, v85, v94
    v_sub_f32 v76, v84, v95
    v_add_f32 v77, v85, v94
    v_add_f32 v72, v102, v66
    v_add_f32 v73, v103, v67
    v_sub_f32 v88, v102, v66
    v_sub_f32 v89, v103, v67
    v_add_f32 v92, v74, v96
    v_add_f32 v93, v75, v97
    v_sub_f32 v100, v74, v96
    v_sub_f32 v101, v75, v97
    v_add_f32 v86, v72, v92
    v_add_f32 v87, v73, v93
    v_sub_f32 v90, v72, v92
    v_sub_f32 v91, v73, v93
    v_add_f32 v82, v88, v101
    v_sub_f32 v83, v89, v100
    v_sub_f32 v98, v88, v101
    v_add_f32 v99, v89, v100
    v_mul_f32 v78, v87, v37
    v_fma_f32 v78, v86, v36, -v78
    v_mul_f32 v79, v86, v37
    v_fma_f32 v79, v87, v36, v79
    v_mul_f32 v104, v71, v39
    v_fma_f32 v104, v70, v38, -v104
    v_mul_f32 v105, v70, v39
    v_fma_f32 v105, v71, v38, v105
    v_mul_f32 v84, v83, v41
    v_fma_f32 v84, v82, v40, -v84
    v_mul_f32 v85, v82, v41
    v_fma_f32 v85, v83, v40, v85
    v_mul_f32 v94, v69, v43
    v_fma_f32 v94, v68, v42, -v94
    v_mul_f32 v95, v68, v43
    v_fma_f32 v95, v69, v42, v95
    v_mul_f32 v102, v91, v45
    v_fma_f32 v102, v90, v44, -v102
    v_mul_f32 v103, v90, v45
    v_fma_f32 v103, v91, v44, v103
    v_mul_f32 v74, v77, v47
    v_fma_f32 v74, v76, v46, -v74
    v_mul_f32 v75, v76, v47
    v_fma_f32 v75, v77, v46, v75
    v_mul_f32 v66, v99, v49
    v_fma_f32 v66, v98, v48, -v66
    v_mul_f32 v67, v98, v49
    v_fma_f32 v67, v99, v48, v67
    ds_write_b64 v4, v[80:81] offset:0
    ds_write_b64 v4, v[78:79] offset:32
    ds_write_b64 v4, v[104:105] offset:64
    ds_write_b64 v4, v[84:85] offset:96
    ds_write_b64 v4, v[94:95] offset:128
    ds_write_b64 v4, v[102:103] offset:160
    ds_write_b64 v4, v[74:75] offset:192
    ds_write_b64 v4, v[66:67] offset:224
    s_waitcnt lgkmcnt(0)
    s_barrier
    ds_read_b64 v[80:81], v5 offset:0
    ds_read_b64 v[78:79], v5 offset:8
    ds_read_b64 v[104:105], v5 offset:16
    ds_read_b64 v[84:85], v5 offset:24
    ds_read_b64 v[94:95], v5 offset:32
    ds_read_b64 v[102:103], v5 offset:40
    ds_read_b64 v[74:75], v5 offset:48
    ds_read_b64 v[66:67], v5 offset:56
    s_waitcnt lgkmcnt(0)
    s_waitcnt vmcnt(0)
    v_add_f32 v96, v80, v104
    v_add_f32 v97, v81, v105
    v_sub_f32 v72, v80, v104
    v_sub_f32 v73, v81, v105
    v_add_f32 v92, v78, v84
    v_add_f32 v93, v79, v85
    v_sub_f32 v88, v78, v84
    v_sub_f32 v89, v79, v85
    v_add_f32 v100, v96, v92
    v_add_f32 v101, v97, v93
    v_sub_f32 v86, v96, v92
    v_sub_f32 v87, v97, v93
    v_add_f32 v70, v72, v89
    v_sub_f32 v71, v73, v88
    v_sub_f32 v82, v72, v89
    v_add_f32 v83, v73, v88
    v_mul_f32 v68, v101, v51
    v_fma_f32 v68, v100, v50, -v68
    v_mul_f32 v69, v100, v51
    v_fma_f32 v69, v101, v50, v69
    v_mul_f32 v90, v71, v53
    v_fma_f32 v90, v70, v52, -v90
    v_mul_f32 v91, v70, v53
    v_fma_f32 v91, v71, v52, v91
    v_mul_f32 v76, v87, v55
    v_fma_f32 v76, v86, v54, -v76
    v_mul_f32 v77, v86, v55
    v_fma_f32 v77, v87, v54, v77
    v_mul_f32 v98, v83, v57
    v_fma_f32 v98, v82, v56, -v98
    v_mul_f32 v99, v82, v57
    v_fma_f32 v99, v83, v56, v99
    v_add_f32 v80, v68, v76
    v_add_f32 v81, v69, v77
    v_sub_f32 v78, v68, v76
    v_sub_f32 v79, v69, v77
    v_add_f32 v104, v90, v98
    v_add_f32 v105, v91, v99
    v_sub_f32 v84, v90, v98
    v_sub_f32 v85, v91, v99
    v_add_f32 v96, v80, v104
    v_add_f32 v97, v81, v105
    v_sub_f32 v92, v80, v104
    v_sub_f32 v93, v81, v105
    v_sub_f32 v72, v78, v85
    v_add_f32 v73, v79, v84
    v_add_f32 v88, v78, v85
    v_sub_f32 v89, v79, v84
    v_add_f32 v100, v94, v74
    v_add_f32 v101, v95, v75
    v_sub_f32 v70, v94, v74
    v_sub_f32 v71, v95, v75
    v_add_f32 v86, v102, v66
    v_add_f32 v87, v103, v67
    v_sub_f32 v82, v102, v66
    v_sub_f32 v83, v103, v67
    v_add_f32 v68, v100, v86
    v_add_f32 v69, v101, v87
    v_sub_f32 v90, v100, v86
    v_sub_f32 v91, v101, v87
    v_add_f32 v76, v70, v83
    v_sub_f32 v77, v71, v82
    v_sub_f32 v98, v70, v83
    v_add_f32 v99, v71, v82
    v_mul_f32 v80, v69, v59
    v_fma_f32 v80, v68, v58, -v80
    v_mul_f32 v81, v68, v59
    v_fma_f32 v81, v69, v58, v81
    v_mul_f32 v104, v77, v61
    v_fma_f32 v104, v76, v60, -v104
    v_mul_f32 v105, v76, v61
    v_fma_f32 v105, v77, v60, v105
    v_mul_f32 v78, v91, v63
    v_fma_f32 v78, v90, v62, -v78
    v_mul_f32 v79, v90, v63
    v_fma_f32 v79, v91, v62, v79
    v_mul_f32 v84, v99, v65
    v_fma_f32 v84, v98, v64, -v84
    v_mul_f32 v85, v98, v65
    v_fma_f32 v85, v99, v64, v85
    v_add_f32 v94, v80, v78
    v_add_f32 v95, v81, v79
    v_sub_f32 v102, v80, v78
    v_sub_f32 v103, v81, v79
    v_add_f32 v74, v104, v84
    v_add_f32 v75, v105, v85
    v_sub_f32 v66, v104, v84
    v_sub_f32 v67, v105, v85
    v_add_f32 v100, v94, v74
    v_add_f32 v101, v95, v75
    v_sub_f32 v86, v94, v74
    v_sub_f32 v87, v95, v75
    v_sub_f32 v70, v102, v67
    v_add_f32 v71, v103, v66
    v_add_f32 v82, v102, v67
    v_sub_f32 v83, v103, v66
    ds_write_b64 v5, v[96:97] offset:18432
    ds_write_b64 v5, v[72:73] offset:18440
    ds_write_b64 v5, v[92:93] offset:18448
    ds_write_b64 v5, v[88:89] offset:18456
    ds_write_b64 v5, v[100:101] offset:18464
    ds_write_b64 v5, v[70:71] offset:18472
    ds_write_b64 v5, v[86:87] offset:18480
    ds_write_b64 v5, v[82:83] offset:18488
    s_waitcnt lgkmcnt(0)
    s_barrier
    ds_read_b64 v[96:97], v4 offset:18432
    ds_read_b64 v[72:73], v4 offset:18464
    ds_read_b64 v[92:93], v4 offset:18496
    ds_read_b64 v[88:89], v4 offset:18528
    ds_read_b64 v[100:101], v4 offset:18560
    ds_read_b64 v[70:71], v4 offset:18592
    ds_read_b64 v[86:87], v4 offset:18624
    ds_read_b64 v[82:83], v4 offset:18656
    s_waitcnt lgkmcnt(0)
    v_mul_f32 v68, v73, v37
    v_fma_f32 v68, v72, v36, v68
    v_mul_f32 v69, v72, v37
    v_fma_f32 v69, v73, v36, -v69
    v_mul_f32 v76, v93, v39
    v_fma_f32 v76, v92, v38, v76
    v_mul_f32 v77, v92, v39
    v_fma_f32 v77, v93, v38, -v77
    v_mul_f32 v90, v89, v41
    v_fma_f32 v90, v88, v40, v90
    v_mul_f32 v91, v88, v41
    v_fma_f32 v91, v89, v40, -v91
    v_mul_f32 v98, v101, v43
    v_fma_f32 v98, v100, v42, v98
    v_mul_f32 v99, v100, v43
    v_fma_f32 v99, v101, v42, -v99
    v_mul_f32 v80, v71, v45
    v_fma_f32 v80, v70, v44, v80
    v_mul_f32 v81, v70, v45
    v_fma_f32 v81, v71, v44, -v81
    v_mul_f32 v104, v87, v47
    v_fma_f32 v104, v86, v46, v104
    v_mul_f32 v105, v86, v47
    v_fma_f32 v105, v87, v46, -v105
    v_mul_f32 v78, v83, v49
    v_fma_f32 v78, v82, v48, v78
    v_mul_f32 v79, v82, v49
    v_fma_f32 v79, v83, v48, -v79
    v_add_f32 v84, v96, v98
    v_add_f32 v85, v97, v99
    v_sub_f32 v94, v96, v98
    v_sub_f32 v95, v97, v99
    v_add_f32 v74, v68, v80
    v_add_f32 v75, v69, v81
    v_sub_f32 v102, v68, v80
    v_sub_f32 v103, v69, v81
    v_add_f32 v66, v76, v104
    v_add_f32 v67, v77, v105
    v_sub_f32 v72, v76, v104
    v_sub_f32 v73, v77, v105
    v_add_f32 v92, v90, v78
    v_add_f32 v93, v91, v79
    v_sub_f32 v88, v90, v78
    v_sub_f32 v89, v91, v79
    v_sub_f32 v100, v102, v103
    v_add_f32 v101, v102, v103
    v_mul_f32 v100, s16, v100
    v_mul_f32 v101, s16, v101
    v_add_f32 v70, v88, v89
    v_sub_f32 v71, v88, v89
    v_mul_f32 v70, s17, v70
    v_mul_f32 v71, s16, v71
    v_sub_f32 v86, 0, v73
    v_mov_b32 v87, v72
    v_add_f32 v82, v84, v66
    v_add_f32 v83, v85, v67
    v_sub_f32 v96, v84, v66
    v_sub_f32 v97, v85, v67
    v_add_f32 v98, v74, v92
    v_add_f32 v99, v75, v93
    v_sub_f32 v68, v74, v92
    v_sub_f32 v69, v75, v93
    v_add_f32 v80, v82, v98
    v_add_f32 v81, v83, v99
    v_sub_f32 v76, v82, v98
    v_sub_f32 v77, v83, v99
    v_sub_f32 v104, v96, v69
    v_add_f32 v105, v97, v68
    v_add_f32 v90, v96, v69
    v_sub_f32 v91, v97, v68
    v_add_f32 v78, v94, v86
    v_add_f32 v79, v95, v87
    v_sub_f32 v102, v94, v86
    v_sub_f32 v103, v95, v87
    v_add_f32 v88, v100, v70
    v_add_f32 v89, v101, v71
    v_sub_f32 v72, v100, v70
    v_sub_f32 v73, v101, v71
    v_add_f32 v84, v78, v88
    v_add_f32 v85, v79, v89
    v_sub_f32 v74, v78, v88
    v_sub_f32 v75, v79, v89
    v_sub_f32 v66, v102, v73
    v_add_f32 v67, v103, v72
    v_add_f32 v92, v102, v73
    v_sub_f32 v93, v103, v72
    ds_write_b64 v4, v[80:81] offset:0
    ds_write_b64 v4, v[84:85] offset:32
    ds_write_b64 v4, v[104:105] offset:64
    ds_write_b64 v4, v[66:67] offset:96
    ds_write_b64 v4, v[76:77] offset:128
    ds_write_b64 v4, v[74:75] offset:160
    ds_write_b64 v4, v[90:91] offset:192
    ds_write_b64 v4, v[92:93] offset:224
    s_waitcnt lgkmcnt(0)
    s_barrier
    ds_read_b64 v[80:81], v3 offset:0
    ds_read_b64 v[84:85], v3 offset:288
    ds_read_b64 v[104:105], v3 offset:576
    ds_read_b64 v[66:67], v3 offset:864
    ds_read_b64 v[76:77], v3 offset:1152
    ds_read_b64 v[74:75], v3 offset:1440
    ds_read_b64 v[90:91], v3 offset:1728
    ds_read_b64 v[92:93], v3 offset:2016
    s_waitcnt lgkmcnt(0)
    v_mul_f32 v82, v85, v23
    v_fma_f32 v82, v84, v22, v82
    v_mul_f32 v83, v84, v23
    v_fma_f32 v83, v85, v22, -v83
    v_mul_f32 v98, v105, v25
    v_fma_f32 v98, v104, v24, v98
    v_mul_f32 v99, v104, v25
    v_fma_f32 v99, v105, v24, -v99
    v_mul_f32 v96, v67, v27
    v_fma_f32 v96, v66, v26, v96
    v_mul_f32 v97, v66, v27
    v_fma_f32 v97, v67, v26, -v97
    v_mul_f32 v68, v77, v29
    v_fma_f32 v68, v76, v28, v68
    v_mul_f32 v69, v76, v29
    v_fma_f32 v69, v77, v28, -v69
    v_mul_f32 v94, v75, v31
    v_fma_f32 v94, v74, v30, v94
    v_mul_f32 v95, v74, v31
    v_fma_f32 v95, v75, v30, -v95
    v_mul_f32 v100, v91, v33
    v_fma_f32 v100, v90, v32, v100
    v_mul_f32 v101, v90, v33
    v_fma_f32 v101, v91, v32, -v101
    v_mul_f32 v86, v93, v35
    v_fma_f32 v86, v92, v34, v86
    v_mul_f32 v87, v92, v35
    v_fma_f32 v87, v93, v34, -v87
    v_add_f32 v70, v80, v68
    v_add_f32 v71, v81, v69
    v_sub_f32 v78, v80, v68
    v_sub_f32 v79, v81, v69
    v_add_f32 v88, v82, v94
    v_add_f32 v89, v83, v95
    v_sub_f32 v102, v82, v94
    v_sub_f32 v103, v83, v95
    v_add_f32 v72, v98, v100
    v_add_f32 v73, v99, v101
    v_sub_f32 v84, v98, v100
    v_sub_f32 v85, v99, v101
    v_add_f32 v104, v96, v86
    v_add_f32 v105, v97, v87
    v_sub_f32 v66, v96, v86
    v_sub_f32 v67, v97, v87
    v_sub_f32 v76, v102, v103
    v_add_f32 v77, v102, v103
    v_mul_f32 v76, s16, v76
    v_mul_f32 v77, s16, v77
    v_add_f32 v74, v66, v67
    v_sub_f32 v75, v66, v67
    v_mul_f32 v74, s17, v74
    v_mul_f32 v75, s16, v75
    v_sub_f32 v90, 0, v85
    v_mov_b32 v91, v84
    v_add_f32 v92, v70, v72
    v_add_f32 v93, v71, v73
    v_sub_f32 v80, v70, v72
    v_sub_f32 v81, v71, v73
    v_add_f32 v68, v88, v104
    v_add_f32 v69, v89, v105
    v_sub_f32 v82, v88, v104
    v_sub_f32 v83, v89, v105
    v_add_f32 v94, v92, v68
    v_add_f32 v95, v93, v69
    v_sub_f32 v98, v92, v68
    v_sub_f32 v99, v93, v69
    v_sub_f32 v100, v80, v83
    v_add_f32 v101, v81, v82
    v_add_f32 v96, v80, v83
    v_sub_f32 v97, v81, v82
    v_add_f32 v86, v78, v90
    v_add_f32 v87, v79, v91
    v_sub_f32 v102, v78, v90
    v_sub_f32 v103, v79, v91
    v_add_f32 v66, v76, v74
    v_add_f32 v67, v77, v75
    v_sub_f32 v84, v76, v74
    v_sub_f32 v85, v77, v75
    v_add_f32 v70, v86, v66
    v_add_f32 v71, v87, v67
    v_sub_f32 v88, v86, v66
    v_sub_f32 v89, v87, v67
    v_sub_f32 v72, v102, v85
    v_add_f32 v73, v103, v84
    v_add_f32 v104, v102, v85
    v_sub_f32 v105, v103, v84
    ds_write_b64 v2, v[94:95] offset:18432
    ds_write_b64 v2, v[70:71] offset:18688
    ds_write_b64 v2, v[100:101] offset:18944
    ds_write_b64 v2, v[72:73] offset:19200
    ds_write_b64 v2, v[98:99] offset:19456
    ds_write_b64 v2, v[88:89] offset:19712
    ds_write_b64 v2, v[96:97] offset:19968
    ds_write_b64 v2, v[104:105] offset:20224
    s_waitcnt lgkmcnt(0)
    s_barrier
    ds_read_b64 v[94:95], v1 offset:18432
    ds_read_b64 v[70:71], v1 offset:20480
    ds_read_b64 v[100:101], v1 offset:22528
    ds_read_b64 v[72:73], v1 offset:24576
    ds_read_b64 v[98:99], v1 offset:26624
    ds_read_b64 v[88:89], v1 offset:28672
    ds_read_b64 v[96:97], v1 offset:30720
    ds_read_b64 v[104:105], v1 offset:32768
    s_waitcnt lgkmcnt(0)
    v_mul_f32 v92, v71, v9
    v_fma_f32 v92, v70, v8, v92
    v_mul_f32 v93, v70, v9
    v_fma_f32 v93, v71, v8, -v93
    v_mul_f32 v68, v101, v11
    v_fma_f32 v68, v100, v10, v68
    v_mul_f32 v69, v100, v11
    v_fma_f32 v69, v101, v10, -v69
    v_mul_f32 v80, v73, v13
    v_fma_f32 v80, v72, v12, v80
    v_mul_f32 v81, v72, v13
    v_fma_f32 v81, v73, v12, -v81
    v_mul_f32 v82, v99, v15
    v_fma_f32 v82, v98, v14, v82
    v_mul_f32 v83, v98, v15
    v_fma_f32 v83, v99, v14, -v83
    v_mul_f32 v78, v89, v17
    v_fma_f32 v78, v88, v16, v78
    v_mul_f32 v79, v88, v17
    v_fma_f32 v79, v89, v16, -v79
    v_mul_f32 v76, v97, v19
    v_fma_f32 v76, v96, v18, v76
    v_mul_f32 v77, v96, v19
    v_fma_f32 v77, v97, v18, -v77
    v_mul_f32 v90, v105, v21
    v_fma_f32 v90, v104, v20, v90
    v_mul_f32 v91, v104, v21
    v_fma_f32 v91, v105, v20, -v91
    v_add_f32 v74, v94, v82
    v_add_f32 v75, v95, v83
    v_sub_f32 v86, v94, v82
    v_sub_f32 v87, v95, v83
    v_add_f32 v66, v92, v78
    v_add_f32 v67, v93, v79
    v_sub_f32 v102, v92, v78
    v_sub_f32 v103, v93, v79
    v_add_f32 v84, v68, v76
    v_add_f32 v85, v69, v77
    v_sub_f32 v70, v68, v76
    v_sub_f32 v71, v69, v77
    v_add_f32 v100, v80, v90
    v_add_f32 v101, v81, v91
    v_sub_f32 v72, v80, v90
    v_sub_f32 v73, v81, v91
    v_sub_f32 v98, v102, v103
    v_add_f32 v99, v102, v103
    v_mul_f32 v98, s16, v98
    v_mul_f32 v99, s16, v99
    v_add_f32 v88, v72, v73
    v_sub_f32 v89, v72, v73
    v_mul_f32 v88, s17, v88
    v_mul_f32 v89, s16, v89
    v_sub_f32 v96, 0, v71
    v_mov_b32 v97, v70
    v_add_f32 v104, v74, v84
    v_add_f32 v105, v75, v85
    v_sub_f32 v94, v74, v84
    v_sub_f32 v95, v75, v85
    v_add_f32 v82, v66, v100
    v_add_f32 v83, v67, v101
    v_sub_f32 v92, v66, v100
    v_sub_f32 v93, v67, v101
    v_add_f32 v78, v104, v82
    v_add_f32 v79, v105, v83
    v_sub_f32 v68, v104, v82
    v_sub_f32 v69, v105, v83
    v_sub_f32 v76, v94, v93
    v_add_f32 v77, v95, v92
    v_add_f32 v80, v94, v93
    v_sub_f32 v81, v95, v92
    v_add_f32 v90, v86, v96
    v_add_f32 v91, v87, v97
    v_sub_f32 v102, v86, v96
    v_sub_f32 v103, v87, v97
    v_add_f32 v72, v98, v88
    v_add_f32 v73, v99, v89
    v_sub_f32 v70, v98, v88
    v_sub_f32 v71, v99, v89
    v_add_f32 v74, v90, v72
    v_add_f32 v75, v91, v73
    v_sub_f32 v66, v90, v72
    v_sub_f32 v67, v91, v73
    v_sub_f32 v84, v102, v71
    v_add_f32 v85, v103, v70
    v_add_f32 v100, v102, v71
    v_sub_f32 v101, v103, v70
    buffer_store_dwordx2 v[78:79], v1, s[8:11], 0 offen offset:0
    buffer_store_dwordx2 v[74:75], v1, s[8:11], 0 offen offset:2048
    buffer_store_dwordx2 v[76:77], v1, s[8:11], s18 offen offset:0
    buffer_store_dwordx2 v[84:85], v1, s[8:11], s18 offen offset:2048
    buffer_store_dwordx2 v[68:69], v1, s[8:11], s19 offen offset:0
    buffer_store_dwordx2 v[66:67], v1, s[8:11], s19 offen offset:2048
    buffer_store_dwordx2 v[80:81], v1, s[8:11], s20 offen offset:0
    buffer_store_dwordx2 v[100:101], v1, s[8:11], s20 offen offset:2048
.Lk2a_kernel_end:
    s_endpgm
.globl k3a_kernel
.p2align 8
.type k3a_kernel,@function
k3a_kernel:
    s_cmp_ge_u32 s2, 256
    s_cbranch_scc1 .Lk3a_kernel_end
    s_load_dwordx2 s[4:5], s[0:1], 72
    s_load_dwordx2 s[6:7], s[0:1], 0
    s_mov_b32 s40, 0x3f3504f3
    s_mov_b32 s41, 0xbf3504f3
    s_mov_b32 s42, 0x3e9e377a
    s_mov_b32 s43, 0xbf4f1bbd
    s_mov_b32 s44, 0x3f737871
    s_mov_b32 s45, 0x3f167918
    s_mov_b32 s46, 0x3f4f1bbd
    s_mov_b32 s47, 0x3f167918
    s_mov_b32 s48, 0x3e9e377a
    s_mov_b32 s49, 0x3f737871
    s_mov_b32 s50, 0xbe9e377a
    s_mov_b32 s51, 0x3f737871
    s_mov_b32 s52, 0xbf4f1bbd
    s_mov_b32 s53, 0x3f167918
    s_waitcnt lgkmcnt(0)
    s_mov_b32 s8, s6
    s_mov_b32 s9, s7
    s_mov_b32 s10, 2621440
    s_mov_b32 s11, 0x00020000
    s_mov_b32 s12, s4
    s_mov_b32 s13, s5
    s_mov_b32 s14, 5259264
    s_mov_b32 s15, 0x00020000
    s_mov_b32 s3, 12582912
    s_add_u32 s24, s4, s3
    s_addc_u32 s25, s5, 0
    s_mov_b32 s26, 2621440
    s_mov_b32 s27, 0x00020000
    s_mov_b32 s3, 15728640
    s_add_u32 s28, s4, s3
    s_addc_u32 s29, s5, 0
    s_mov_b32 s30, 2621440
    s_mov_b32 s31, 0x00020000
    v_and_b32 v1, 63, v0
    v_lshrrev_b32 v2, 6, v0
    s_nop 1
    v_readfirstlane_b32 s20, v2
    v_and_b32 v4, 3, v0
    v_lshrrev_b32 v5, 2, v0
    v_mul_u32_u24 v6, 5184, v4
    s_lshl_b32 s21, s2, 6
    v_lshlrev_b32 v7, 4, v4
    v_add_u32 v7, s21, v7
    v_lshl_add_u32 v14, v5, 14, v7
    buffer_load_dwordx4 v[16:19], v14, s[12:15], 0 offen
    v_lshl_add_u32 v8, v5, 3, v6
    v_sub_u32 v9, 640, v5
    v_cmp_eq_u32 vcc, 0, v5
    s_nop 1
    v_cndmask_b32 v9, v9, 0, vcc
    v_lshl_add_u32 v9, v9, 3, v6
    s_waitcnt vmcnt(0)
    v_cmp_eq_u32 vcc, 0, v5
    s_nop 1
    v_cndmask_b32 v17, v17, 0, vcc
    v_cndmask_b32 v19, v19, 0, vcc
    v_sub_f32 v10, v16, v19
    v_add_f32 v11, v17, v18
    v_add_f32 v12, v16, v19
    v_sub_f32 v13, v18, v17
    ds_write_b64 v8, v[10:11] offset:23040
    ds_write_b64 v9, v[12:13] offset:23040
    v_add_u32 v5, 80, v5
    v_lshl_add_u32 v14, v5, 14, v7
    buffer_load_dwordx4 v[16:19], v14, s[12:15], 0 offen
    v_lshl_add_u32 v8, v5, 3, v6
    v_sub_u32 v9, 640, v5
    v_cmp_eq_u32 vcc, 0, v5
    s_nop 1
    v_cndmask_b32 v9, v9, 0, vcc
    v_lshl_add_u32 v9, v9, 3, v6
    s_waitcnt vmcnt(0)
    v_sub_f32 v10, v16, v19
    v_add_f32 v11, v17, v18
    v_add_f32 v12, v16, v19
    v_sub_f32 v13, v18, v17
    ds_write_b64 v8, v[10:11] offset:23040
    ds_write_b64 v9, v[12:13] offset:23040
    v_add_u32 v5, 80, v5
    v_lshl_add_u32 v14, v5, 14, v7
    buffer_load_dwordx4 v[16:19], v14, s[12:15], 0 offen
    v_lshl_add_u32 v8, v5, 3, v6
    v_sub_u32 v9, 640, v5
    v_cmp_eq_u32 vcc, 0, v5
    s_nop 1
    v_cndmask_b32 v9, v9, 0, vcc
    v_lshl_add_u32 v9, v9, 3, v6
    s_waitcnt vmcnt(0)
    v_sub_f32 v10, v16, v19
    v_add_f32 v11, v17, v18
    v_add_f32 v12, v16, v19
    v_sub_f32 v13, v18, v17
    ds_write_b64 v8, v[10:11] offset:23040
    ds_write_b64 v9, v[12:13] offset:23040
    v_add_u32 v5, 80, v5
    v_lshl_add_u32 v14, v5, 14, v7
    buffer_load_dwordx4 v[16:19], v14, s[12:15], 0 offen
    v_lshl_add_u32 v8, v5, 3, v6
    v_sub_u32 v9, 640, v5
    v_cmp_eq_u32 vcc, 0, v5
    s_nop 1
    v_cndmask_b32 v9, v9, 0, vcc
    v_lshl_add_u32 v9, v9, 3, v6
    s_waitcnt vmcnt(0)
    v_sub_f32 v10, v16, v19
    v_add_f32 v11, v17, v18
    v_add_f32 v12, v16, v19
    v_sub_f32 v13, v18, v17
    ds_write_b64 v8, v[10:11] offset:23040
    ds_write_b64 v9, v[12:13] offset:23040
    v_add_u32 v5, 80, v5
    v_cmp_ge_u32 vcc, 320, v5
    s_and_saveexec_b64 s[22:23], vcc
    v_lshl_add_u32 v14, v5, 14, v7
    buffer_load_dwordx4 v[16:19], v14, s[12:15], 0 offen
    v_lshl_add_u32 v8, v5, 3, v6
    v_sub_u32 v9, 640, v5
    v_cmp_eq_u32 vcc, 0, v5
    s_nop 1
    v_cndmask_b32 v9, v9, 0, vcc
    v_lshl_add_u32 v9, v9, 3, v6
    s_waitcnt vmcnt(0)
    v_cmp_eq_u32 vcc, 320, v5
    s_nop 1
    v_cndmask_b32 v17, v17, 0, vcc
    v_cndmask_b32 v19, v19, 0, vcc
    v_sub_f32 v10, v16, v19
    v_add_f32 v11, v17, v18
    v_add_f32 v12, v16, v19
    v_sub_f32 v13, v18, v17
    ds_write_b64 v8, v[10:11] offset:23040
    ds_write_b64 v9, v[12:13] offset:23040
    s_mov_b64 exec, s[22:23]
    s_waitcnt lgkmcnt(0)
    s_barrier
    v_lshrrev_b32 v4, 3, v0
    v_and_b32 v5, 7, v0
    v_cvt_f32_u32 v40, v5
    v_mul_f32 v20, 0xbc800000, v40
    v_fract_f32 v20, v20
    v_sin_f32 v21, v20
    v_cos_f32 v20, v20
    v_mul_f32 v22, 0xbd000000, v40
    v_fract_f32 v22, v22
    v_sin_f32 v23, v22
    v_cos_f32 v22, v22
    v_mul_f32 v24, 0xbd400000, v40
    v_fract_f32 v24, v24
    v_sin_f32 v25, v24
    v_cos_f32 v24, v24
    v_mul_f32 v26, 0xbd800000, v40
    v_fract_f32 v26, v26
    v_sin_f32 v27, v26
    v_cos_f32 v26, v26
    v_mul_f32 v28, 0xbda00000, v40
    v_fract_f32 v28, v28
    v_sin_f32 v29, v28
    v_cos_f32 v28, v28
    v_mul_f32 v30, 0xbdc00000, v40
    v_fract_f32 v30, v30
    v_sin_f32 v31, v30
    v_cos_f32 v30, v30
    v_mul_f32 v32, 0xbde00000, v40
    v_fract_f32 v32, v32
    v_sin_f32 v33, v32
    v_cos_f32 v32, v32
    s_nop 0
    v_mul_u32_u24 v6, 205, v4
    v_lshrrev_b32 v6, 11, v6
    v_mul_u32_u24 v7, 10, v6
    v_sub_u32 v7, v4, v7
    v_mul_u32_u24 v3, 10, v5
    v_add_u32 v8, v7, v3
    v_mul_u32_u24 v3, 648, v6
    v_add_u32 v3, v3, v8
    v_lshlrev_b32 v3, 3, v3
    ds_read_b64 v[64:65], v3 offset:23040
    ds_read_b64 v[66:67], v3 offset:23680
    ds_read_b64 v[68:69], v3 offset:24320
    ds_read_b64 v[70:71], v3 offset:24960
    ds_read_b64 v[72:73], v3 offset:25600
    ds_read_b64 v[74:75], v3 offset:26240
    ds_read_b64 v[76:77], v3 offset:26880
    ds_read_b64 v[78:79], v3 offset:27520
    s_waitcnt lgkmcnt(0)
    v_add_f32 v80, v64, v72
    v_add_f32 v81, v65, v73
    v_sub_f32 v82, v64, v72
    v_sub_f32 v83, v65, v73
    v_add_f32 v84, v66, v74
    v_add_f32 v85, v67, v75
    v_sub_f32 v86, v66, v74
    v_sub_f32 v87, v67, v75
    v_add_f32 v88, v68, v76
    v_add_f32 v89, v69, v77
    v_sub_f32 v90, v68, v76
    v_sub_f32 v91, v69, v77
    v_add_f32 v92, v70, v78
    v_add_f32 v93, v71, v79
    v_sub_f32 v94, v70, v78
    v_sub_f32 v95, v71, v79
    v_sub_f32 v96, v86, v87
    v_add_f32 v97, v86, v87
    v_mul_f32 v96, s40, v96
    v_mul_f32 v97, s40, v97
    v_add_f32 v98, v94, v95
    v_sub_f32 v99, v94, v95
    v_mul_f32 v98, s41, v98
    v_mul_f32 v99, s40, v99
    v_sub_f32 v100, 0, v91
    v_mov_b32 v101, v90
    v_add_f32 v102, v80, v88
    v_add_f32 v103, v81, v89
    v_sub_f32 v104, v80, v88
    v_sub_f32 v105, v81, v89
    v_add_f32 v106, v84, v92
    v_add_f32 v107, v85, v93
    v_sub_f32 v108, v84, v92
    v_sub_f32 v109, v85, v93
    v_add_f32 v110, v102, v106
    v_add_f32 v111, v103, v107
    v_sub_f32 v64, v102, v106
    v_sub_f32 v65, v103, v107
    v_sub_f32 v72, v104, v109
    v_add_f32 v73, v105, v108
    v_add_f32 v66, v104, v109
    v_sub_f32 v67, v105, v108
    v_add_f32 v74, v82, v100
    v_add_f32 v75, v83, v101
    v_sub_f32 v68, v82, v100
    v_sub_f32 v69, v83, v101
    v_add_f32 v76, v96, v98
    v_add_f32 v77, v97, v99
    v_sub_f32 v70, v96, v98
    v_sub_f32 v71, v97, v99
    v_add_f32 v78, v74, v76
    v_add_f32 v79, v75, v77
    v_sub_f32 v86, v74, v76
    v_sub_f32 v87, v75, v77
    v_sub_f32 v94, v68, v71
    v_add_f32 v95, v69, v70
    v_add_f32 v90, v68, v71
    v_sub_f32 v91, v69, v70
    v_mul_f32 v80, v79, v21
    v_fma_f32 v80, v78, v20, v80
    v_mul_f32 v81, v78, v21
    v_fma_f32 v81, v79, v20, -v81
    v_mul_f32 v84, v73, v23
    v_fma_f32 v84, v72, v22, v84
    v_mul_f32 v85, v72, v23
    v_fma_f32 v85, v73, v22, -v85
    v_mul_f32 v88, v95, v25
    v_fma_f32 v88, v94, v24, v88
    v_mul_f32 v89, v94, v25
    v_fma_f32 v89, v95, v24, -v89
    v_mul_f32 v92, v65, v27
    v_fma_f32 v92, v64, v26, v92
    v_mul_f32 v93, v64, v27
    v_fma_f32 v93, v65, v26, -v93
    v_mul_f32 v102, v87, v29
    v_fma_f32 v102, v86, v28, v102
    v_mul_f32 v103, v86, v29
    v_fma_f32 v103, v87, v28, -v103
    v_mul_f32 v106, v67, v31
    v_fma_f32 v106, v66, v30, v106
    v_mul_f32 v107, v66, v31
    v_fma_f32 v107, v67, v30, -v107
    v_mul_f32 v104, v91, v33
    v_fma_f32 v104, v90, v32, v104
    v_mul_f32 v105, v90, v33
    v_fma_f32 v105, v91, v32, -v105
    v_mul_u32_u24 v3, 72, v0
    ds_write_b64 v3, v[110:111] offset:0
    ds_write_b64 v3, v[80:81] offset:8
    ds_write_b64 v3, v[84:85] offset:16
    ds_write_b64 v3, v[88:89] offset:24
    ds_write_b64 v3, v[92:93] offset:32
    ds_write_b64 v3, v[102:103] offset:40
    ds_write_b64 v3, v[106:107] offset:48
    ds_write_b64 v3, v[104:105] offset:56
    s_waitcnt lgkmcnt(0)
    s_barrier
    v_cvt_f32_u32 v40, v7
    v_cvt_f32_u32 v41, v5
    v_add_f32 v20, 0x00000000, v41
    v_mul_f32 v20, v20, v40
    v_mul_f32 v20, 0xbacccccd, v20
    v_fract_f32 v20, v20
    v_sin_f32 v21, v20
    v_cos_f32 v20, v20
    v_add_f32 v22, 0x41000000, v41
    v_mul_f32 v22, v22, v40
    v_mul_f32 v22, 0xbacccccd, v22
    v_fract_f32 v22, v22
    v_sin_f32 v23, v22
    v_cos_f32 v22, v22
    v_add_f32 v24, 0x41800000, v41
    v_mul_f32 v24, v24, v40
    v_mul_f32 v24, 0xbacccccd, v24
    v_fract_f32 v24, v24
    v_sin_f32 v25, v24
    v_cos_f32 v24, v24
    v_add_f32 v26, 0x41c00000, v41
    v_mul_f32 v26, v26, v40
    v_mul_f32 v26, 0xbacccccd, v26
    v_fract_f32 v26, v26
    v_sin_f32 v27, v26
    v_cos_f32 v26, v26
    v_add_f32 v28, 0x42000000, v41
    v_mul_f32 v28, v28, v40
    v_mul_f32 v28, 0xbacccccd, v28
    v_fract_f32 v28, v28
    v_sin_f32 v29, v28
    v_cos_f32 v28, v28
    v_add_f32 v30, 0x42200000, v41
    v_mul_f32 v30, v30, v40
    v_mul_f32 v30, 0xbacccccd, v30
    v_fract_f32 v30, v30
    v_sin_f32 v31, v30
    v_cos_f32 v30, v30
    v_add_f32 v32, 0x42400000, v41
    v_mul_f32 v32, v32, v40
    v_mul_f32 v32, 0xbacccccd, v32
    v_fract_f32 v32, v32
    v_sin_f32 v33, v32
    v_cos_f32 v32, v32
    v_add_f32 v34, 0x42600000, v41
    v_mul_f32 v34, v34, v40
    v_mul_f32 v34, 0xbacccccd, v34
    v_fract_f32 v34, v34
    v_sin_f32 v35, v34
    v_cos_f32 v34, v34
    s_nop 0
    v_mul_u32_u24 v3, 576, v4
    v_lshl_add_u32 v3, v5, 3, v3
    ds_read_b64 v[108:109], v3 offset:0
    ds_read_b64 v[82:83], v3 offset:72
    ds_read_b64 v[96:97], v3 offset:144
    ds_read_b64 v[100:101], v3 offset:216
    ds_read_b64 v[98:99], v3 offset:288
    ds_read_b64 v[74:75], v3 offset:360
    ds_read_b64 v[76:77], v3 offset:432
    ds_read_b64 v[68:69], v3 offset:504
    s_waitcnt lgkmcnt(0)
    v_add_f32 v70, v108, v98
    v_add_f32 v71, v109, v99
    v_sub_f32 v78, v108, v98
    v_sub_f32 v79, v109, v99
    v_add_f32 v72, v82, v74
    v_add_f32 v73, v83, v75
    v_sub_f32 v94, v82, v74
    v_sub_f32 v95, v83, v75
    v_add_f32 v64, v96, v76
    v_add_f32 v65, v97, v77
    v_sub_f32 v86, v96, v76
    v_sub_f32 v87, v97, v77
    v_add_f32 v66, v100, v68
    v_add_f32 v67, v101, v69
    v_sub_f32 v90, v100, v68
    v_sub_f32 v91, v101, v69
    v_sub_f32 v110, v94, v95
    v_add_f32 v111, v94, v95
    v_mul_f32 v110, s40, v110
    v_mul_f32 v111, s40, v111
    v_add_f32 v80, v90, v91
    v_sub_f32 v81, v90, v91
    v_mul_f32 v80, s41, v80
    v_mul_f32 v81, s40, v81
    v_sub_f32 v84, 0, v87
    v_mov_b32 v85, v86
    v_add_f32 v88, v70, v64
    v_add_f32 v89, v71, v65
    v_sub_f32 v92, v70, v64
    v_sub_f32 v93, v71, v65
    v_add_f32 v102, v72, v66
    v_add_f32 v103, v73, v67
    v_sub_f32 v106, v72, v66
    v_sub_f32 v107, v73, v67
    v_add_f32 v104, v88, v102
    v_add_f32 v105, v89, v103
    v_sub_f32 v108, v88, v102
    v_sub_f32 v109, v89, v103
    v_sub_f32 v98, v92, v107
    v_add_f32 v99, v93, v106
    v_add_f32 v82, v92, v107
    v_sub_f32 v83, v93, v106
    v_add_f32 v74, v78, v84
    v_add_f32 v75, v79, v85
    v_sub_f32 v96, v78, v84
    v_sub_f32 v97, v79, v85
    v_add_f32 v76, v110, v80
    v_add_f32 v77, v111, v81
    v_sub_f32 v100, v110, v80
    v_sub_f32 v101, v111, v81
    v_add_f32 v68, v74, v76
    v_add_f32 v69, v75, v77
    v_sub_f32 v94, v74, v76
    v_sub_f32 v95, v75, v77
    v_sub_f32 v90, v96, v101
    v_add_f32 v91, v97, v100
    v_add_f32 v86, v96, v101
    v_sub_f32 v87, v97, v100
    v_mul_f32 v70, v105, v21
    v_fma_f32 v70, v104, v20, v70
    v_mul_f32 v71, v104, v21
    v_fma_f32 v71, v105, v20, -v71
    v_mul_f32 v72, v69, v23
    v_fma_f32 v72, v68, v22, v72
    v_mul_f32 v73, v68, v23
    v_fma_f32 v73, v69, v22, -v73
    v_mul_f32 v64, v99, v25
    v_fma_f32 v64, v98, v24, v64
    v_mul_f32 v65, v98, v25
    v_fma_f32 v65, v99, v24, -v65
    v_mul_f32 v66, v91, v27
    v_fma_f32 v66, v90, v26, v66
    v_mul_f32 v67, v90, v27
    v_fma_f32 v67, v91, v26, -v67
    v_mul_f32 v88, v109, v29
    v_fma_f32 v88, v108, v28, v88
    v_mul_f32 v89, v108, v29
    v_fma_f32 v89, v109, v28, -v89
    v_mul_f32 v102, v95, v31
    v_fma_f32 v102, v94, v30, v102
    v_mul_f32 v103, v94, v31
    v_fma_f32 v103, v95, v30, -v103
    v_mul_f32 v92, v83, v33
    v_fma_f32 v92, v82, v32, v92
    v_mul_f32 v93, v82, v33
    v_fma_f32 v93, v83, v32, -v93
    v_mul_f32 v106, v87, v35
    v_fma_f32 v106, v86, v34, v106
    v_mul_f32 v107, v86, v35
    v_fma_f32 v107, v87, v34, -v107
    ds_write_b64 v3, v[70:71] offset:23040
    ds_write_b64 v3, v[72:73] offset:23104
    ds_write_b64 v3, v[64:65] offset:23168
    ds_write_b64 v3, v[66:67] offset:23232
    ds_write_b64 v3, v[88:89] offset:23296
    ds_write_b64 v3, v[102:103] offset:23360
    ds_write_b64 v3, v[92:93] offset:23424
    ds_write_b64 v3, v[106:107] offset:23488
    s_waitcnt lgkmcnt(0)
    s_barrier
    s_cmp_ge_u32 s20, 4
    s_cbranch_scc1 .Lk3a_kernel_end
    s_mul_i32 s21, s20, 5760
    v_lshlrev_b32 v3, 3, v1
    v_add_u32 v3, s21, v3
    ds_read_b64 v[78:79], v3 offset:23040
    ds_read_b64 v[110:111], v3 offset:23616
    ds_read_b64 v[84:85], v3 offset:24192
    ds_read_b64 v[80:81], v3 offset:24768
    ds_read_b64 v[74:75], v3 offset:25344
    ds_read_b64 v[76:77], v3 offset:25920
    ds_read_b64 v[96:97], v3 offset:26496
    ds_read_b64 v[100:101], v3 offset:27072
    ds_read_b64 v[104:105], v3 offset:27648
    ds_read_b64 v[68:69], v3 offset:28224
    s_lshl_b32 s21, s2, 3
    s_lshl_b32 s22, s20, 1
    s_add_u32 s21, s21, s22
    s_mul_i32 s21, s21, 1280
    v_lshlrev_b32 v2, 2, v1
    buffer_load_dword v4, v2, s[8:11], s21 offen offset:0
    buffer_load_dword v5, v2, s[8:11], s21 offen offset:256
    buffer_load_dword v6, v2, s[8:11], s21 offen offset:512
    buffer_load_dword v7, v2, s[8:11], s21 offen offset:768
    buffer_load_dword v8, v2, s[8:11], s21 offen offset:1024
    buffer_load_dword v9, v2, s[8:11], s21 offen offset:1280
    buffer_load_dword v10, v2, s[8:11], s21 offen offset:1536
    buffer_load_dword v11, v2, s[8:11], s21 offen offset:1792
    buffer_load_dword v12, v2, s[8:11], s21 offen offset:2048
    buffer_load_dword v13, v2, s[8:11], s21 offen offset:2304
    s_waitcnt lgkmcnt(0)
    v_add_f32 v98, v78, v76
    v_add_f32 v99, v79, v77
    v_sub_f32 v90, v78, v76
    v_sub_f32 v91, v79, v77
    v_add_f32 v108, v110, v96
    v_add_f32 v109, v111, v97
    v_sub_f32 v94, v110, v96
    v_sub_f32 v95, v111, v97
    v_add_f32 v82, v84, v100
    v_add_f32 v83, v85, v101
    v_sub_f32 v86, v84, v100
    v_sub_f32 v87, v85, v101
    v_add_f32 v70, v80, v104
    v_add_f32 v71, v81, v105
    v_sub_f32 v72, v80, v104
    v_sub_f32 v73, v81, v105
    v_add_f32 v64, v74, v68
    v_add_f32 v65, v75, v69
    v_sub_f32 v66, v74, v68
    v_sub_f32 v67, v75, v69
    v_mul_f32 v88, s47, v95
    v_fma_f32 v88, s46, v94, -v88
    v_mul_f32 v89, s47, v94
    v_fma_f32 v89, s46, v95, v89
    v_mul_f32 v102, s49, v87
    v_fma_f32 v102, s48, v86, -v102
    v_mul_f32 v103, s49, v86
    v_fma_f32 v103, s48, v87, v103
    v_mul_f32 v92, s51, v73
    v_fma_f32 v92, s50, v72, -v92
    v_mul_f32 v93, s51, v72
    v_fma_f32 v93, s50, v73, v93
    v_mul_f32 v106, s53, v67
    v_fma_f32 v106, s52, v66, -v106
    v_mul_f32 v107, s53, v66
    v_fma_f32 v107, s52, v67, v107
    v_add_f32 v78, v108, v64
    v_add_f32 v79, v109, v65
    v_add_f32 v76, v82, v70
    v_add_f32 v77, v83, v71
    v_sub_f32 v110, v108, v64
    v_sub_f32 v111, v109, v65
    v_sub_f32 v96, v82, v70
    v_sub_f32 v97, v83, v71
    v_add_f32 v84, v98, v78
    v_add_f32 v84, v84, v76
    v_fma_f32 v100, s42, v78, v98
    v_fma_f32 v100, s43, v76, v100
    v_fma_f32 v80, s43, v78, v98
    v_fma_f32 v80, s42, v76, v80
    v_add_f32 v85, v99, v79
    v_add_f32 v85, v85, v77
    v_fma_f32 v101, s42, v79, v99
    v_fma_f32 v101, s43, v77, v101
    v_fma_f32 v81, s43, v79, v99
    v_fma_f32 v81, s42, v77, v81
    v_mul_f32 v104, s44, v110
    v_fma_f32 v104, s45, v96, v104
    v_mul_f32 v74, s45, v110
    v_fma_f32 v74, -s44, v96, v74
    v_mul_f32 v105, s44, v111
    v_fma_f32 v105, s45, v97, v105
    v_mul_f32 v75, s45, v111
    v_fma_f32 v75, -s44, v97, v75
    v_add_f32 v68, v100, v105
    v_sub_f32 v69, v101, v104
    v_sub_f32 v94, v100, v105
    v_add_f32 v95, v101, v104
    v_add_f32 v86, v80, v75
    v_sub_f32 v87, v81, v74
    v_sub_f32 v72, v80, v75
    v_add_f32 v73, v81, v74
    v_add_f32 v66, v88, v106
    v_add_f32 v67, v89, v107
    v_add_f32 v108, v102, v92
    v_add_f32 v109, v103, v93
    v_sub_f32 v82, v88, v106
    v_sub_f32 v83, v89, v107
    v_sub_f32 v70, v102, v92
    v_sub_f32 v71, v103, v93
    v_add_f32 v64, v90, v66
    v_add_f32 v64, v64, v108
    v_fma_f32 v98, s42, v66, v90
    v_fma_f32 v98, s43, v108, v98
    v_fma_f32 v78, s43, v66, v90
    v_fma_f32 v78, s42, v108, v78
    v_add_f32 v65, v91, v67
    v_add_f32 v65, v65, v109
    v_fma_f32 v99, s42, v67, v91
    v_fma_f32 v99, s43, v109, v99
    v_fma_f32 v79, s43, v67, v91
    v_fma_f32 v79, s42, v109, v79
    v_mul_f32 v76, s44, v82
    v_fma_f32 v76, s45, v70, v76
    v_mul_f32 v110, s45, v82
    v_fma_f32 v110, -s44, v70, v110
    v_mul_f32 v77, s44, v83
    v_fma_f32 v77, s45, v71, v77
    v_mul_f32 v111, s45, v83
    v_fma_f32 v111, -s44, v71, v111
    v_add_f32 v96, v98, v77
    v_sub_f32 v97, v99, v76
    v_sub_f32 v100, v98, v77
    v_add_f32 v101, v99, v76
    v_add_f32 v104, v78, v111
    v_sub_f32 v105, v79, v110
    v_sub_f32 v80, v78, v111
    v_add_f32 v81, v79, v110
    s_mul_i32 s22, s20, 5120
    v_lshlrev_b32 v3, 3, v1
    v_add_u32 v3, s22, v3
    ds_write_b64 v3, v[84:85] offset:0
    ds_write_b64 v3, v[64:65] offset:512
    ds_write_b64 v3, v[94:95] offset:1024
    ds_write_b64 v3, v[100:101] offset:1536
    ds_write_b64 v3, v[72:73] offset:2048
    ds_write_b64 v3, v[80:81] offset:2560
    ds_write_b64 v3, v[86:87] offset:3072
    ds_write_b64 v3, v[104:105] offset:3584
    ds_write_b64 v3, v[68:69] offset:4096
    ds_write_b64 v3, v[96:97] offset:4608
    v_lshlrev_b32 v3, 4, v1
    v_add_u32 v3, s22, v3
    s_waitcnt lgkmcnt(0)
    ds_read_b128 v[44:47], v3 offset:0
    ds_read_b128 v[48:51], v3 offset:1024
    ds_read_b128 v[52:55], v3 offset:2048
    ds_read_b128 v[56:59], v3 offset:3072
    ds_read_b128 v[60:63], v3 offset:4096
    s_waitcnt vmcnt(0) lgkmcnt(0)
    v_cvt_pk_bf16_f32 v44, v44, v44
    v_lshlrev_b32 v44, 16, v44
    v_lshlrev_b32 v20, 16, v4
    v_add_f32 v20, v20, v44
    v_cvt_pk_bf16_f32 v46, v46, v46
    v_lshlrev_b32 v46, 16, v46
    v_and_b32 v21, 0xffff0000, v4
    v_add_f32 v21, v21, v46
    v_cvt_pk_bf16_f32 v4, v20, v21
    buffer_store_dword v4, v2, s[24:27], s21 offen offset:0
    v_lshlrev_b32 v20, 16, v4
    v_and_b32 v21, 0xffff0000, v4
    v_cvt_pk_bf16_f32 v48, v48, v48
    v_lshlrev_b32 v48, 16, v48
    v_lshlrev_b32 v22, 16, v5
    v_add_f32 v22, v22, v48
    v_cvt_pk_bf16_f32 v50, v50, v50
    v_lshlrev_b32 v50, 16, v50
    v_and_b32 v23, 0xffff0000, v5
    v_add_f32 v23, v23, v50
    v_cvt_pk_bf16_f32 v5, v22, v23
    buffer_store_dword v5, v2, s[24:27], s21 offen offset:256
    v_lshlrev_b32 v22, 16, v5
    v_and_b32 v23, 0xffff0000, v5
    v_cvt_pk_bf16_f32 v52, v52, v52
    v_lshlrev_b32 v52, 16, v52
    v_lshlrev_b32 v24, 16, v6
    v_add_f32 v24, v24, v52
    v_cvt_pk_bf16_f32 v54, v54, v54
    v_lshlrev_b32 v54, 16, v54
    v_and_b32 v25, 0xffff0000, v6
    v_add_f32 v25, v25, v54
    v_cvt_pk_bf16_f32 v6, v24, v25
    buffer_store_dword v6, v2, s[24:27], s21 offen offset:512
    v_lshlrev_b32 v24, 16, v6
    v_and_b32 v25, 0xffff0000, v6
    v_cvt_pk_bf16_f32 v56, v56, v56
    v_lshlrev_b32 v56, 16, v56
    v_lshlrev_b32 v26, 16, v7
    v_add_f32 v26, v26, v56
    v_cvt_pk_bf16_f32 v58, v58, v58
    v_lshlrev_b32 v58, 16, v58
    v_and_b32 v27, 0xffff0000, v7
    v_add_f32 v27, v27, v58
    v_cvt_pk_bf16_f32 v7, v26, v27
    buffer_store_dword v7, v2, s[24:27], s21 offen offset:768
    v_lshlrev_b32 v26, 16, v7
    v_and_b32 v27, 0xffff0000, v7
    v_cvt_pk_bf16_f32 v60, v60, v60
    v_lshlrev_b32 v60, 16, v60
    v_lshlrev_b32 v28, 16, v8
    v_add_f32 v28, v28, v60
    v_cvt_pk_bf16_f32 v62, v62, v62
    v_lshlrev_b32 v62, 16, v62
    v_and_b32 v29, 0xffff0000, v8
    v_add_f32 v29, v29, v62
    v_cvt_pk_bf16_f32 v8, v28, v29
    buffer_store_dword v8, v2, s[24:27], s21 offen offset:1024
    v_lshlrev_b32 v28, 16, v8
    v_and_b32 v29, 0xffff0000, v8
    v_cvt_pk_bf16_f32 v45, v45, v45
    v_lshlrev_b32 v45, 16, v45
    v_lshlrev_b32 v30, 16, v9
    v_add_f32 v30, v30, v45
    v_cvt_pk_bf16_f32 v47, v47, v47
    v_lshlrev_b32 v47, 16, v47
    v_and_b32 v31, 0xffff0000, v9
    v_add_f32 v31, v31, v47
    v_cvt_pk_bf16_f32 v9, v30, v31
    buffer_store_dword v9, v2, s[24:27], s21 offen offset:1280
    v_lshlrev_b32 v30, 16, v9
    v_and_b32 v31, 0xffff0000, v9
    v_cvt_pk_bf16_f32 v49, v49, v49
    v_lshlrev_b32 v49, 16, v49
    v_lshlrev_b32 v32, 16, v10
    v_add_f32 v32, v32, v49
    v_cvt_pk_bf16_f32 v51, v51, v51
    v_lshlrev_b32 v51, 16, v51
    v_and_b32 v33, 0xffff0000, v10
    v_add_f32 v33, v33, v51
    v_cvt_pk_bf16_f32 v10, v32, v33
    buffer_store_dword v10, v2, s[24:27], s21 offen offset:1536
    v_lshlrev_b32 v32, 16, v10
    v_and_b32 v33, 0xffff0000, v10
    v_cvt_pk_bf16_f32 v53, v53, v53
    v_lshlrev_b32 v53, 16, v53
    v_lshlrev_b32 v34, 16, v11
    v_add_f32 v34, v34, v53
    v_cvt_pk_bf16_f32 v55, v55, v55
    v_lshlrev_b32 v55, 16, v55
    v_and_b32 v35, 0xffff0000, v11
    v_add_f32 v35, v35, v55
    v_cvt_pk_bf16_f32 v11, v34, v35
    buffer_store_dword v11, v2, s[24:27], s21 offen offset:1792
    v_lshlrev_b32 v34, 16, v11
    v_and_b32 v35, 0xffff0000, v11
    v_cvt_pk_bf16_f32 v57, v57, v57
    v_lshlrev_b32 v57, 16, v57
    v_lshlrev_b32 v36, 16, v12
    v_add_f32 v36, v36, v57
    v_cvt_pk_bf16_f32 v59, v59, v59
    v_lshlrev_b32 v59, 16, v59
    v_and_b32 v37, 0xffff0000, v12
    v_add_f32 v37, v37, v59
    v_cvt_pk_bf16_f32 v12, v36, v37
    buffer_store_dword v12, v2, s[24:27], s21 offen offset:2048
    v_lshlrev_b32 v36, 16, v12
    v_and_b32 v37, 0xffff0000, v12
    v_cvt_pk_bf16_f32 v61, v61, v61
    v_lshlrev_b32 v61, 16, v61
    v_lshlrev_b32 v38, 16, v13
    v_add_f32 v38, v38, v61
    v_cvt_pk_bf16_f32 v63, v63, v63
    v_lshlrev_b32 v63, 16, v63
    v_and_b32 v39, 0xffff0000, v13
    v_add_f32 v39, v39, v63
    v_cvt_pk_bf16_f32 v13, v38, v39
    buffer_store_dword v13, v2, s[24:27], s21 offen offset:2304
    v_lshlrev_b32 v38, 16, v13
    v_and_b32 v39, 0xffff0000, v13
    v_add_f32 v40, v20, v21
    v_add_f32 v40, v40, v22
    v_add_f32 v40, v40, v23
    v_add_f32 v40, v40, v24
    v_add_f32 v40, v40, v25
    v_add_f32 v40, v40, v26
    v_add_f32 v40, v40, v27
    v_add_f32 v40, v40, v28
    v_add_f32 v40, v40, v29
    v_add_f32 v41, v30, v31
    v_add_f32 v41, v41, v32
    v_add_f32 v41, v41, v33
    v_add_f32 v41, v41, v34
    v_add_f32 v41, v41, v35
    v_add_f32 v41, v41, v36
    v_add_f32 v41, v41, v37
    v_add_f32 v41, v41, v38
    v_add_f32 v41, v41, v39
    s_nop 1
    v_add_f32_dpp v40, v40, v40 quad_perm:[1,0,3,2] row_mask:0xf bank_mask:0xf
    v_add_f32_dpp v41, v41, v41 quad_perm:[1,0,3,2] row_mask:0xf bank_mask:0xf
    s_nop 1
    v_add_f32_dpp v40, v40, v40 quad_perm:[2,3,0,1] row_mask:0xf bank_mask:0xf
    v_add_f32_dpp v41, v41, v41 quad_perm:[2,3,0,1] row_mask:0xf bank_mask:0xf
    s_nop 1
    v_add_f32_dpp v40, v40, v40 row_half_mirror row_mask:0xf bank_mask:0xf
    v_add_f32_dpp v41, v41, v41 row_half_mirror row_mask:0xf bank_mask:0xf
    s_nop 1
    v_add_f32_dpp v40, v40, v40 row_mirror row_mask:0xf bank_mask:0xf
    v_add_f32_dpp v41, v41, v41 row_mirror row_mask:0xf bank_mask:0xf
    v_mov_b32 v44, v40
    v_mov_b32 v45, v41
    s_nop 1
    v_permlane16_swap_b32 v40, v44
    v_permlane16_swap_b32 v41, v45
    s_nop 1
    v_add_f32 v40, v40, v44
    v_add_f32 v41, v41, v45
    v_mov_b32 v44, v40
    v_mov_b32 v45, v41
    s_nop 1
    v_permlane32_swap_b32 v40, v44
    v_permlane32_swap_b32 v41, v45
    s_nop 1
    v_add_f32 v40, v40, v44
    v_add_f32 v41, v41, v45
    v_mul_f32 v40, 0x3acccccd, v40
    v_mul_f32 v41, 0x3acccccd, v41
    v_sub_f32 v44, v20, v40
    v_mul_f32 v42, v44, v44
    v_sub_f32 v44, v21, v40
    v_fma_f32 v42, v44, v44, v42
    v_sub_f32 v44, v22, v40
    v_fma_f32 v42, v44, v44, v42
    v_sub_f32 v44, v23, v40
    v_fma_f32 v42, v44, v44, v42
    v_sub_f32 v44, v24, v40
    v_fma_f32 v42, v44, v44, v42
    v_sub_f32 v44, v25, v40
    v_fma_f32 v42, v44, v44, v42
    v_sub_f32 v44, v26, v40
    v_fma_f32 v42, v44, v44, v42
    v_sub_f32 v44, v27, v40
    v_fma_f32 v42, v44, v44, v42
    v_sub_f32 v44, v28, v40
    v_fma_f32 v42, v44, v44, v42
    v_sub_f32 v44, v29, v40
    v_fma_f32 v42, v44, v44, v42
    v_sub_f32 v44, v30, v41
    v_mul_f32 v43, v44, v44
    v_sub_f32 v44, v31, v41
    v_fma_f32 v43, v44, v44, v43
    v_sub_f32 v44, v32, v41
    v_fma_f32 v43, v44, v44, v43
    v_sub_f32 v44, v33, v41
    v_fma_f32 v43, v44, v44, v43
    v_sub_f32 v44, v34, v41
    v_fma_f32 v43, v44, v44, v43
    v_sub_f32 v44, v35, v41
    v_fma_f32 v43, v44, v44, v43
    v_sub_f32 v44, v36, v41
    v_fma_f32 v43, v44, v44, v43
    v_sub_f32 v44, v37, v41
    v_fma_f32 v43, v44, v44, v43
    v_sub_f32 v44, v38, v41
    v_fma_f32 v43, v44, v44, v43
    v_sub_f32 v44, v39, v41
    v_fma_f32 v43, v44, v44, v43
    s_nop 1
    v_add_f32_dpp v42, v42, v42 quad_perm:[1,0,3,2] row_mask:0xf bank_mask:0xf
    v_add_f32_dpp v43, v43, v43 quad_perm:[1,0,3,2] row_mask:0xf bank_mask:0xf
    s_nop 1
    v_add_f32_dpp v42, v42, v42 quad_perm:[2,3,0,1] row_mask:0xf bank_mask:0xf
    v_add_f32_dpp v43, v43, v43 quad_perm:[2,3,0,1] row_mask:0xf bank_mask:0xf
    s_nop 1
    v_add_f32_dpp v42, v42, v42 row_half_mirror row_mask:0xf bank_mask:0xf
    v_add_f32_dpp v43, v43, v43 row_half_mirror row_mask:0xf bank_mask:0xf
    s_nop 1
    v_add_f32_dpp v42, v42, v42 row_mirror row_mask:0xf bank_mask:0xf
    v_add_f32_dpp v43, v43, v43 row_mirror row_mask:0xf bank_mask:0xf
    v_mov_b32 v44, v42
    v_mov_b32 v45, v43
    s_nop 1
    v_permlane16_swap_b32 v42, v44
    v_permlane16_swap_b32 v43, v45
    s_nop 1
    v_add_f32 v42, v42, v44
    v_add_f32 v43, v43, v45
    v_mov_b32 v44, v42
    v_mov_b32 v45, v43
    s_nop 1
    v_permlane32_swap_b32 v42, v44
    v_permlane32_swap_b32 v43, v45
    s_nop 1
    v_add_f32 v42, v42, v44
    v_add_f32 v43, v43, v45
    v_mul_f32 v42, 0x3acccccd, v42
    v_cvt_pk_bf16_f32 v42, v42, v42
    v_lshlrev_b32 v42, 16, v42
    v_add_f32 v42, 0x3727c5ac, v42
    v_cvt_pk_bf16_f32 v42, v42, v42
    v_lshlrev_b32 v42, 16, v42
    v_sqrt_f32 v42, v42
    s_nop 0
    v_cvt_pk_bf16_f32 v42, v42, v42
    v_lshlrev_b32 v42, 16, v42
    v_rcp_f32 v44, v42
    v_cvt_pk_bf16_f32 v40, v40, v40
    v_lshlrev_b32 v40, 16, v40
    v_mul_f32 v43, 0x3acccccd, v43
    v_cvt_pk_bf16_f32 v43, v43, v43
    v_lshlrev_b32 v43, 16, v43
    v_add_f32 v43, 0x3727c5ac, v43
    v_cvt_pk_bf16_f32 v43, v43, v43
    v_lshlrev_b32 v43, 16, v43
    v_sqrt_f32 v43, v43
    s_nop 0
    v_cvt_pk_bf16_f32 v43, v43, v43
    v_lshlrev_b32 v43, 16, v43
    v_rcp_f32 v45, v43
    v_cvt_pk_bf16_f32 v41, v41, v41
    v_lshlrev_b32 v41, 16, v41
    v_sub_f32 v20, v20, v40
    v_cvt_pk_bf16_f32 v20, v20, v20
    v_lshlrev_b32 v20, 16, v20
    v_mul_f32 v46, v20, v44
    v_fma_f32 v47, -v46, v42, v20
    v_fma_f32 v20, v47, v44, v46
    v_cvt_pk_bf16_f32 v20, v20, v20
    v_lshlrev_b32 v20, 16, v20
    v_sub_f32 v21, v21, v40
    v_cvt_pk_bf16_f32 v21, v21, v21
    v_lshlrev_b32 v21, 16, v21
    v_mul_f32 v46, v21, v44
    v_fma_f32 v47, -v46, v42, v21
    v_fma_f32 v21, v47, v44, v46
    v_cvt_pk_bf16_f32 v21, v21, v21
    v_lshlrev_b32 v21, 16, v21
    v_sub_f32 v22, v22, v40
    v_cvt_pk_bf16_f32 v22, v22, v22
    v_lshlrev_b32 v22, 16, v22
    v_mul_f32 v46, v22, v44
    v_fma_f32 v47, -v46, v42, v22
    v_fma_f32 v22, v47, v44, v46
    v_cvt_pk_bf16_f32 v22, v22, v22
    v_lshlrev_b32 v22, 16, v22
    v_sub_f32 v23, v23, v40
    v_cvt_pk_bf16_f32 v23, v23, v23
    v_lshlrev_b32 v23, 16, v23
    v_mul_f32 v46, v23, v44
    v_fma_f32 v47, -v46, v42, v23
    v_fma_f32 v23, v47, v44, v46
    v_cvt_pk_bf16_f32 v23, v23, v23
    v_lshlrev_b32 v23, 16, v23
    v_sub_f32 v24, v24, v40
    v_cvt_pk_bf16_f32 v24, v24, v24
    v_lshlrev_b32 v24, 16, v24
    v_mul_f32 v46, v24, v44
    v_fma_f32 v47, -v46, v42, v24
    v_fma_f32 v24, v47, v44, v46
    v_cvt_pk_bf16_f32 v24, v24, v24
    v_lshlrev_b32 v24, 16, v24
    v_sub_f32 v25, v25, v40
    v_cvt_pk_bf16_f32 v25, v25, v25
    v_lshlrev_b32 v25, 16, v25
    v_mul_f32 v46, v25, v44
    v_fma_f32 v47, -v46, v42, v25
    v_fma_f32 v25, v47, v44, v46
    v_cvt_pk_bf16_f32 v25, v25, v25
    v_lshlrev_b32 v25, 16, v25
    v_sub_f32 v26, v26, v40
    v_cvt_pk_bf16_f32 v26, v26, v26
    v_lshlrev_b32 v26, 16, v26
    v_mul_f32 v46, v26, v44
    v_fma_f32 v47, -v46, v42, v26
    v_fma_f32 v26, v47, v44, v46
    v_cvt_pk_bf16_f32 v26, v26, v26
    v_lshlrev_b32 v26, 16, v26
    v_sub_f32 v27, v27, v40
    v_cvt_pk_bf16_f32 v27, v27, v27
    v_lshlrev_b32 v27, 16, v27
    v_mul_f32 v46, v27, v44
    v_fma_f32 v47, -v46, v42, v27
    v_fma_f32 v27, v47, v44, v46
    v_cvt_pk_bf16_f32 v27, v27, v27
    v_lshlrev_b32 v27, 16, v27
    v_sub_f32 v28, v28, v40
    v_cvt_pk_bf16_f32 v28, v28, v28
    v_lshlrev_b32 v28, 16, v28
    v_mul_f32 v46, v28, v44
    v_fma_f32 v47, -v46, v42, v28
    v_fma_f32 v28, v47, v44, v46
    v_cvt_pk_bf16_f32 v28, v28, v28
    v_lshlrev_b32 v28, 16, v28
    v_sub_f32 v29, v29, v40
    v_cvt_pk_bf16_f32 v29, v29, v29
    v_lshlrev_b32 v29, 16, v29
    v_mul_f32 v46, v29, v44
    v_fma_f32 v47, -v46, v42, v29
    v_fma_f32 v29, v47, v44, v46
    v_cvt_pk_bf16_f32 v29, v29, v29
    v_lshlrev_b32 v29, 16, v29
    v_sub_f32 v30, v30, v41
    v_cvt_pk_bf16_f32 v30, v30, v30
    v_lshlrev_b32 v30, 16, v30
    v_mul_f32 v46, v30, v45
    v_fma_f32 v47, -v46, v43, v30
    v_fma_f32 v30, v47, v45, v46
    v_cvt_pk_bf16_f32 v30, v30, v30
    v_lshlrev_b32 v30, 16, v30
    v_sub_f32 v31, v31, v41
    v_cvt_pk_bf16_f32 v31, v31, v31
    v_lshlrev_b32 v31, 16, v31
    v_mul_f32 v46, v31, v45
    v_fma_f32 v47, -v46, v43, v31
    v_fma_f32 v31, v47, v45, v46
    v_cvt_pk_bf16_f32 v31, v31, v31
    v_lshlrev_b32 v31, 16, v31
    v_sub_f32 v32, v32, v41
    v_cvt_pk_bf16_f32 v32, v32, v32
    v_lshlrev_b32 v32, 16, v32
    v_mul_f32 v46, v32, v45
    v_fma_f32 v47, -v46, v43, v32
    v_fma_f32 v32, v47, v45, v46
    v_cvt_pk_bf16_f32 v32, v32, v32
    v_lshlrev_b32 v32, 16, v32
    v_sub_f32 v33, v33, v41
    v_cvt_pk_bf16_f32 v33, v33, v33
    v_lshlrev_b32 v33, 16, v33
    v_mul_f32 v46, v33, v45
    v_fma_f32 v47, -v46, v43, v33
    v_fma_f32 v33, v47, v45, v46
    v_cvt_pk_bf16_f32 v33, v33, v33
    v_lshlrev_b32 v33, 16, v33
    v_sub_f32 v34, v34, v41
    v_cvt_pk_bf16_f32 v34, v34, v34
    v_lshlrev_b32 v34, 16, v34
    v_mul_f32 v46, v34, v45
    v_fma_f32 v47, -v46, v43, v34
    v_fma_f32 v34, v47, v45, v46
    v_cvt_pk_bf16_f32 v34, v34, v34
    v_lshlrev_b32 v34, 16, v34
    v_sub_f32 v35, v35, v41
    v_cvt_pk_bf16_f32 v35, v35, v35
    v_lshlrev_b32 v35, 16, v35
    v_mul_f32 v46, v35, v45
    v_fma_f32 v47, -v46, v43, v35
    v_fma_f32 v35, v47, v45, v46
    v_cvt_pk_bf16_f32 v35, v35, v35
    v_lshlrev_b32 v35, 16, v35
    v_sub_f32 v36, v36, v41
    v_cvt_pk_bf16_f32 v36, v36, v36
    v_lshlrev_b32 v36, 16, v36
    v_mul_f32 v46, v36, v45
    v_fma_f32 v47, -v46, v43, v36
    v_fma_f32 v36, v47, v45, v46
    v_cvt_pk_bf16_f32 v36, v36, v36
    v_lshlrev_b32 v36, 16, v36
    v_sub_f32 v37, v37, v41
    v_cvt_pk_bf16_f32 v37, v37, v37
    v_lshlrev_b32 v37, 16, v37
    v_mul_f32 v46, v37, v45
    v_fma_f32 v47, -v46, v43, v37
    v_fma_f32 v37, v47, v45, v46
    v_cvt_pk_bf16_f32 v37, v37, v37
    v_lshlrev_b32 v37, 16, v37
    v_sub_f32 v38, v38, v41
    v_cvt_pk_bf16_f32 v38, v38, v38
    v_lshlrev_b32 v38, 16, v38
    v_mul_f32 v46, v38, v45
    v_fma_f32 v47, -v46, v43, v38
    v_fma_f32 v38, v47, v45, v46
    v_cvt_pk_bf16_f32 v38, v38, v38
    v_lshlrev_b32 v38, 16, v38
    v_sub_f32 v39, v39, v41
    v_cvt_pk_bf16_f32 v39, v39, v39
    v_lshlrev_b32 v39, 16, v39
    v_mul_f32 v46, v39, v45
    v_fma_f32 v47, -v46, v43, v39
    v_fma_f32 v39, v47, v45, v46
    v_cvt_pk_bf16_f32 v39, v39, v39
    v_lshlrev_b32 v39, 16, v39
    v_cvt_pk_bf16_f32 v4, v20, v21
    buffer_store_dword v4, v2, s[28:31], s21 offen offset:0
    v_cvt_pk_bf16_f32 v5, v22, v23
    buffer_store_dword v5, v2, s[28:31], s21 offen offset:256
    v_cvt_pk_bf16_f32 v6, v24, v25
    buffer_store_dword v6, v2, s[28:31], s21 offen offset:512
    v_cvt_pk_bf16_f32 v7, v26, v27
    buffer_store_dword v7, v2, s[28:31], s21 offen offset:768
    v_cvt_pk_bf16_f32 v8, v28, v29
    buffer_store_dword v8, v2, s[28:31], s21 offen offset:1024
    v_cvt_pk_bf16_f32 v9, v30, v31
    buffer_store_dword v9, v2, s[28:31], s21 offen offset:1280
    v_cvt_pk_bf16_f32 v10, v32, v33
    buffer_store_dword v10, v2, s[28:31], s21 offen offset:1536
    v_cvt_pk_bf16_f32 v11, v34, v35
    buffer_store_dword v11, v2, s[28:31], s21 offen offset:1792
    v_cvt_pk_bf16_f32 v12, v36, v37
    buffer_store_dword v12, v2, s[28:31], s21 offen offset:2048
    v_cvt_pk_bf16_f32 v13, v38, v39
    buffer_store_dword v13, v2, s[28:31], s21 offen offset:2304
.Lk3a_kernel_end:
    s_endpgm
.globl g1a_kernel
.p2align 8
.type g1a_kernel,@function
g1a_kernel:
    s_cmp_ge_u32 s2, 432
    s_cbranch_scc1 .Lg1a_kernel_end
    s_load_dwordx2 s[4:5], s[0:1], 72
    s_and_b32 s18, s2, 7
    s_mul_i32 s18, s18, 54
    s_lshr_b32 s19, s2, 3
    s_add_u32 s18, s18, s19
    s_and_b32 s20, s18, 15
    s_lshr_b32 s21, s18, 4
    s_waitcnt lgkmcnt(0)
    s_mov_b32 s3, 15728640
    s_add_u32 s8, s4, s3
    s_addc_u32 s9, s5, 0
    s_mov_b32 s10, 2621440
    s_mov_b32 s11, 0x00020000
    s_mov_b32 s3, 44040192
    s_add_u32 s12, s4, s3
    s_addc_u32 s13, s5, 0
    s_mov_b32 s14, 4423680
    s_mov_b32 s15, 0x00020000
    s_mul_i32 s16, s20, 163840
    s_mul_i32 s17, s21, 163840
    v_lshrrev_b32 v5, 3, v0
    v_and_b32 v6, 7, v0
    s_mov_b32 s19, 1280
    v_mul_lo_u32 v1, v5, s19
    v_lshl_add_u32 v1, v6, 4, v1
    v_mul_u32_u24 v2, 144, v5
    v_lshl_add_u32 v2, v6, 4, v2
    v_lshrrev_b32 v5, 6, v0
    v_and_b32 v6, 31, v0
    v_lshrrev_b32 v7, 5, v0
    v_and_b32 v7, 1, v7
    v_lshrrev_b32 v8, 1, v5
    v_and_b32 v9, 1, v5
    v_lshl_add_u32 v8, v8, 6, v6
    v_mul_u32_u24 v3, 144, v8
    v_lshl_add_u32 v3, v7, 4, v3
    v_lshl_add_u32 v9, v9, 5, v6
    v_mul_u32_u24 v4, 144, v9
    v_lshl_add_u32 v4, v7, 4, v4
    v_add_u32 v4, 18432, v4
    v_add_u32 v10, 36864, v2
    v_add_u32 v11, 36864, v3
    v_add_u32 v12, 36864, v4
    v_mov_b32 v64, 0
    v_mov_b32 v65, 0
    v_mov_b32 v66, 0
    v_mov_b32 v67, 0
    v_mov_b32 v68, 0
    v_mov_b32 v69, 0
    v_mov_b32 v70, 0
    v_mov_b32 v71, 0
    v_mov_b32 v72, 0
    v_mov_b32 v73, 0
    v_mov_b32 v74, 0
    v_mov_b32 v75, 0
    v_mov_b32 v76, 0
    v_mov_b32 v77, 0
    v_mov_b32 v78, 0
    v_mov_b32 v79, 0
    v_mov_b32 v80, 0
    v_mov_b32 v81, 0
    v_mov_b32 v82, 0
    v_mov_b32 v83, 0
    v_mov_b32 v84, 0
    v_mov_b32 v85, 0
    v_mov_b32 v86, 0
    v_mov_b32 v87, 0
    v_mov_b32 v88, 0
    v_mov_b32 v89, 0
    v_mov_b32 v90, 0
    v_mov_b32 v91, 0
    v_mov_b32 v92, 0
    v_mov_b32 v93, 0
    v_mov_b32 v94, 0
    v_mov_b32 v95, 0
    v_mov_b32 v96, 0
    v_mov_b32 v97, 0
    v_mov_b32 v98, 0
    v_mov_b32 v99, 0
    v_mov_b32 v100, 0
    v_mov_b32 v101, 0
    v_mov_b32 v102, 0
    v_mov_b32 v103, 0
    v_mov_b32 v104, 0
    v_mov_b32 v105, 0
    v_mov_b32 v106, 0
    v_mov_b32 v107, 0
    v_mov_b32 v108, 0
    v_mov_b32 v109, 0
    v_mov_b32 v110, 0
    v_mov_b32 v111, 0
    v_mov_b32 v112, 0
    v_mov_b32 v113, 0
    v_mov_b32 v114, 0
    v_mov_b32 v115, 0
    v_mov_b32 v116, 0
    v_mov_b32 v117, 0
    v_mov_b32 v118, 0
    v_mov_b32 v119, 0
    v_mov_b32 v120, 0
    v_mov_b32 v121, 0
    v_mov_b32 v122, 0
    v_mov_b32 v123, 0
    v_mov_b32 v124, 0
    v_mov_b32 v125, 0
    v_mov_b32 v126, 0
    v_mov_b32 v127, 0
    s_add_u32 s25, s16, 40960
    s_add_u32 s28, s17, 40960
    s_add_u32 s26, s16, 81920
    s_add_u32 s29, s17, 81920
    s_add_u32 s27, s16, 122880
    s_add_u32 s30, s17, 122880
    buffer_load_dwordx4 v[16:19], v1, s[8:11], s16 offen offset:0
    buffer_load_dwordx4 v[20:23], v1, s[8:11], s25 offen
    buffer_load_dwordx4 v[24:27], v1, s[8:11], s26 offen
    buffer_load_dwordx4 v[28:31], v1, s[8:11], s27 offen
    buffer_load_dwordx4 v[32:35], v1, s[12:15], s17 offen
    buffer_load_dwordx4 v[36:39], v1, s[12:15], s28 offen
    buffer_load_dwordx4 v[40:43], v1, s[12:15], s29 offen
    buffer_load_dwordx4 v[44:47], v1, s[12:15], s30 offen
    s_waitcnt vmcnt(0)
    ds_write_b128 v2, v[16:19] offset:0
    ds_write_b128 v2, v[20:23] offset:4608
    ds_write_b128 v2, v[24:27] offset:9216
    ds_write_b128 v2, v[28:31] offset:13824
    ds_write_b128 v2, v[32:35] offset:18432
    ds_write_b128 v2, v[36:39] offset:23040
    ds_write_b128 v2, v[40:43] offset:27648
    ds_write_b128 v2, v[44:47] offset:32256
    s_waitcnt lgkmcnt(0)
    s_barrier
    s_add_u32 s16, s16, 128
    s_add_u32 s17, s17, 128
    s_add_u32 s25, s16, 40960
    s_add_u32 s28, s17, 40960
    s_add_u32 s26, s16, 81920
    s_add_u32 s29, s17, 81920
    s_add_u32 s27, s16, 122880
    s_add_u32 s30, s17, 122880
    buffer_load_dwordx4 v[16:19], v1, s[8:11], s16 offen offset:0
    buffer_load_dwordx4 v[20:23], v1, s[8:11], s25 offen
    buffer_load_dwordx4 v[24:27], v1, s[8:11], s26 offen
    buffer_load_dwordx4 v[28:31], v1, s[8:11], s27 offen
    buffer_load_dwordx4 v[32:35], v1, s[12:15], s17 offen
    buffer_load_dwordx4 v[36:39], v1, s[12:15], s28 offen
    buffer_load_dwordx4 v[40:43], v1, s[12:15], s29 offen
    buffer_load_dwordx4 v[44:47], v1, s[12:15], s30 offen
    ds_read_b128 v[48:51], v3 offset:0
    ds_read_b128 v[52:55], v3 offset:4608
    ds_read_b128 v[56:59], v4 offset:0
    ds_read_b128 v[60:63], v4 offset:9216
    ds_read_b128 v[128:131], v3 offset:32
    ds_read_b128 v[132:135], v3 offset:4640
    ds_read_b128 v[136:139], v4 offset:32
    ds_read_b128 v[140:143], v4 offset:9248
    s_waitcnt lgkmcnt(4)
    v_mfma_f32_32x32x16_bf16 v[64:79], v[56:59], v[48:51], v[64:79]
    v_mfma_f32_32x32x16_bf16 v[80:95], v[60:63], v[48:51], v[80:95]
    v_mfma_f32_32x32x16_bf16 v[96:111], v[56:59], v[52:55], v[96:111]
    v_mfma_f32_32x32x16_bf16 v[112:127], v[60:63], v[52:55], v[112:127]
    ds_read_b128 v[48:51], v3 offset:64
    ds_read_b128 v[52:55], v3 offset:4672
    ds_read_b128 v[56:59], v4 offset:64
    ds_read_b128 v[60:63], v4 offset:9280
    s_waitcnt lgkmcnt(4)
    v_mfma_f32_32x32x16_bf16 v[64:79], v[136:139], v[128:131], v[64:79]
    v_mfma_f32_32x32x16_bf16 v[80:95], v[140:143], v[128:131], v[80:95]
    v_mfma_f32_32x32x16_bf16 v[96:111], v[136:139], v[132:135], v[96:111]
    v_mfma_f32_32x32x16_bf16 v[112:127], v[140:143], v[132:135], v[112:127]
    ds_read_b128 v[128:131], v3 offset:96
    ds_read_b128 v[132:135], v3 offset:4704
    ds_read_b128 v[136:139], v4 offset:96
    ds_read_b128 v[140:143], v4 offset:9312
    s_waitcnt lgkmcnt(4)
    v_mfma_f32_32x32x16_bf16 v[64:79], v[56:59], v[48:51], v[64:79]
    v_mfma_f32_32x32x16_bf16 v[80:95], v[60:63], v[48:51], v[80:95]
    v_mfma_f32_32x32x16_bf16 v[96:111], v[56:59], v[52:55], v[96:111]
    v_mfma_f32_32x32x16_bf16 v[112:127], v[60:63], v[52:55], v[112:127]
    s_waitcnt lgkmcnt(0)
    s_waitcnt vmcnt(0)
    v_mfma_f32_32x32x16_bf16 v[64:79], v[136:139], v[128:131], v[64:79]
    ds_write_b128 v10, v[16:19] offset:0
    ds_write_b128 v10, v[20:23] offset:4608
    v_mfma_f32_32x32x16_bf16 v[80:95], v[140:143], v[128:131], v[80:95]
    ds_write_b128 v10, v[24:27] offset:9216
    ds_write_b128 v10, v[28:31] offset:13824
    v_mfma_f32_32x32x16_bf16 v[96:111], v[136:139], v[132:135], v[96:111]
    ds_write_b128 v10, v[32:35] offset:18432
    ds_write_b128 v10, v[36:39] offset:23040
    v_mfma_f32_32x32x16_bf16 v[112:127], v[140:143], v[132:135], v[112:127]
    ds_write_b128 v10, v[40:43] offset:27648
    ds_write_b128 v10, v[44:47] offset:32256
    s_waitcnt lgkmcnt(0)
    s_barrier
    s_add_u32 s16, s16, 128
    s_add_u32 s17, s17, 128
    s_add_u32 s25, s16, 40960
    s_add_u32 s28, s17, 40960
    s_add_u32 s26, s16, 81920
    s_add_u32 s29, s17, 81920
    s_add_u32 s27, s16, 122880
    s_add_u32 s30, s17, 122880
    buffer_load_dwordx4 v[16:19], v1, s[8:11], s16 offen offset:0
    buffer_load_dwordx4 v[20:23], v1, s[8:11], s25 offen
    buffer_load_dwordx4 v[24:27], v1, s[8:11], s26 offen
    buffer_load_dwordx4 v[28:31], v1, s[8:11], s27 offen
    buffer_load_dwordx4 v[32:35], v1, s[12:15], s17 offen
    buffer_load_dwordx4 v[36:39], v1, s[12:15], s28 offen
    buffer_load_dwordx4 v[40:43], v1, s[12:15], s29 offen
    buffer_load_dwordx4 v[44:47], v1, s[12:15], s30 offen
    ds_read_b128 v[48:51], v11 offset:0
    ds_read_b128 v[52:55], v11 offset:4608
    ds_read_b128 v[56:59], v12 offset:0
    ds_read_b128 v[60:63], v12 offset:9216
    ds_read_b128 v[128:131], v11 offset:32
    ds_read_b128 v[132:135], v11 offset:4640
    ds_read_b128 v[136:139], v12 offset:32
    ds_read_b128 v[140:143], v12 offset:9248
    s_waitcnt lgkmcnt(4)
    v_mfma_f32_32x32x16_bf16 v[64:79], v[56:59], v[48:51], v[64:79]
    v_mfma_f32_32x32x16_bf16 v[80:95], v[60:63], v[48:51], v[80:95]
    v_mfma_f32_32x32x16_bf16 v[96:111], v[56:59], v[52:55], v[96:111]
    v_mfma_f32_32x32x16_bf16 v[112:127], v[60:63], v[52:55], v[112:127]
    ds_read_b128 v[48:51], v11 offset:64
    ds_read_b128 v[52:55], v11 offset:4672
    ds_read_b128 v[56:59], v12 offset:64
    ds_read_b128 v[60:63], v12 offset:9280
    s_waitcnt lgkmcnt(4)
    v_mfma_f32_32x32x16_bf16 v[64:79], v[136:139], v[128:131], v[64:79]
    v_mfma_f32_32x32x16_bf16 v[80:95], v[140:143], v[128:131], v[80:95]
    v_mfma_f32_32x32x16_bf16 v[96:111], v[136:139], v[132:135], v[96:111]
    v_mfma_f32_32x32x16_bf16 v[112:127], v[140:143], v[132:135], v[112:127]
    ds_read_b128 v[128:131], v11 offset:96
    ds_read_b128 v[132:135], v11 offset:4704
    ds_read_b128 v[136:139], v12 offset:96
    ds_read_b128 v[140:143], v12 offset:9312
    s_waitcnt lgkmcnt(4)
    v_mfma_f32_32x32x16_bf16 v[64:79], v[56:59], v[48:51], v[64:79]
    v_mfma_f32_32x32x16_bf16 v[80:95], v[60:63], v[48:51], v[80:95]
    v_mfma_f32_32x32x16_bf16 v[96:111], v[56:59], v[52:55], v[96:111]
    v_mfma_f32_32x32x16_bf16 v[112:127], v[60:63], v[52:55], v[112:127]
    s_waitcnt lgkmcnt(0)
    s_waitcnt vmcnt(0)
    v_mfma_f32_32x32x16_bf16 v[64:79], v[136:139], v[128:131], v[64:79]
    ds_write_b128 v2, v[16:19] offset:0
    ds_write_b128 v2, v[20:23] offset:4608
    v_mfma_f32_32x32x16_bf16 v[80:95], v[140:143], v[128:131], v[80:95]
    ds_write_b128 v2, v[24:27] offset:9216
    ds_write_b128 v2, v[28:31] offset:13824
    v_mfma_f32_32x32x16_bf16 v[96:111], v[136:139], v[132:135], v[96:111]
    ds_write_b128 v2, v[32:35] offset:18432
    ds_write_b128 v2, v[36:39] offset:23040
    v_mfma_f32_32x32x16_bf16 v[112:127], v[140:143], v[132:135], v[112:127]
    ds_write_b128 v2, v[40:43] offset:27648
    ds_write_b128 v2, v[44:47] offset:32256
    s_waitcnt lgkmcnt(0)
    s_barrier
    s_add_u32 s16, s16, 128
    s_add_u32 s17, s17, 128
    s_add_u32 s25, s16, 40960
    s_add_u32 s28, s17, 40960
    s_add_u32 s26, s16, 81920
    s_add_u32 s29, s17, 81920
    s_add_u32 s27, s16, 122880
    s_add_u32 s30, s17, 122880
    buffer_load_dwordx4 v[16:19], v1, s[8:11], s16 offen offset:0
    buffer_load_dwordx4 v[20:23], v1, s[8:11], s25 offen
    buffer_load_dwordx4 v[24:27], v1, s[8:11], s26 offen
    buffer_load_dwordx4 v[28:31], v1, s[8:11], s27 offen
    buffer_load_dwordx4 v[32:35], v1, s[12:15], s17 offen
    buffer_load_dwordx4 v[36:39], v1, s[12:15], s28 offen
    buffer_load_dwordx4 v[40:43], v1, s[12:15], s29 offen
    buffer_load_dwordx4 v[44:47], v1, s[12:15], s30 offen
    ds_read_b128 v[48:51], v3 offset:0
    ds_read_b128 v[52:55], v3 offset:4608
    ds_read_b128 v[56:59], v4 offset:0
    ds_read_b128 v[60:63], v4 offset:9216
    ds_read_b128 v[128:131], v3 offset:32
    ds_read_b128 v[132:135], v3 offset:4640
    ds_read_b128 v[136:139], v4 offset:32
    ds_read_b128 v[140:143], v4 offset:9248
    s_waitcnt lgkmcnt(4)
    v_mfma_f32_32x32x16_bf16 v[64:79], v[56:59], v[48:51], v[64:79]
    v_mfma_f32_32x32x16_bf16 v[80:95], v[60:63], v[48:51], v[80:95]
    v_mfma_f32_32x32x16_bf16 v[96:111], v[56:59], v[52:55], v[96:111]
    v_mfma_f32_32x32x16_bf16 v[112:127], v[60:63], v[52:55], v[112:127]
    ds_read_b128 v[48:51], v3 offset:64
    ds_read_b128 v[52:55], v3 offset:4672
    ds_read_b128 v[56:59], v4 offset:64
    ds_read_b128 v[60:63], v4 offset:9280
    s_waitcnt lgkmcnt(4)
    v_mfma_f32_32x32x16_bf16 v[64:79], v[136:139], v[128:131], v[64:79]
    v_mfma_f32_32x32x16_bf16 v[80:95], v[140:143], v[128:131], v[80:95]
    v_mfma_f32_32x32x16_bf16 v[96:111], v[136:139], v[132:135], v[96:111]
    v_mfma_f32_32x32x16_bf16 v[112:127], v[140:143], v[132:135], v[112:127]
    ds_read_b128 v[128:131], v3 offset:96
    ds_read_b128 v[132:135], v3 offset:4704
    ds_read_b128 v[136:139], v4 offset:96
    ds_read_b128 v[140:143], v4 offset:9312
    s_waitcnt lgkmcnt(4)
    v_mfma_f32_32x32x16_bf16 v[64:79], v[56:59], v[48:51], v[64:79]
    v_mfma_f32_32x32x16_bf16 v[80:95], v[60:63], v[48:51], v[80:95]
    v_mfma_f32_32x32x16_bf16 v[96:111], v[56:59], v[52:55], v[96:111]
    v_mfma_f32_32x32x16_bf16 v[112:127], v[60:63], v[52:55], v[112:127]
    s_waitcnt lgkmcnt(0)
    s_waitcnt vmcnt(0)
    v_mfma_f32_32x32x16_bf16 v[64:79], v[136:139], v[128:131], v[64:79]
    ds_write_b128 v10, v[16:19] offset:0
    ds_write_b128 v10, v[20:23] offset:4608
    v_mfma_f32_32x32x16_bf16 v[80:95], v[140:143], v[128:131], v[80:95]
    ds_write_b128 v10, v[24:27] offset:9216
    ds_write_b128 v10, v[28:31] offset:13824
    v_mfma_f32_32x32x16_bf16 v[96:111], v[136:139], v[132:135], v[96:111]
    ds_write_b128 v10, v[32:35] offset:18432
    ds_write_b128 v10, v[36:39] offset:23040
    v_mfma_f32_32x32x16_bf16 v[112:127], v[140:143], v[132:135], v[112:127]
    ds_write_b128 v10, v[40:43] offset:27648
    ds_write_b128 v10, v[44:47] offset:32256
    s_waitcnt lgkmcnt(0)
    s_barrier
    s_add_u32 s16, s16, 128
    s_add_u32 s17, s17, 128
    s_add_u32 s25, s16, 40960
    s_add_u32 s28, s17, 40960
    s_add_u32 s26, s16, 81920
    s_add_u32 s29, s17, 81920
    s_add_u32 s27, s16, 122880
    s_add_u32 s30, s17, 122880
    buffer_load_dwordx4 v[16:19], v1, s[8:11], s16 offen offset:0
    buffer_load_dwordx4 v[20:23], v1, s[8:11], s25 offen
    buffer_load_dwordx4 v[24:27], v1, s[8:11], s26 offen
    buffer_load_dwordx4 v[28:31], v1, s[8:11], s27 offen
    buffer_load_dwordx4 v[32:35], v1, s[12:15], s17 offen
    buffer_load_dwordx4 v[36:39], v1, s[12:15], s28 offen
    buffer_load_dwordx4 v[40:43], v1, s[12:15], s29 offen
    buffer_load_dwordx4 v[44:47], v1, s[12:15], s30 offen
    ds_read_b128 v[48:51], v11 offset:0
    ds_read_b128 v[52:55], v11 offset:4608
    ds_read_b128 v[56:59], v12 offset:0
    ds_read_b128 v[60:63], v12 offset:9216
    ds_read_b128 v[128:131], v11 offset:32
    ds_read_b128 v[132:135], v11 offset:4640
    ds_read_b128 v[136:139], v12 offset:32
    ds_read_b128 v[140:143], v12 offset:9248
    s_waitcnt lgkmcnt(4)
    v_mfma_f32_32x32x16_bf16 v[64:79], v[56:59], v[48:51], v[64:79]
    v_mfma_f32_32x32x16_bf16 v[80:95], v[60:63], v[48:51], v[80:95]
    v_mfma_f32_32x32x16_bf16 v[96:111], v[56:59], v[52:55], v[96:111]
    v_mfma_f32_32x32x16_bf16 v[112:127], v[60:63], v[52:55], v[112:127]
    ds_read_b128 v[48:51], v11 offset:64
    ds_read_b128 v[52:55], v11 offset:4672
    ds_read_b128 v[56:59], v12 offset:64
    ds_read_b128 v[60:63], v12 offset:9280
    s_waitcnt lgkmcnt(4)
    v_mfma_f32_32x32x16_bf16 v[64:79], v[136:139], v[128:131], v[64:79]
    v_mfma_f32_32x32x16_bf16 v[80:95], v[140:143], v[128:131], v[80:95]
    v_mfma_f32_32x32x16_bf16 v[96:111], v[136:139], v[132:135], v[96:111]
    v_mfma_f32_32x32x16_bf16 v[112:127], v[140:143], v[132:135], v[112:127]
    ds_read_b128 v[128:131], v11 offset:96
    ds_read_b128 v[132:135], v11 offset:4704
    ds_read_b128 v[136:139], v12 offset:96
    ds_read_b128 v[140:143], v12 offset:9312
    s_waitcnt lgkmcnt(4)
    v_mfma_f32_32x32x16_bf16 v[64:79], v[56:59], v[48:51], v[64:79]
    v_mfma_f32_32x32x16_bf16 v[80:95], v[60:63], v[48:51], v[80:95]
    v_mfma_f32_32x32x16_bf16 v[96:111], v[56:59], v[52:55], v[96:111]
    v_mfma_f32_32x32x16_bf16 v[112:127], v[60:63], v[52:55], v[112:127]
    s_waitcnt lgkmcnt(0)
    s_waitcnt vmcnt(0)
    v_mfma_f32_32x32x16_bf16 v[64:79], v[136:139], v[128:131], v[64:79]
    ds_write_b128 v2, v[16:19] offset:0
    ds_write_b128 v2, v[20:23] offset:4608
    v_mfma_f32_32x32x16_bf16 v[80:95], v[140:143], v[128:131], v[80:95]
    ds_write_b128 v2, v[24:27] offset:9216
    ds_write_b128 v2, v[28:31] offset:13824
    v_mfma_f32_32x32x16_bf16 v[96:111], v[136:139], v[132:135], v[96:111]
    ds_write_b128 v2, v[32:35] offset:18432
    ds_write_b128 v2, v[36:39] offset:23040
    v_mfma_f32_32x32x16_bf16 v[112:127], v[140:143], v[132:135], v[112:127]
    ds_write_b128 v2, v[40:43] offset:27648
    ds_write_b128 v2, v[44:47] offset:32256
    s_waitcnt lgkmcnt(0)
    s_barrier
    s_add_u32 s16, s16, 128
    s_add_u32 s17, s17, 128
    s_add_u32 s25, s16, 40960
    s_add_u32 s28, s17, 40960
    s_add_u32 s26, s16, 81920
    s_add_u32 s29, s17, 81920
    s_add_u32 s27, s16, 122880
    s_add_u32 s30, s17, 122880
    buffer_load_dwordx4 v[16:19], v1, s[8:11], s16 offen offset:0
    buffer_load_dwordx4 v[20:23], v1, s[8:11], s25 offen
    buffer_load_dwordx4 v[24:27], v1, s[8:11], s26 offen
    buffer_load_dwordx4 v[28:31], v1, s[8:11], s27 offen
    buffer_load_dwordx4 v[32:35], v1, s[12:15], s17 offen
    buffer_load_dwordx4 v[36:39], v1, s[12:15], s28 offen
    buffer_load_dwordx4 v[40:43], v1, s[12:15], s29 offen
    buffer_load_dwordx4 v[44:47], v1, s[12:15], s30 offen
    ds_read_b128 v[48:51], v3 offset:0
    ds_read_b128 v[52:55], v3 offset:4608
    ds_read_b128 v[56:59], v4 offset:0
    ds_read_b128 v[60:63], v4 offset:9216
    ds_read_b128 v[128:131], v3 offset:32
    ds_read_b128 v[132:135], v3 offset:4640
    ds_read_b128 v[136:139], v4 offset:32
    ds_read_b128 v[140:143], v4 offset:9248
    s_waitcnt lgkmcnt(4)
    v_mfma_f32_32x32x16_bf16 v[64:79], v[56:59], v[48:51], v[64:79]
    v_mfma_f32_32x32x16_bf16 v[80:95], v[60:63], v[48:51], v[80:95]
    v_mfma_f32_32x32x16_bf16 v[96:111], v[56:59], v[52:55], v[96:111]
    v_mfma_f32_32x32x16_bf16 v[112:127], v[60:63], v[52:55], v[112:127]
    ds_read_b128 v[48:51], v3 offset:64
    ds_read_b128 v[52:55], v3 offset:4672
    ds_read_b128 v[56:59], v4 offset:64
    ds_read_b128 v[60:63], v4 offset:9280
    s_waitcnt lgkmcnt(4)
    v_mfma_f32_32x32x16_bf16 v[64:79], v[136:139], v[128:131], v[64:79]
    v_mfma_f32_32x32x16_bf16 v[80:95], v[140:143], v[128:131], v[80:95]
    v_mfma_f32_32x32x16_bf16 v[96:111], v[136:139], v[132:135], v[96:111]
    v_mfma_f32_32x32x16_bf16 v[112:127], v[140:143], v[132:135], v[112:127]
    ds_read_b128 v[128:131], v3 offset:96
    ds_read_b128 v[132:135], v3 offset:4704
    ds_read_b128 v[136:139], v4 offset:96
    ds_read_b128 v[140:143], v4 offset:9312
    s_waitcnt lgkmcnt(4)
    v_mfma_f32_32x32x16_bf16 v[64:79], v[56:59], v[48:51], v[64:79]
    v_mfma_f32_32x32x16_bf16 v[80:95], v[60:63], v[48:51], v[80:95]
    v_mfma_f32_32x32x16_bf16 v[96:111], v[56:59], v[52:55], v[96:111]
    v_mfma_f32_32x32x16_bf16 v[112:127], v[60:63], v[52:55], v[112:127]
    s_waitcnt lgkmcnt(0)
    s_waitcnt vmcnt(0)
    v_mfma_f32_32x32x16_bf16 v[64:79], v[136:139], v[128:131], v[64:79]
    ds_write_b128 v10, v[16:19] offset:0
    ds_write_b128 v10, v[20:23] offset:4608
    v_mfma_f32_32x32x16_bf16 v[80:95], v[140:143], v[128:131], v[80:95]
    ds_write_b128 v10, v[24:27] offset:9216
    ds_write_b128 v10, v[28:31] offset:13824
    v_mfma_f32_32x32x16_bf16 v[96:111], v[136:139], v[132:135], v[96:111]
    ds_write_b128 v10, v[32:35] offset:18432
    ds_write_b128 v10, v[36:39] offset:23040
    v_mfma_f32_32x32x16_bf16 v[112:127], v[140:143], v[132:135], v[112:127]
    ds_write_b128 v10, v[40:43] offset:27648
    ds_write_b128 v10, v[44:47] offset:32256
    s_waitcnt lgkmcnt(0)
    s_barrier
    s_add_u32 s16, s16, 128
    s_add_u32 s17, s17, 128
    s_add_u32 s25, s16, 40960
    s_add_u32 s28, s17, 40960
    s_add_u32 s26, s16, 81920
    s_add_u32 s29, s17, 81920
    s_add_u32 s27, s16, 122880
    s_add_u32 s30, s17, 122880
    buffer_load_dwordx4 v[16:19], v1, s[8:11], s16 offen offset:0
    buffer_load_dwordx4 v[20:23], v1, s[8:11], s25 offen
    buffer_load_dwordx4 v[24:27], v1, s[8:11], s26 offen
    buffer_load_dwordx4 v[28:31], v1, s[8:11], s27 offen
    buffer_load_dwordx4 v[32:35], v1, s[12:15], s17 offen
    buffer_load_dwordx4 v[36:39], v1, s[12:15], s28 offen
    buffer_load_dwordx4 v[40:43], v1, s[12:15], s29 offen
    buffer_load_dwordx4 v[44:47], v1, s[12:15], s30 offen
    ds_read_b128 v[48:51], v11 offset:0
    ds_read_b128 v[52:55], v11 offset:4608
    ds_read_b128 v[56:59], v12 offset:0
    ds_read_b128 v[60:63], v12 offset:9216
    ds_read_b128 v[128:131], v11 offset:32
    ds_read_b128 v[132:135], v11 offset:4640
    ds_read_b128 v[136:139], v12 offset:32
    ds_read_b128 v[140:143], v12 offset:9248
    s_waitcnt lgkmcnt(4)
    v_mfma_f32_32x32x16_bf16 v[64:79], v[56:59], v[48:51], v[64:79]
    v_mfma_f32_32x32x16_bf16 v[80:95], v[60:63], v[48:51], v[80:95]
    v_mfma_f32_32x32x16_bf16 v[96:111], v[56:59], v[52:55], v[96:111]
    v_mfma_f32_32x32x16_bf16 v[112:127], v[60:63], v[52:55], v[112:127]
    ds_read_b128 v[48:51], v11 offset:64
    ds_read_b128 v[52:55], v11 offset:4672
    ds_read_b128 v[56:59], v12 offset:64
    ds_read_b128 v[60:63], v12 offset:9280
    s_waitcnt lgkmcnt(4)
    v_mfma_f32_32x32x16_bf16 v[64:79], v[136:139], v[128:131], v[64:79]
    v_mfma_f32_32x32x16_bf16 v[80:95], v[140:143], v[128:131], v[80:95]
    v_mfma_f32_32x32x16_bf16 v[96:111], v[136:139], v[132:135], v[96:111]
    v_mfma_f32_32x32x16_bf16 v[112:127], v[140:143], v[132:135], v[112:127]
    ds_read_b128 v[128:131], v11 offset:96
    ds_read_b128 v[132:135], v11 offset:4704
    ds_read_b128 v[136:139], v12 offset:96
    ds_read_b128 v[140:143], v12 offset:9312
    s_waitcnt lgkmcnt(4)
    v_mfma_f32_32x32x16_bf16 v[64:79], v[56:59], v[48:51], v[64:79]
    v_mfma_f32_32x32x16_bf16 v[80:95], v[60:63], v[48:51], v[80:95]
    v_mfma_f32_32x32x16_bf16 v[96:111], v[56:59], v[52:55], v[96:111]
    v_mfma_f32_32x32x16_bf16 v[112:127], v[60:63], v[52:55], v[112:127]
    s_waitcnt lgkmcnt(0)
    s_waitcnt vmcnt(0)
    v_mfma_f32_32x32x16_bf16 v[64:79], v[136:139], v[128:131], v[64:79]
    ds_write_b128 v2, v[16:19] offset:0
    ds_write_b128 v2, v[20:23] offset:4608
    v_mfma_f32_32x32x16_bf16 v[80:95], v[140:143], v[128:131], v[80:95]
    ds_write_b128 v2, v[24:27] offset:9216
    ds_write_b128 v2, v[28:31] offset:13824
    v_mfma_f32_32x32x16_bf16 v[96:111], v[136:139], v[132:135], v[96:111]
    ds_write_b128 v2, v[32:35] offset:18432
    ds_write_b128 v2, v[36:39] offset:23040
    v_mfma_f32_32x32x16_bf16 v[112:127], v[140:143], v[132:135], v[112:127]
    ds_write_b128 v2, v[40:43] offset:27648
    ds_write_b128 v2, v[44:47] offset:32256
    s_waitcnt lgkmcnt(0)
    s_barrier
    s_add_u32 s16, s16, 128
    s_add_u32 s17, s17, 128
    s_add_u32 s25, s16, 40960
    s_add_u32 s28, s17, 40960
    s_add_u32 s26, s16, 81920
    s_add_u32 s29, s17, 81920
    s_add_u32 s27, s16, 122880
    s_add_u32 s30, s17, 122880
    buffer_load_dwordx4 v[16:19], v1, s[8:11], s16 offen offset:0
    buffer_load_dwordx4 v[20:23], v1, s[8:11], s25 offen
    buffer_load_dwordx4 v[24:27], v1, s[8:11], s26 offen
    buffer_load_dwordx4 v[28:31], v1, s[8:11], s27 offen
    buffer_load_dwordx4 v[32:35], v1, s[12:15], s17 offen
    buffer_load_dwordx4 v[36:39], v1, s[12:15], s28 offen
    buffer_load_dwordx4 v[40:43], v1, s[12:15], s29 offen
    buffer_load_dwordx4 v[44:47], v1, s[12:15], s30 offen
    ds_read_b128 v[48:51], v3 offset:0
    ds_read_b128 v[52:55], v3 offset:4608
    ds_read_b128 v[56:59], v4 offset:0
    ds_read_b128 v[60:63], v4 offset:9216
    ds_read_b128 v[128:131], v3 offset:32
    ds_read_b128 v[132:135], v3 offset:4640
    ds_read_b128 v[136:139], v4 offset:32
    ds_read_b128 v[140:143], v4 offset:9248
    s_waitcnt lgkmcnt(4)
    v_mfma_f32_32x32x16_bf16 v[64:79], v[56:59], v[48:51], v[64:79]
    v_mfma_f32_32x32x16_bf16 v[80:95], v[60:63], v[48:51], v[80:95]
    v_mfma_f32_32x32x16_bf16 v[96:111], v[56:59], v[52:55], v[96:111]
    v_mfma_f32_32x32x16_bf16 v[112:127], v[60:63], v[52:55], v[112:127]
    ds_read_b128 v[48:51], v3 offset:64
    ds_read_b128 v[52:55], v3 offset:4672
    ds_read_b128 v[56:59], v4 offset:64
    ds_read_b128 v[60:63], v4 offset:9280
    s_waitcnt lgkmcnt(4)
    v_mfma_f32_32x32x16_bf16 v[64:79], v[136:139], v[128:131], v[64:79]
    v_mfma_f32_32x32x16_bf16 v[80:95], v[140:143], v[128:131], v[80:95]
    v_mfma_f32_32x32x16_bf16 v[96:111], v[136:139], v[132:135], v[96:111]
    v_mfma_f32_32x32x16_bf16 v[112:127], v[140:143], v[132:135], v[112:127]
    ds_read_b128 v[128:131], v3 offset:96
    ds_read_b128 v[132:135], v3 offset:4704
    ds_read_b128 v[136:139], v4 offset:96
    ds_read_b128 v[140:143], v4 offset:9312
    s_waitcnt lgkmcnt(4)
    v_mfma_f32_32x32x16_bf16 v[64:79], v[56:59], v[48:51], v[64:79]
    v_mfma_f32_32x32x16_bf16 v[80:95], v[60:63], v[48:51], v[80:95]
    v_mfma_f32_32x32x16_bf16 v[96:111], v[56:59], v[52:55], v[96:111]
    v_mfma_f32_32x32x16_bf16 v[112:127], v[60:63], v[52:55], v[112:127]
    s_waitcnt lgkmcnt(0)
    s_waitcnt vmcnt(0)
    v_mfma_f32_32x32x16_bf16 v[64:79], v[136:139], v[128:131], v[64:79]
    ds_write_b128 v10, v[16:19] offset:0
    ds_write_b128 v10, v[20:23] offset:4608
    v_mfma_f32_32x32x16_bf16 v[80:95], v[140:143], v[128:131], v[80:95]
    ds_write_b128 v10, v[24:27] offset:9216
    ds_write_b128 v10, v[28:31] offset:13824
    v_mfma_f32_32x32x16_bf16 v[96:111], v[136:139], v[132:135], v[96:111]
    ds_write_b128 v10, v[32:35] offset:18432
    ds_write_b128 v10, v[36:39] offset:23040
    v_mfma_f32_32x32x16_bf16 v[112:127], v[140:143], v[132:135], v[112:127]
    ds_write_b128 v10, v[40:43] offset:27648
    ds_write_b128 v10, v[44:47] offset:32256
    s_waitcnt lgkmcnt(0)
    s_barrier
    s_add_u32 s16, s16, 128
    s_add_u32 s17, s17, 128
    s_add_u32 s25, s16, 40960
    s_add_u32 s28, s17, 40960
    s_add_u32 s26, s16, 81920
    s_add_u32 s29, s17, 81920
    s_add_u32 s27, s16, 122880
    s_add_u32 s30, s17, 122880
    buffer_load_dwordx4 v[16:19], v1, s[8:11], s16 offen offset:0
    buffer_load_dwordx4 v[20:23], v1, s[8:11], s25 offen
    buffer_load_dwordx4 v[24:27], v1, s[8:11], s26 offen
    buffer_load_dwordx4 v[28:31], v1, s[8:11], s27 offen
    buffer_load_dwordx4 v[32:35], v1, s[12:15], s17 offen
    buffer_load_dwordx4 v[36:39], v1, s[12:15], s28 offen
    buffer_load_dwordx4 v[40:43], v1, s[12:15], s29 offen
    buffer_load_dwordx4 v[44:47], v1, s[12:15], s30 offen
    ds_read_b128 v[48:51], v11 offset:0
    ds_read_b128 v[52:55], v11 offset:4608
    ds_read_b128 v[56:59], v12 offset:0
    ds_read_b128 v[60:63], v12 offset:9216
    ds_read_b128 v[128:131], v11 offset:32
    ds_read_b128 v[132:135], v11 offset:4640
    ds_read_b128 v[136:139], v12 offset:32
    ds_read_b128 v[140:143], v12 offset:9248
    s_waitcnt lgkmcnt(4)
    v_mfma_f32_32x32x16_bf16 v[64:79], v[56:59], v[48:51], v[64:79]
    v_mfma_f32_32x32x16_bf16 v[80:95], v[60:63], v[48:51], v[80:95]
    v_mfma_f32_32x32x16_bf16 v[96:111], v[56:59], v[52:55], v[96:111]
    v_mfma_f32_32x32x16_bf16 v[112:127], v[60:63], v[52:55], v[112:127]
    ds_read_b128 v[48:51], v11 offset:64
    ds_read_b128 v[52:55], v11 offset:4672
    ds_read_b128 v[56:59], v12 offset:64
    ds_read_b128 v[60:63], v12 offset:9280
    s_waitcnt lgkmcnt(4)
    v_mfma_f32_32x32x16_bf16 v[64:79], v[136:139], v[128:131], v[64:79]
    v_mfma_f32_32x32x16_bf16 v[80:95], v[140:143], v[128:131], v[80:95]
    v_mfma_f32_32x32x16_bf16 v[96:111], v[136:139], v[132:135], v[96:111]
    v_mfma_f32_32x32x16_bf16 v[112:127], v[140:143], v[132:135], v[112:127]
    ds_read_b128 v[128:131], v11 offset:96
    ds_read_b128 v[132:135], v11 offset:4704
    ds_read_b128 v[136:139], v12 offset:96
    ds_read_b128 v[140:143], v12 offset:9312
    s_waitcnt lgkmcnt(4)
    v_mfma_f32_32x32x16_bf16 v[64:79], v[56:59], v[48:51], v[64:79]
    v_mfma_f32_32x32x16_bf16 v[80:95], v[60:63], v[48:51], v[80:95]
    v_mfma_f32_32x32x16_bf16 v[96:111], v[56:59], v[52:55], v[96:111]
    v_mfma_f32_32x32x16_bf16 v[112:127], v[60:63], v[52:55], v[112:127]
    s_waitcnt lgkmcnt(0)
    s_waitcnt vmcnt(0)
    v_mfma_f32_32x32x16_bf16 v[64:79], v[136:139], v[128:131], v[64:79]
    ds_write_b128 v2, v[16:19] offset:0
    ds_write_b128 v2, v[20:23] offset:4608
    v_mfma_f32_32x32x16_bf16 v[80:95], v[140:143], v[128:131], v[80:95]
    ds_write_b128 v2, v[24:27] offset:9216
    ds_write_b128 v2, v[28:31] offset:13824
    v_mfma_f32_32x32x16_bf16 v[96:111], v[136:139], v[132:135], v[96:111]
    ds_write_b128 v2, v[32:35] offset:18432
    ds_write_b128 v2, v[36:39] offset:23040
    v_mfma_f32_32x32x16_bf16 v[112:127], v[140:143], v[132:135], v[112:127]
    ds_write_b128 v2, v[40:43] offset:27648
    ds_write_b128 v2, v[44:47] offset:32256
    s_waitcnt lgkmcnt(0)
    s_barrier
    s_add_u32 s16, s16, 128
    s_add_u32 s17, s17, 128
    s_add_u32 s25, s16, 40960
    s_add_u32 s28, s17, 40960
    s_add_u32 s26, s16, 81920
    s_add_u32 s29, s17, 81920
    s_add_u32 s27, s16, 122880
    s_add_u32 s30, s17, 122880
    buffer_load_dwordx4 v[16:19], v1, s[8:11], s16 offen offset:0
    buffer_load_dwordx4 v[20:23], v1, s[8:11], s25 offen
    buffer_load_dwordx4 v[24:27], v1, s[8:11], s26 offen
    buffer_load_dwordx4 v[28:31], v1, s[8:11], s27 offen
    buffer_load_dwordx4 v[32:35], v1, s[12:15], s17 offen
    buffer_load_dwordx4 v[36:39], v1, s[12:15], s28 offen
    buffer_load_dwordx4 v[40:43], v1, s[12:15], s29 offen
    buffer_load_dwordx4 v[44:47], v1, s[12:15], s30 offen
    ds_read_b128 v[48:51], v3 offset:0
    ds_read_b128 v[52:55], v3 offset:4608
    ds_read_b128 v[56:59], v4 offset:0
    ds_read_b128 v[60:63], v4 offset:9216
    ds_read_b128 v[128:131], v3 offset:32
    ds_read_b128 v[132:135], v3 offset:4640
    ds_read_b128 v[136:139], v4 offset:32
    ds_read_b128 v[140:143], v4 offset:9248
    s_waitcnt lgkmcnt(4)
    v_mfma_f32_32x32x16_bf16 v[64:79], v[56:59], v[48:51], v[64:79]
    v_mfma_f32_32x32x16_bf16 v[80:95], v[60:63], v[48:51], v[80:95]
    v_mfma_f32_32x32x16_bf16 v[96:111], v[56:59], v[52:55], v[96:111]
    v_mfma_f32_32x32x16_bf16 v[112:127], v[60:63], v[52:55], v[112:127]
    ds_read_b128 v[48:51], v3 offset:64
    ds_read_b128 v[52:55], v3 offset:4672
    ds_read_b128 v[56:59], v4 offset:64
    ds_read_b128 v[60:63], v4 offset:9280
    s_waitcnt lgkmcnt(4)
    v_mfma_f32_32x32x16_bf16 v[64:79], v[136:139], v[128:131], v[64:79]
    v_mfma_f32_32x32x16_bf16 v[80:95], v[140:143], v[128:131], v[80:95]
    v_mfma_f32_32x32x16_bf16 v[96:111], v[136:139], v[132:135], v[96:111]
    v_mfma_f32_32x32x16_bf16 v[112:127], v[140:143], v[132:135], v[112:127]
    ds_read_b128 v[128:131], v3 offset:96
    ds_read_b128 v[132:135], v3 offset:4704
    ds_read_b128 v[136:139], v4 offset:96
    ds_read_b128 v[140:143], v4 offset:9312
    s_waitcnt lgkmcnt(4)
    v_mfma_f32_32x32x16_bf16 v[64:79], v[56:59], v[48:51], v[64:79]
    v_mfma_f32_32x32x16_bf16 v[80:95], v[60:63], v[48:51], v[80:95]
    v_mfma_f32_32x32x16_bf16 v[96:111], v[56:59], v[52:55], v[96:111]
    v_mfma_f32_32x32x16_bf16 v[112:127], v[60:63], v[52:55], v[112:127]
    s_waitcnt lgkmcnt(0)
    s_waitcnt vmcnt(0)
    v_mfma_f32_32x32x16_bf16 v[64:79], v[136:139], v[128:131], v[64:79]
    ds_write_b128 v10, v[16:19] offset:0
    ds_write_b128 v10, v[20:23] offset:4608
    v_mfma_f32_32x32x16_bf16 v[80:95], v[140:143], v[128:131], v[80:95]
    ds_write_b128 v10, v[24:27] offset:9216
    ds_write_b128 v10, v[28:31] offset:13824
    v_mfma_f32_32x32x16_bf16 v[96:111], v[136:139], v[132:135], v[96:111]
    ds_write_b128 v10, v[32:35] offset:18432
    ds_write_b128 v10, v[36:39] offset:23040
    v_mfma_f32_32x32x16_bf16 v[112:127], v[140:143], v[132:135], v[112:127]
    ds_write_b128 v10, v[40:43] offset:27648
    ds_write_b128 v10, v[44:47] offset:32256
    s_waitcnt lgkmcnt(0)
    s_barrier
    ds_read_b128 v[48:51], v11 offset:0
    ds_read_b128 v[52:55], v11 offset:4608
    ds_read_b128 v[56:59], v12 offset:0
    ds_read_b128 v[60:63], v12 offset:9216
    ds_read_b128 v[128:131], v11 offset:32
    ds_read_b128 v[132:135], v11 offset:4640
    ds_read_b128 v[136:139], v12 offset:32
    ds_read_b128 v[140:143], v12 offset:9248
    s_waitcnt lgkmcnt(4)
    v_mfma_f32_32x32x16_bf16 v[64:79], v[56:59], v[48:51], v[64:79]
    v_mfma_f32_32x32x16_bf16 v[80:95], v[60:63], v[48:51], v[80:95]
    v_mfma_f32_32x32x16_bf16 v[96:111], v[56:59], v[52:55], v[96:111]
    v_mfma_f32_32x32x16_bf16 v[112:127], v[60:63], v[52:55], v[112:127]
    ds_read_b128 v[48:51], v11 offset:64
    ds_read_b128 v[52:55], v11 offset:4672
    ds_read_b128 v[56:59], v12 offset:64
    ds_read_b128 v[60:63], v12 offset:9280
    s_waitcnt lgkmcnt(4)
    v_mfma_f32_32x32x16_bf16 v[64:79], v[136:139], v[128:131], v[64:79]
    v_mfma_f32_32x32x16_bf16 v[80:95], v[140:143], v[128:131], v[80:95]
    v_mfma_f32_32x32x16_bf16 v[96:111], v[136:139], v[132:135], v[96:111]
    v_mfma_f32_32x32x16_bf16 v[112:127], v[140:143], v[132:135], v[112:127]
    ds_read_b128 v[128:131], v11 offset:96
    ds_read_b128 v[132:135], v11 offset:4704
    ds_read_b128 v[136:139], v12 offset:96
    ds_read_b128 v[140:143], v12 offset:9312
    s_waitcnt lgkmcnt(4)
    v_mfma_f32_32x32x16_bf16 v[64:79], v[56:59], v[48:51], v[64:79]
    v_mfma_f32_32x32x16_bf16 v[80:95], v[60:63], v[48:51], v[80:95]
    v_mfma_f32_32x32x16_bf16 v[96:111], v[56:59], v[52:55], v[96:111]
    v_mfma_f32_32x32x16_bf16 v[112:127], v[60:63], v[52:55], v[112:127]
    s_waitcnt lgkmcnt(0)
    v_mfma_f32_32x32x16_bf16 v[64:79], v[136:139], v[128:131], v[64:79]
    v_mfma_f32_32x32x16_bf16 v[80:95], v[140:143], v[128:131], v[80:95]
    v_mfma_f32_32x32x16_bf16 v[96:111], v[136:139], v[132:135], v[96:111]
    v_mfma_f32_32x32x16_bf16 v[112:127], v[140:143], v[132:135], v[112:127]
    s_nop 7
    s_nop 7
    v_lshrrev_b32 v5, 6, v0
    v_and_b32 v6, 31, v0
    v_lshrrev_b32 v7, 5, v0
    v_and_b32 v7, 1, v7
    v_lshrrev_b32 v8, 1, v5
    v_and_b32 v9, 1, v5
    v_lshl_add_u32 v8, v8, 6, v6
    s_mov_b32 s3, 18874368
    s_add_u32 s8, s4, s3
    s_addc_u32 s9, s5, 0
    s_mov_b32 s10, 7077888
    s_mov_b32 s11, 0x00020000
    s_mov_b32 s19, 3456
    v_mul_lo_u32 v8, v8, s19
    v_lshl_add_u32 v9, v9, 0, v9
    v_and_b32 v9, 1, v5
    v_lshlrev_b32 v9, 6, v9
    v_lshl_add_u32 v9, v7, 3, v9
    v_add_u32 v8, v8, v9
    s_mul_i32 s16, s20, 442368
    s_lshl_b32 s17, s21, 7
    s_add_u32 s16, s16, s17
    v_cvt_pk_bf16_f32 v64, v64, v64
    v_lshlrev_b32 v64, 16, v64
    v_cvt_pk_bf16_f32 v80, v80, v80
    v_lshlrev_b32 v80, 16, v80
    v_mul_f32 v12, 0xbfb8aa3b, v64
    v_exp_f32 v12, v12
    s_nop 0
    v_add_f32 v12, 1.0, v12
    v_rcp_f32 v12, v12
    s_nop 0
    v_mul_f32 v12, v64, v12
    v_cvt_pk_bf16_f32 v12, v12, v12
    v_lshlrev_b32 v12, 16, v12
    v_mul_f32 v12, v12, v80
    v_cvt_pk_bf16_f32 v65, v65, v65
    v_lshlrev_b32 v65, 16, v65
    v_cvt_pk_bf16_f32 v81, v81, v81
    v_lshlrev_b32 v81, 16, v81
    v_mul_f32 v13, 0xbfb8aa3b, v65
    v_exp_f32 v13, v13
    s_nop 0
    v_add_f32 v13, 1.0, v13
    v_rcp_f32 v13, v13
    s_nop 0
    v_mul_f32 v13, v65, v13
    v_cvt_pk_bf16_f32 v13, v13, v13
    v_lshlrev_b32 v13, 16, v13
    v_mul_f32 v13, v13, v81
    v_cvt_pk_bf16_f32 v66, v66, v66
    v_lshlrev_b32 v66, 16, v66
    v_cvt_pk_bf16_f32 v82, v82, v82
    v_lshlrev_b32 v82, 16, v82
    v_mul_f32 v14, 0xbfb8aa3b, v66
    v_exp_f32 v14, v14
    s_nop 0
    v_add_f32 v14, 1.0, v14
    v_rcp_f32 v14, v14
    s_nop 0
    v_mul_f32 v14, v66, v14
    v_cvt_pk_bf16_f32 v14, v14, v14
    v_lshlrev_b32 v14, 16, v14
    v_mul_f32 v14, v14, v82
    v_cvt_pk_bf16_f32 v67, v67, v67
    v_lshlrev_b32 v67, 16, v67
    v_cvt_pk_bf16_f32 v83, v83, v83
    v_lshlrev_b32 v83, 16, v83
    v_mul_f32 v15, 0xbfb8aa3b, v67
    v_exp_f32 v15, v15
    s_nop 0
    v_add_f32 v15, 1.0, v15
    v_rcp_f32 v15, v15
    s_nop 0
    v_mul_f32 v15, v67, v15
    v_cvt_pk_bf16_f32 v15, v15, v15
    v_lshlrev_b32 v15, 16, v15
    v_mul_f32 v15, v15, v83
    v_cvt_pk_bf16_f32 v16, v12, v13
    v_cvt_pk_bf16_f32 v17, v14, v15
    s_add_u32 s17, s16, 0
    buffer_store_dwordx2 v[16:17], v8, s[8:11], s17 offen
    s_nop 0
    v_cvt_pk_bf16_f32 v68, v68, v68
    v_lshlrev_b32 v68, 16, v68
    v_cvt_pk_bf16_f32 v84, v84, v84
    v_lshlrev_b32 v84, 16, v84
    v_mul_f32 v12, 0xbfb8aa3b, v68
    v_exp_f32 v12, v12
    s_nop 0
    v_add_f32 v12, 1.0, v12
    v_rcp_f32 v12, v12
    s_nop 0
    v_mul_f32 v12, v68, v12
    v_cvt_pk_bf16_f32 v12, v12, v12
    v_lshlrev_b32 v12, 16, v12
    v_mul_f32 v12, v12, v84
    v_cvt_pk_bf16_f32 v69, v69, v69
    v_lshlrev_b32 v69, 16, v69
    v_cvt_pk_bf16_f32 v85, v85, v85
    v_lshlrev_b32 v85, 16, v85
    v_mul_f32 v13, 0xbfb8aa3b, v69
    v_exp_f32 v13, v13
    s_nop 0
    v_add_f32 v13, 1.0, v13
    v_rcp_f32 v13, v13
    s_nop 0
    v_mul_f32 v13, v69, v13
    v_cvt_pk_bf16_f32 v13, v13, v13
    v_lshlrev_b32 v13, 16, v13
    v_mul_f32 v13, v13, v85
    v_cvt_pk_bf16_f32 v70, v70, v70
    v_lshlrev_b32 v70, 16, v70
    v_cvt_pk_bf16_f32 v86, v86, v86
    v_lshlrev_b32 v86, 16, v86
    v_mul_f32 v14, 0xbfb8aa3b, v70
    v_exp_f32 v14, v14
    s_nop 0
    v_add_f32 v14, 1.0, v14
    v_rcp_f32 v14, v14
    s_nop 0
    v_mul_f32 v14, v70, v14
    v_cvt_pk_bf16_f32 v14, v14, v14
    v_lshlrev_b32 v14, 16, v14
    v_mul_f32 v14, v14, v86
    v_cvt_pk_bf16_f32 v71, v71, v71
    v_lshlrev_b32 v71, 16, v71
    v_cvt_pk_bf16_f32 v87, v87, v87
    v_lshlrev_b32 v87, 16, v87
    v_mul_f32 v15, 0xbfb8aa3b, v71
    v_exp_f32 v15, v15
    s_nop 0
    v_add_f32 v15, 1.0, v15
    v_rcp_f32 v15, v15
    s_nop 0
    v_mul_f32 v15, v71, v15
    v_cvt_pk_bf16_f32 v15, v15, v15
    v_lshlrev_b32 v15, 16, v15
    v_mul_f32 v15, v15, v87
    v_cvt_pk_bf16_f32 v16, v12, v13
    v_cvt_pk_bf16_f32 v17, v14, v15
    s_add_u32 s17, s16, 16
    buffer_store_dwordx2 v[16:17], v8, s[8:11], s17 offen
    s_nop 0
    v_cvt_pk_bf16_f32 v72, v72, v72
    v_lshlrev_b32 v72, 16, v72
    v_cvt_pk_bf16_f32 v88, v88, v88
    v_lshlrev_b32 v88, 16, v88
    v_mul_f32 v12, 0xbfb8aa3b, v72
    v_exp_f32 v12, v12
    s_nop 0
    v_add_f32 v12, 1.0, v12
    v_rcp_f32 v12, v12
    s_nop 0
    v_mul_f32 v12, v72, v12
    v_cvt_pk_bf16_f32 v12, v12, v12
    v_lshlrev_b32 v12, 16, v12
    v_mul_f32 v12, v12, v88
    v_cvt_pk_bf16_f32 v73, v73, v73
    v_lshlrev_b32 v73, 16, v73
    v_cvt_pk_bf16_f32 v89, v89, v89
    v_lshlrev_b32 v89, 16, v89
    v_mul_f32 v13, 0xbfb8aa3b, v73
    v_exp_f32 v13, v13
    s_nop 0
    v_add_f32 v13, 1.0, v13
    v_rcp_f32 v13, v13
    s_nop 0
    v_mul_f32 v13, v73, v13
    v_cvt_pk_bf16_f32 v13, v13, v13
    v_lshlrev_b32 v13, 16, v13
    v_mul_f32 v13, v13, v89
    v_cvt_pk_bf16_f32 v74, v74, v74
    v_lshlrev_b32 v74, 16, v74
    v_cvt_pk_bf16_f32 v90, v90, v90
    v_lshlrev_b32 v90, 16, v90
    v_mul_f32 v14, 0xbfb8aa3b, v74
    v_exp_f32 v14, v14
    s_nop 0
    v_add_f32 v14, 1.0, v14
    v_rcp_f32 v14, v14
    s_nop 0
    v_mul_f32 v14, v74, v14
    v_cvt_pk_bf16_f32 v14, v14, v14
    v_lshlrev_b32 v14, 16, v14
    v_mul_f32 v14, v14, v90
    v_cvt_pk_bf16_f32 v75, v75, v75
    v_lshlrev_b32 v75, 16, v75
    v_cvt_pk_bf16_f32 v91, v91, v91
    v_lshlrev_b32 v91, 16, v91
    v_mul_f32 v15, 0xbfb8aa3b, v75
    v_exp_f32 v15, v15
    s_nop 0
    v_add_f32 v15, 1.0, v15
    v_rcp_f32 v15, v15
    s_nop 0
    v_mul_f32 v15, v75, v15
    v_cvt_pk_bf16_f32 v15, v15, v15
    v_lshlrev_b32 v15, 16, v15
    v_mul_f32 v15, v15, v91
    v_cvt_pk_bf16_f32 v16, v12, v13
    v_cvt_pk_bf16_f32 v17, v14, v15
    s_add_u32 s17, s16, 32
    buffer_store_dwordx2 v[16:17], v8, s[8:11], s17 offen
    s_nop 0
    v_cvt_pk_bf16_f32 v76, v76, v76
    v_lshlrev_b32 v76, 16, v76
    v_cvt_pk_bf16_f32 v92, v92, v92
    v_lshlrev_b32 v92, 16, v92
    v_mul_f32 v12, 0xbfb8aa3b, v76
    v_exp_f32 v12, v12
    s_nop 0
    v_add_f32 v12, 1.0, v12
    v_rcp_f32 v12, v12
    s_nop 0
    v_mul_f32 v12, v76, v12
    v_cvt_pk_bf16_f32 v12, v12, v12
    v_lshlrev_b32 v12, 16, v12
    v_mul_f32 v12, v12, v92
    v_cvt_pk_bf16_f32 v77, v77, v77
    v_lshlrev_b32 v77, 16, v77
    v_cvt_pk_bf16_f32 v93, v93, v93
    v_lshlrev_b32 v93, 16, v93
    v_mul_f32 v13, 0xbfb8aa3b, v77
    v_exp_f32 v13, v13
    s_nop 0
    v_add_f32 v13, 1.0, v13
    v_rcp_f32 v13, v13
    s_nop 0
    v_mul_f32 v13, v77, v13
    v_cvt_pk_bf16_f32 v13, v13, v13
    v_lshlrev_b32 v13, 16, v13
    v_mul_f32 v13, v13, v93
    v_cvt_pk_bf16_f32 v78, v78, v78
    v_lshlrev_b32 v78, 16, v78
    v_cvt_pk_bf16_f32 v94, v94, v94
    v_lshlrev_b32 v94, 16, v94
    v_mul_f32 v14, 0xbfb8aa3b, v78
    v_exp_f32 v14, v14
    s_nop 0
    v_add_f32 v14, 1.0, v14
    v_rcp_f32 v14, v14
    s_nop 0
    v_mul_f32 v14, v78, v14
    v_cvt_pk_bf16_f32 v14, v14, v14
    v_lshlrev_b32 v14, 16, v14
    v_mul_f32 v14, v14, v94
    v_cvt_pk_bf16_f32 v79, v79, v79
    v_lshlrev_b32 v79, 16, v79
    v_cvt_pk_bf16_f32 v95, v95, v95
    v_lshlrev_b32 v95, 16, v95
    v_mul_f32 v15, 0xbfb8aa3b, v79
    v_exp_f32 v15, v15
    s_nop 0
    v_add_f32 v15, 1.0, v15
    v_rcp_f32 v15, v15
    s_nop 0
    v_mul_f32 v15, v79, v15
    v_cvt_pk_bf16_f32 v15, v15, v15
    v_lshlrev_b32 v15, 16, v15
    v_mul_f32 v15, v15, v95
    v_cvt_pk_bf16_f32 v16, v12, v13
    v_cvt_pk_bf16_f32 v17, v14, v15
    s_add_u32 s17, s16, 48
    buffer_store_dwordx2 v[16:17], v8, s[8:11], s17 offen
    s_nop 0
    v_cvt_pk_bf16_f32 v96, v96, v96
    v_lshlrev_b32 v96, 16, v96
    v_cvt_pk_bf16_f32 v112, v112, v112
    v_lshlrev_b32 v112, 16, v112
    v_mul_f32 v12, 0xbfb8aa3b, v96
    v_exp_f32 v12, v12
    s_nop 0
    v_add_f32 v12, 1.0, v12
    v_rcp_f32 v12, v12
    s_nop 0
    v_mul_f32 v12, v96, v12
    v_cvt_pk_bf16_f32 v12, v12, v12
    v_lshlrev_b32 v12, 16, v12
    v_mul_f32 v12, v12, v112
    v_cvt_pk_bf16_f32 v97, v97, v97
    v_lshlrev_b32 v97, 16, v97
    v_cvt_pk_bf16_f32 v113, v113, v113
    v_lshlrev_b32 v113, 16, v113
    v_mul_f32 v13, 0xbfb8aa3b, v97
    v_exp_f32 v13, v13
    s_nop 0
    v_add_f32 v13, 1.0, v13
    v_rcp_f32 v13, v13
    s_nop 0
    v_mul_f32 v13, v97, v13
    v_cvt_pk_bf16_f32 v13, v13, v13
    v_lshlrev_b32 v13, 16, v13
    v_mul_f32 v13, v13, v113
    v_cvt_pk_bf16_f32 v98, v98, v98
    v_lshlrev_b32 v98, 16, v98
    v_cvt_pk_bf16_f32 v114, v114, v114
    v_lshlrev_b32 v114, 16, v114
    v_mul_f32 v14, 0xbfb8aa3b, v98
    v_exp_f32 v14, v14
    s_nop 0
    v_add_f32 v14, 1.0, v14
    v_rcp_f32 v14, v14
    s_nop 0
    v_mul_f32 v14, v98, v14
    v_cvt_pk_bf16_f32 v14, v14, v14
    v_lshlrev_b32 v14, 16, v14
    v_mul_f32 v14, v14, v114
    v_cvt_pk_bf16_f32 v99, v99, v99
    v_lshlrev_b32 v99, 16, v99
    v_cvt_pk_bf16_f32 v115, v115, v115
    v_lshlrev_b32 v115, 16, v115
    v_mul_f32 v15, 0xbfb8aa3b, v99
    v_exp_f32 v15, v15
    s_nop 0
    v_add_f32 v15, 1.0, v15
    v_rcp_f32 v15, v15
    s_nop 0
    v_mul_f32 v15, v99, v15
    v_cvt_pk_bf16_f32 v15, v15, v15
    v_lshlrev_b32 v15, 16, v15
    v_mul_f32 v15, v15, v115
    v_cvt_pk_bf16_f32 v16, v12, v13
    v_cvt_pk_bf16_f32 v17, v14, v15
    s_add_u32 s17, s16, 110592
    buffer_store_dwordx2 v[16:17], v8, s[8:11], s17 offen
    s_nop 0
    v_cvt_pk_bf16_f32 v100, v100, v100
    v_lshlrev_b32 v100, 16, v100
    v_cvt_pk_bf16_f32 v116, v116, v116
    v_lshlrev_b32 v116, 16, v116
    v_mul_f32 v12, 0xbfb8aa3b, v100
    v_exp_f32 v12, v12
    s_nop 0
    v_add_f32 v12, 1.0, v12
    v_rcp_f32 v12, v12
    s_nop 0
    v_mul_f32 v12, v100, v12
    v_cvt_pk_bf16_f32 v12, v12, v12
    v_lshlrev_b32 v12, 16, v12
    v_mul_f32 v12, v12, v116
    v_cvt_pk_bf16_f32 v101, v101, v101
    v_lshlrev_b32 v101, 16, v101
    v_cvt_pk_bf16_f32 v117, v117, v117
    v_lshlrev_b32 v117, 16, v117
    v_mul_f32 v13, 0xbfb8aa3b, v101
    v_exp_f32 v13, v13
    s_nop 0
    v_add_f32 v13, 1.0, v13
    v_rcp_f32 v13, v13
    s_nop 0
    v_mul_f32 v13, v101, v13
    v_cvt_pk_bf16_f32 v13, v13, v13
    v_lshlrev_b32 v13, 16, v13
    v_mul_f32 v13, v13, v117
    v_cvt_pk_bf16_f32 v102, v102, v102
    v_lshlrev_b32 v102, 16, v102
    v_cvt_pk_bf16_f32 v118, v118, v118
    v_lshlrev_b32 v118, 16, v118
    v_mul_f32 v14, 0xbfb8aa3b, v102
    v_exp_f32 v14, v14
    s_nop 0
    v_add_f32 v14, 1.0, v14
    v_rcp_f32 v14, v14
    s_nop 0
    v_mul_f32 v14, v102, v14
    v_cvt_pk_bf16_f32 v14, v14, v14
    v_lshlrev_b32 v14, 16, v14
    v_mul_f32 v14, v14, v118
    v_cvt_pk_bf16_f32 v103, v103, v103
    v_lshlrev_b32 v103, 16, v103
    v_cvt_pk_bf16_f32 v119, v119, v119
    v_lshlrev_b32 v119, 16, v119
    v_mul_f32 v15, 0xbfb8aa3b, v103
    v_exp_f32 v15, v15
    s_nop 0
    v_add_f32 v15, 1.0, v15
    v_rcp_f32 v15, v15
    s_nop 0
    v_mul_f32 v15, v103, v15
    v_cvt_pk_bf16_f32 v15, v15, v15
    v_lshlrev_b32 v15, 16, v15
    v_mul_f32 v15, v15, v119
    v_cvt_pk_bf16_f32 v16, v12, v13
    v_cvt_pk_bf16_f32 v17, v14, v15
    s_add_u32 s17, s16, 110608
    buffer_store_dwordx2 v[16:17], v8, s[8:11], s17 offen
    s_nop 0
    v_cvt_pk_bf16_f32 v104, v104, v104
    v_lshlrev_b32 v104, 16, v104
    v_cvt_pk_bf16_f32 v120, v120, v120
    v_lshlrev_b32 v120, 16, v120
    v_mul_f32 v12, 0xbfb8aa3b, v104
    v_exp_f32 v12, v12
    s_nop 0
    v_add_f32 v12, 1.0, v12
    v_rcp_f32 v12, v12
    s_nop 0
    v_mul_f32 v12, v104, v12
    v_cvt_pk_bf16_f32 v12, v12, v12
    v_lshlrev_b32 v12, 16, v12
    v_mul_f32 v12, v12, v120
    v_cvt_pk_bf16_f32 v105, v105, v105
    v_lshlrev_b32 v105, 16, v105
    v_cvt_pk_bf16_f32 v121, v121, v121
    v_lshlrev_b32 v121, 16, v121
    v_mul_f32 v13, 0xbfb8aa3b, v105
    v_exp_f32 v13, v13
    s_nop 0
    v_add_f32 v13, 1.0, v13
    v_rcp_f32 v13, v13
    s_nop 0
    v_mul_f32 v13, v105, v13
    v_cvt_pk_bf16_f32 v13, v13, v13
    v_lshlrev_b32 v13, 16, v13
    v_mul_f32 v13, v13, v121
    v_cvt_pk_bf16_f32 v106, v106, v106
    v_lshlrev_b32 v106, 16, v106
    v_cvt_pk_bf16_f32 v122, v122, v122
    v_lshlrev_b32 v122, 16, v122
    v_mul_f32 v14, 0xbfb8aa3b, v106
    v_exp_f32 v14, v14
    s_nop 0
    v_add_f32 v14, 1.0, v14
    v_rcp_f32 v14, v14
    s_nop 0
    v_mul_f32 v14, v106, v14
    v_cvt_pk_bf16_f32 v14, v14, v14
    v_lshlrev_b32 v14, 16, v14
    v_mul_f32 v14, v14, v122
    v_cvt_pk_bf16_f32 v107, v107, v107
    v_lshlrev_b32 v107, 16, v107
    v_cvt_pk_bf16_f32 v123, v123, v123
    v_lshlrev_b32 v123, 16, v123
    v_mul_f32 v15, 0xbfb8aa3b, v107
    v_exp_f32 v15, v15
    s_nop 0
    v_add_f32 v15, 1.0, v15
    v_rcp_f32 v15, v15
    s_nop 0
    v_mul_f32 v15, v107, v15
    v_cvt_pk_bf16_f32 v15, v15, v15
    v_lshlrev_b32 v15, 16, v15
    v_mul_f32 v15, v15, v123
    v_cvt_pk_bf16_f32 v16, v12, v13
    v_cvt_pk_bf16_f32 v17, v14, v15
    s_add_u32 s17, s16, 110624
    buffer_store_dwordx2 v[16:17], v8, s[8:11], s17 offen
    s_nop 0
    v_cvt_pk_bf16_f32 v108, v108, v108
    v_lshlrev_b32 v108, 16, v108
    v_cvt_pk_bf16_f32 v124, v124, v124
    v_lshlrev_b32 v124, 16, v124
    v_mul_f32 v12, 0xbfb8aa3b, v108
    v_exp_f32 v12, v12
    s_nop 0
    v_add_f32 v12, 1.0, v12
    v_rcp_f32 v12, v12
    s_nop 0
    v_mul_f32 v12, v108, v12
    v_cvt_pk_bf16_f32 v12, v12, v12
    v_lshlrev_b32 v12, 16, v12
    v_mul_f32 v12, v12, v124
    v_cvt_pk_bf16_f32 v109, v109, v109
    v_lshlrev_b32 v109, 16, v109
    v_cvt_pk_bf16_f32 v125, v125, v125
    v_lshlrev_b32 v125, 16, v125
    v_mul_f32 v13, 0xbfb8aa3b, v109
    v_exp_f32 v13, v13
    s_nop 0
    v_add_f32 v13, 1.0, v13
    v_rcp_f32 v13, v13
    s_nop 0
    v_mul_f32 v13, v109, v13
    v_cvt_pk_bf16_f32 v13, v13, v13
    v_lshlrev_b32 v13, 16, v13
    v_mul_f32 v13, v13, v125
    v_cvt_pk_bf16_f32 v110, v110, v110
    v_lshlrev_b32 v110, 16, v110
    v_cvt_pk_bf16_f32 v126, v126, v126
    v_lshlrev_b32 v126, 16, v126
    v_mul_f32 v14, 0xbfb8aa3b, v110
    v_exp_f32 v14, v14
    s_nop 0
    v_add_f32 v14, 1.0, v14
    v_rcp_f32 v14, v14
    s_nop 0
    v_mul_f32 v14, v110, v14
    v_cvt_pk_bf16_f32 v14, v14, v14
    v_lshlrev_b32 v14, 16, v14
    v_mul_f32 v14, v14, v126
    v_cvt_pk_bf16_f32 v111, v111, v111
    v_lshlrev_b32 v111, 16, v111
    v_cvt_pk_bf16_f32 v127, v127, v127
    v_lshlrev_b32 v127, 16, v127
    v_mul_f32 v15, 0xbfb8aa3b, v111
    v_exp_f32 v15, v15
    s_nop 0
    v_add_f32 v15, 1.0, v15
    v_rcp_f32 v15, v15
    s_nop 0
    v_mul_f32 v15, v111, v15
    v_cvt_pk_bf16_f32 v15, v15, v15
    v_lshlrev_b32 v15, 16, v15
    v_mul_f32 v15, v15, v127
    v_cvt_pk_bf16_f32 v16, v12, v13
    v_cvt_pk_bf16_f32 v17, v14, v15
    s_add_u32 s17, s16, 110640
    buffer_store_dwordx2 v[16:17], v8, s[8:11], s17 offen
    s_nop 0
.Lg1a_kernel_end:
    s_endpgm
.globl g2a_kernel
.p2align 8
.type g2a_kernel,@function
g2a_kernel:
    s_cmp_ge_u32 s2, 240
    s_cbranch_scc1 .Lg2a_kernel_end
    s_load_dwordx2 s[4:5], s[0:1], 72
    s_and_b32 s18, s2, 7
    s_mul_i32 s18, s18, 30
    s_lshr_b32 s19, s2, 3
    s_add_u32 s18, s18, s19
    s_mul_i32 s20, s18, 4370
    s_lshr_b32 s20, s20, 16
    s_mul_i32 s21, s20, 15
    s_sub_u32 s21, s18, s21
    s_mul_i32 s22, s21, 21846
    s_lshr_b32 s22, s22, 16
    s_mul_i32 s23, s22, 3
    s_sub_u32 s23, s21, s23
    s_mov_b32 s21, s22
    s_waitcnt lgkmcnt(0)
    s_mov_b32 s3, 18874368
    s_add_u32 s8, s4, s3
    s_addc_u32 s9, s5, 0
    s_mov_b32 s10, 7077888
    s_mov_b32 s11, 0x00020000
    s_mov_b32 s3, 49283072
    s_add_u32 s12, s4, s3
    s_addc_u32 s13, s5, 0
    s_mov_b32 s14, 2211840
    s_mov_b32 s15, 0x00020000
    s_mul_i32 s16, s20, 442368
    s_mul_i32 s17, s21, 442368
    s_mul_i32 s18, s23, 1152
    s_add_u32 s16, s16, s18
    s_add_u32 s17, s17, s18
    v_lshrrev_b32 v5, 3, v0
    v_and_b32 v6, 7, v0
    s_mov_b32 s19, 3456
    v_mul_lo_u32 v1, v5, s19
    v_lshl_add_u32 v1, v6, 4, v1
    v_mul_u32_u24 v2, 144, v5
    v_lshl_add_u32 v2, v6, 4, v2
    v_lshrrev_b32 v5, 6, v0
    v_and_b32 v6, 31, v0
    v_lshrrev_b32 v7, 5, v0
    v_and_b32 v7, 1, v7
    v_lshrrev_b32 v8, 1, v5
    v_and_b32 v9, 1, v5
    v_lshl_add_u32 v8, v8, 6, v6
    v_mul_u32_u24 v3, 144, v8
    v_lshl_add_u32 v3, v7, 4, v3
    v_lshl_add_u32 v9, v9, 5, v6
    v_mul_u32_u24 v4, 144, v9
    v_lshl_add_u32 v4, v7, 4, v4
    v_add_u32 v4, 18432, v4
    v_add_u32 v10, 36864, v2
    v_add_u32 v11, 36864, v3
    v_add_u32 v12, 36864, v4
    v_mov_b32 v64, 0
    v_mov_b32 v65, 0
    v_mov_b32 v66, 0
    v_mov_b32 v67, 0
    v_mov_b32 v68, 0
    v_mov_b32 v69, 0
    v_mov_b32 v70, 0
    v_mov_b32 v71, 0
    v_mov_b32 v72, 0
    v_mov_b32 v73, 0
    v_mov_b32 v74, 0
    v_mov_b32 v75, 0
    v_mov_b32 v76, 0
    v_mov_b32 v77, 0
    v_mov_b32 v78, 0
    v_mov_b32 v79, 0
    v_mov_b32 v80, 0
    v_mov_b32 v81, 0
    v_mov_b32 v82, 0
    v_mov_b32 v83, 0
    v_mov_b32 v84, 0
    v_mov_b32 v85, 0
    v_mov_b32 v86, 0
    v_mov_b32 v87, 0
    v_mov_b32 v88, 0
    v_mov_b32 v89, 0
    v_mov_b32 v90, 0
    v_mov_b32 v91, 0
    v_mov_b32 v92, 0
    v_mov_b32 v93, 0
    v_mov_b32 v94, 0
    v_mov_b32 v95, 0
    v_mov_b32 v96, 0
    v_mov_b32 v97, 0
    v_mov_b32 v98, 0
    v_mov_b32 v99, 0
    v_mov_b32 v100, 0
    v_mov_b32 v101, 0
    v_mov_b32 v102, 0
    v_mov_b32 v103, 0
    v_mov_b32 v104, 0
    v_mov_b32 v105, 0
    v_mov_b32 v106, 0
    v_mov_b32 v107, 0
    v_mov_b32 v108, 0
    v_mov_b32 v109, 0
    v_mov_b32 v110, 0
    v_mov_b32 v111, 0
    v_mov_b32 v112, 0
    v_mov_b32 v113, 0
    v_mov_b32 v114, 0
    v_mov_b32 v115, 0
    v_mov_b32 v116, 0
    v_mov_b32 v117, 0
    v_mov_b32 v118, 0
    v_mov_b32 v119, 0
    v_mov_b32 v120, 0
    v_mov_b32 v121, 0
    v_mov_b32 v122, 0
    v_mov_b32 v123, 0
    v_mov_b32 v124, 0
    v_mov_b32 v125, 0
    v_mov_b32 v126, 0
    v_mov_b32 v127, 0
    s_add_u32 s25, s16, 110592
    s_add_u32 s28, s17, 110592
    s_add_u32 s26, s16, 221184
    s_add_u32 s29, s17, 221184
    s_add_u32 s27, s16, 331776
    s_add_u32 s30, s17, 331776
    buffer_load_dwordx4 v[16:19], v1, s[8:11], s16 offen offset:0
    buffer_load_dwordx4 v[20:23], v1, s[8:11], s25 offen
    buffer_load_dwordx4 v[24:27], v1, s[8:11], s26 offen
    buffer_load_dwordx4 v[28:31], v1, s[8:11], s27 offen
    buffer_load_dwordx4 v[32:35], v1, s[12:15], s17 offen
    buffer_load_dwordx4 v[36:39], v1, s[12:15], s28 offen
    buffer_load_dwordx4 v[40:43], v1, s[12:15], s29 offen
    buffer_load_dwordx4 v[44:47], v1, s[12:15], s30 offen
    s_waitcnt vmcnt(0)
    ds_write_b128 v2, v[16:19] offset:0
    ds_write_b128 v2, v[20:23] offset:4608
    ds_write_b128 v2, v[24:27] offset:9216
    ds_write_b128 v2, v[28:31] offset:13824
    ds_write_b128 v2, v[32:35] offset:18432
    ds_write_b128 v2, v[36:39] offset:23040
    ds_write_b128 v2, v[40:43] offset:27648
    ds_write_b128 v2, v[44:47] offset:32256
    s_waitcnt lgkmcnt(0)
    s_barrier
    s_add_u32 s16, s16, 128
    s_add_u32 s17, s17, 128
    s_add_u32 s25, s16, 110592
    s_add_u32 s28, s17, 110592
    s_add_u32 s26, s16, 221184
    s_add_u32 s29, s17, 221184
    s_add_u32 s27, s16, 331776
    s_add_u32 s30, s17, 331776
    buffer_load_dwordx4 v[16:19], v1, s[8:11], s16 offen offset:0
    buffer_load_dwordx4 v[20:23], v1, s[8:11], s25 offen
    buffer_load_dwordx4 v[24:27], v1, s[8:11], s26 offen
    buffer_load_dwordx4 v[28:31], v1, s[8:11], s27 offen
    buffer_load_dwordx4 v[32:35], v1, s[12:15], s17 offen
    buffer_load_dwordx4 v[36:39], v1, s[12:15], s28 offen
    buffer_load_dwordx4 v[40:43], v1, s[12:15], s29 offen
    buffer_load_dwordx4 v[44:47], v1, s[12:15], s30 offen
    ds_read_b128 v[48:51], v3 offset:0
    ds_read_b128 v[52:55], v3 offset:4608
    ds_read_b128 v[56:59], v4 offset:0
    ds_read_b128 v[60:63], v4 offset:9216
    ds_read_b128 v[128:131], v3 offset:32
    ds_read_b128 v[132:135], v3 offset:4640
    ds_read_b128 v[136:139], v4 offset:32
    ds_read_b128 v[140:143], v4 offset:9248
    s_waitcnt lgkmcnt(4)
    v_mfma_f32_32x32x16_bf16 v[64:79], v[56:59], v[48:51], v[64:79]
    v_mfma_f32_32x32x16_bf16 v[80:95], v[60:63], v[48:51], v[80:95]
    v_mfma_f32_32x32x16_bf16 v[96:111], v[56:59], v[52:55], v[96:111]
    v_mfma_f32_32x32x16_bf16 v[112:127], v[60:63], v[52:55], v[112:127]
    ds_read_b128 v[48:51], v3 offset:64
    ds_read_b128 v[52:55], v3 offset:4672
    ds_read_b128 v[56:59], v4 offset:64
    ds_read_b128 v[60:63], v4 offset:9280
    s_waitcnt lgkmcnt(4)
    v_mfma_f32_32x32x16_bf16 v[64:79], v[136:139], v[128:131], v[64:79]
    v_mfma_f32_32x32x16_bf16 v[80:95], v[140:143], v[128:131], v[80:95]
    v_mfma_f32_32x32x16_bf16 v[96:111], v[136:139], v[132:135], v[96:111]
    v_mfma_f32_32x32x16_bf16 v[112:127], v[140:143], v[132:135], v[112:127]
    ds_read_b128 v[128:131], v3 offset:96
    ds_read_b128 v[132:135], v3 offset:4704
    ds_read_b128 v[136:139], v4 offset:96
    ds_read_b128 v[140:143], v4 offset:9312
    s_waitcnt lgkmcnt(4)
    v_mfma_f32_32x32x16_bf16 v[64:79], v[56:59], v[48:51], v[64:79]
    v_mfma_f32_32x32x16_bf16 v[80:95], v[60:63], v[48:51], v[80:95]
    v_mfma_f32_32x32x16_bf16 v[96:111], v[56:59], v[52:55], v[96:111]
    v_mfma_f32_32x32x16_bf16 v[112:127], v[60:63], v[52:55], v[112:127]
    s_waitcnt lgkmcnt(0)
    s_waitcnt vmcnt(0)
    v_mfma_f32_32x32x16_bf16 v[64:79], v[136:139], v[128:131], v[64:79]
    ds_write_b128 v10, v[16:19] offset:0
    ds_write_b128 v10, v[20:23] offset:4608
    v_mfma_f32_32x32x16_bf16 v[80:95], v[140:143], v[128:131], v[80:95]
    ds_write_b128 v10, v[24:27] offset:9216
    ds_write_b128 v10, v[28:31] offset:13824
    v_mfma_f32_32x32x16_bf16 v[96:111], v[136:139], v[132:135], v[96:111]
    ds_write_b128 v10, v[32:35] offset:18432
    ds_write_b128 v10, v[36:39] offset:23040
    v_mfma_f32_32x32x16_bf16 v[112:127], v[140:143], v[132:135], v[112:127]
    ds_write_b128 v10, v[40:43] offset:27648
    ds_write_b128 v10, v[44:47] offset:32256
    s_waitcnt lgkmcnt(0)
    s_barrier
    s_add_u32 s16, s16, 128
    s_add_u32 s17, s17, 128
    s_add_u32 s25, s16, 110592
    s_add_u32 s28, s17, 110592
    s_add_u32 s26, s16, 221184
    s_add_u32 s29, s17, 221184
    s_add_u32 s27, s16, 331776
    s_add_u32 s30, s17, 331776
    buffer_load_dwordx4 v[16:19], v1, s[8:11], s16 offen offset:0
    buffer_load_dwordx4 v[20:23], v1, s[8:11], s25 offen
    buffer_load_dwordx4 v[24:27], v1, s[8:11], s26 offen
    buffer_load_dwordx4 v[28:31], v1, s[8:11], s27 offen
    buffer_load_dwordx4 v[32:35], v1, s[12:15], s17 offen
    buffer_load_dwordx4 v[36:39], v1, s[12:15], s28 offen
    buffer_load_dwordx4 v[40:43], v1, s[12:15], s29 offen
    buffer_load_dwordx4 v[44:47], v1, s[12:15], s30 offen
    ds_read_b128 v[48:51], v11 offset:0
    ds_read_b128 v[52:55], v11 offset:4608
    ds_read_b128 v[56:59], v12 offset:0
    ds_read_b128 v[60:63], v12 offset:9216
    ds_read_b128 v[128:131], v11 offset:32
    ds_read_b128 v[132:135], v11 offset:4640
    ds_read_b128 v[136:139], v12 offset:32
    ds_read_b128 v[140:143], v12 offset:9248
    s_waitcnt lgkmcnt(4)
    v_mfma_f32_32x32x16_bf16 v[64:79], v[56:59], v[48:51], v[64:79]
    v_mfma_f32_32x32x16_bf16 v[80:95], v[60:63], v[48:51], v[80:95]
    v_mfma_f32_32x32x16_bf16 v[96:111], v[56:59], v[52:55], v[96:111]
    v_mfma_f32_32x32x16_bf16 v[112:127], v[60:63], v[52:55], v[112:127]
    ds_read_b128 v[48:51], v11 offset:64
    ds_read_b128 v[52:55], v11 offset:4672
    ds_read_b128 v[56:59], v12 offset:64
    ds_read_b128 v[60:63], v12 offset:9280
    s_waitcnt lgkmcnt(4)
    v_mfma_f32_32x32x16_bf16 v[64:79], v[136:139], v[128:131], v[64:79]
    v_mfma_f32_32x32x16_bf16 v[80:95], v[140:143], v[128:131], v[80:95]
    v_mfma_f32_32x32x16_bf16 v[96:111], v[136:139], v[132:135], v[96:111]
    v_mfma_f32_32x32x16_bf16 v[112:127], v[140:143], v[132:135], v[112:127]
    ds_read_b128 v[128:131], v11 offset:96
    ds_read_b128 v[132:135], v11 offset:4704
    ds_read_b128 v[136:139], v12 offset:96
    ds_read_b128 v[140:143], v12 offset:9312
    s_waitcnt lgkmcnt(4)
    v_mfma_f32_32x32x16_bf16 v[64:79], v[56:59], v[48:51], v[64:79]
    v_mfma_f32_32x32x16_bf16 v[80:95], v[60:63], v[48:51], v[80:95]
    v_mfma_f32_32x32x16_bf16 v[96:111], v[56:59], v[52:55], v[96:111]
    v_mfma_f32_32x32x16_bf16 v[112:127], v[60:63], v[52:55], v[112:127]
    s_waitcnt lgkmcnt(0)
    s_waitcnt vmcnt(0)
    v_mfma_f32_32x32x16_bf16 v[64:79], v[136:139], v[128:131], v[64:79]
    ds_write_b128 v2, v[16:19] offset:0
    ds_write_b128 v2, v[20:23] offset:4608
    v_mfma_f32_32x32x16_bf16 v[80:95], v[140:143], v[128:131], v[80:95]
    ds_write_b128 v2, v[24:27] offset:9216
    ds_write_b128 v2, v[28:31] offset:13824
    v_mfma_f32_32x32x16_bf16 v[96:111], v[136:139], v[132:135], v[96:111]
    ds_write_b128 v2, v[32:35] offset:18432
    ds_write_b128 v2, v[36:39] offset:23040
    v_mfma_f32_32x32x16_bf16 v[112:127], v[140:143], v[132:135], v[112:127]
    ds_write_b128 v2, v[40:43] offset:27648
    ds_write_b128 v2, v[44:47] offset:32256
    s_waitcnt lgkmcnt(0)
    s_barrier
    s_add_u32 s16, s16, 128
    s_add_u32 s17, s17, 128
    s_add_u32 s25, s16, 110592
    s_add_u32 s28, s17, 110592
    s_add_u32 s26, s16, 221184
    s_add_u32 s29, s17, 221184
    s_add_u32 s27, s16, 331776
    s_add_u32 s30, s17, 331776
    buffer_load_dwordx4 v[16:19], v1, s[8:11], s16 offen offset:0
    buffer_load_dwordx4 v[20:23], v1, s[8:11], s25 offen
    buffer_load_dwordx4 v[24:27], v1, s[8:11], s26 offen
    buffer_load_dwordx4 v[28:31], v1, s[8:11], s27 offen
    buffer_load_dwordx4 v[32:35], v1, s[12:15], s17 offen
    buffer_load_dwordx4 v[36:39], v1, s[12:15], s28 offen
    buffer_load_dwordx4 v[40:43], v1, s[12:15], s29 offen
    buffer_load_dwordx4 v[44:47], v1, s[12:15], s30 offen
    ds_read_b128 v[48:51], v3 offset:0
    ds_read_b128 v[52:55], v3 offset:4608
    ds_read_b128 v[56:59], v4 offset:0
    ds_read_b128 v[60:63], v4 offset:9216
    ds_read_b128 v[128:131], v3 offset:32
    ds_read_b128 v[132:135], v3 offset:4640
    ds_read_b128 v[136:139], v4 offset:32
    ds_read_b128 v[140:143], v4 offset:9248
    s_waitcnt lgkmcnt(4)
    v_mfma_f32_32x32x16_bf16 v[64:79], v[56:59], v[48:51], v[64:79]
    v_mfma_f32_32x32x16_bf16 v[80:95], v[60:63], v[48:51], v[80:95]
    v_mfma_f32_32x32x16_bf16 v[96:111], v[56:59], v[52:55], v[96:111]
    v_mfma_f32_32x32x16_bf16 v[112:127], v[60:63], v[52:55], v[112:127]
    ds_read_b128 v[48:51], v3 offset:64
    ds_read_b128 v[52:55], v3 offset:4672
    ds_read_b128 v[56:59], v4 offset:64
    ds_read_b128 v[60:63], v4 offset:9280
    s_waitcnt lgkmcnt(4)
    v_mfma_f32_32x32x16_bf16 v[64:79], v[136:139], v[128:131], v[64:79]
    v_mfma_f32_32x32x16_bf16 v[80:95], v[140:143], v[128:131], v[80:95]
    v_mfma_f32_32x32x16_bf16 v[96:111], v[136:139], v[132:135], v[96:111]
    v_mfma_f32_32x32x16_bf16 v[112:127], v[140:143], v[132:135], v[112:127]
    ds_read_b128 v[128:131], v3 offset:96
    ds_read_b128 v[132:135], v3 offset:4704
    ds_read_b128 v[136:139], v4 offset:96
    ds_read_b128 v[140:143], v4 offset:9312
    s_waitcnt lgkmcnt(4)
    v_mfma_f32_32x32x16_bf16 v[64:79], v[56:59], v[48:51], v[64:79]
    v_mfma_f32_32x32x16_bf16 v[80:95], v[60:63], v[48:51], v[80:95]
    v_mfma_f32_32x32x16_bf16 v[96:111], v[56:59], v[52:55], v[96:111]
    v_mfma_f32_32x32x16_bf16 v[112:127], v[60:63], v[52:55], v[112:127]
    s_waitcnt lgkmcnt(0)
    s_waitcnt vmcnt(0)
    v_mfma_f32_32x32x16_bf16 v[64:79], v[136:139], v[128:131], v[64:79]
    ds_write_b128 v10, v[16:19] offset:0
    ds_write_b128 v10, v[20:23] offset:4608
    v_mfma_f32_32x32x16_bf16 v[80:95], v[140:143], v[128:131], v[80:95]
    ds_write_b128 v10, v[24:27] offset:9216
    ds_write_b128 v10, v[28:31] offset:13824
    v_mfma_f32_32x32x16_bf16 v[96:111], v[136:139], v[132:135], v[96:111]
    ds_write_b128 v10, v[32:35] offset:18432
    ds_write_b128 v10, v[36:39] offset:23040
    v_mfma_f32_32x32x16_bf16 v[112:127], v[140:143], v[132:135], v[112:127]
    ds_write_b128 v10, v[40:43] offset:27648
    ds_write_b128 v10, v[44:47] offset:32256
    s_waitcnt lgkmcnt(0)
    s_barrier
    s_add_u32 s16, s16, 128
    s_add_u32 s17, s17, 128
    s_add_u32 s25, s16, 110592
    s_add_u32 s28, s17, 110592
    s_add_u32 s26, s16, 221184
    s_add_u32 s29, s17, 221184
    s_add_u32 s27, s16, 331776
    s_add_u32 s30, s17, 331776
    buffer_load_dwordx4 v[16:19], v1, s[8:11], s16 offen offset:0
    buffer_load_dwordx4 v[20:23], v1, s[8:11], s25 offen
    buffer_load_dwordx4 v[24:27], v1, s[8:11], s26 offen
    buffer_load_dwordx4 v[28:31], v1, s[8:11], s27 offen
    buffer_load_dwordx4 v[32:35], v1, s[12:15], s17 offen
    buffer_load_dwordx4 v[36:39], v1, s[12:15], s28 offen
    buffer_load_dwordx4 v[40:43], v1, s[12:15], s29 offen
    buffer_load_dwordx4 v[44:47], v1, s[12:15], s30 offen
    ds_read_b128 v[48:51], v11 offset:0
    ds_read_b128 v[52:55], v11 offset:4608
    ds_read_b128 v[56:59], v12 offset:0
    ds_read_b128 v[60:63], v12 offset:9216
    ds_read_b128 v[128:131], v11 offset:32
    ds_read_b128 v[132:135], v11 offset:4640
    ds_read_b128 v[136:139], v12 offset:32
    ds_read_b128 v[140:143], v12 offset:9248
    s_waitcnt lgkmcnt(4)
    v_mfma_f32_32x32x16_bf16 v[64:79], v[56:59], v[48:51], v[64:79]
    v_mfma_f32_32x32x16_bf16 v[80:95], v[60:63], v[48:51], v[80:95]
    v_mfma_f32_32x32x16_bf16 v[96:111], v[56:59], v[52:55], v[96:111]
    v_mfma_f32_32x32x16_bf16 v[112:127], v[60:63], v[52:55], v[112:127]
    ds_read_b128 v[48:51], v11 offset:64
    ds_read_b128 v[52:55], v11 offset:4672
    ds_read_b128 v[56:59], v12 offset:64
    ds_read_b128 v[60:63], v12 offset:9280
    s_waitcnt lgkmcnt(4)
    v_mfma_f32_32x32x16_bf16 v[64:79], v[136:139], v[128:131], v[64:79]
    v_mfma_f32_32x32x16_bf16 v[80:95], v[140:143], v[128:131], v[80:95]
    v_mfma_f32_32x32x16_bf16 v[96:111], v[136:139], v[132:135], v[96:111]
    v_mfma_f32_32x32x16_bf16 v[112:127], v[140:143], v[132:135], v[112:127]
    ds_read_b128 v[128:131], v11 offset:96
    ds_read_b128 v[132:135], v11 offset:4704
    ds_read_b128 v[136:139], v12 offset:96
    ds_read_b128 v[140:143], v12 offset:9312
    s_waitcnt lgkmcnt(4)
    v_mfma_f32_32x32x16_bf16 v[64:79], v[56:59], v[48:51], v[64:79]
    v_mfma_f32_32x32x16_bf16 v[80:95], v[60:63], v[48:51], v[80:95]
    v_mfma_f32_32x32x16_bf16 v[96:111], v[56:59], v[52:55], v[96:111]
    v_mfma_f32_32x32x16_bf16 v[112:127], v[60:63], v[52:55], v[112:127]
    s_waitcnt lgkmcnt(0)
    s_waitcnt vmcnt(0)
    v_mfma_f32_32x32x16_bf16 v[64:79], v[136:139], v[128:131], v[64:79]
    ds_write_b128 v2, v[16:19] offset:0
    ds_write_b128 v2, v[20:23] offset:4608
    v_mfma_f32_32x32x16_bf16 v[80:95], v[140:143], v[128:131], v[80:95]
    ds_write_b128 v2, v[24:27] offset:9216
    ds_write_b128 v2, v[28:31] offset:13824
    v_mfma_f32_32x32x16_bf16 v[96:111], v[136:139], v[132:135], v[96:111]
    ds_write_b128 v2, v[32:35] offset:18432
    ds_write_b128 v2, v[36:39] offset:23040
    v_mfma_f32_32x32x16_bf16 v[112:127], v[140:143], v[132:135], v[112:127]
    ds_write_b128 v2, v[40:43] offset:27648
    ds_write_b128 v2, v[44:47] offset:32256
    s_waitcnt lgkmcnt(0)
    s_barrier
    s_add_u32 s16, s16, 128
    s_add_u32 s17, s17, 128
    s_add_u32 s25, s16, 110592
    s_add_u32 s28, s17, 110592
    s_add_u32 s26, s16, 221184
    s_add_u32 s29, s17, 221184
    s_add_u32 s27, s16, 331776
    s_add_u32 s30, s17, 331776
    buffer_load_dwordx4 v[16:19], v1, s[8:11], s16 offen offset:0
    buffer_load_dwordx4 v[20:23], v1, s[8:11], s25 offen
    buffer_load_dwordx4 v[24:27], v1, s[8:11], s26 offen
    buffer_load_dwordx4 v[28:31], v1, s[8:11], s27 offen
    buffer_load_dwordx4 v[32:35], v1, s[12:15], s17 offen
    buffer_load_dwordx4 v[36:39], v1, s[12:15], s28 offen
    buffer_load_dwordx4 v[40:43], v1, s[12:15], s29 offen
    buffer_load_dwordx4 v[44:47], v1, s[12:15], s30 offen
    ds_read_b128 v[48:51], v3 offset:0
    ds_read_b128 v[52:55], v3 offset:4608
    ds_read_b128 v[56:59], v4 offset:0
    ds_read_b128 v[60:63], v4 offset:9216
    ds_read_b128 v[128:131], v3 offset:32
    ds_read_b128 v[132:135], v3 offset:4640
    ds_read_b128 v[136:139], v4 offset:32
    ds_read_b128 v[140:143], v4 offset:9248
    s_waitcnt lgkmcnt(4)
    v_mfma_f32_32x32x16_bf16 v[64:79], v[56:59], v[48:51], v[64:79]
    v_mfma_f32_32x32x16_bf16 v[80:95], v[60:63], v[48:51], v[80:95]
    v_mfma_f32_32x32x16_bf16 v[96:111], v[56:59], v[52:55], v[96:111]
    v_mfma_f32_32x32x16_bf16 v[112:127], v[60:63], v[52:55], v[112:127]
    ds_read_b128 v[48:51], v3 offset:64
    ds_read_b128 v[52:55], v3 offset:4672
    ds_read_b128 v[56:59], v4 offset:64
    ds_read_b128 v[60:63], v4 offset:9280
    s_waitcnt lgkmcnt(4)
    v_mfma_f32_32x32x16_bf16 v[64:79], v[136:139], v[128:131], v[64:79]
    v_mfma_f32_32x32x16_bf16 v[80:95], v[140:143], v[128:131], v[80:95]
    v_mfma_f32_32x32x16_bf16 v[96:111], v[136:139], v[132:135], v[96:111]
    v_mfma_f32_32x32x16_bf16 v[112:127], v[140:143], v[132:135], v[112:127]
    ds_read_b128 v[128:131], v3 offset:96
    ds_read_b128 v[132:135], v3 offset:4704
    ds_read_b128 v[136:139], v4 offset:96
    ds_read_b128 v[140:143], v4 offset:9312
    s_waitcnt lgkmcnt(4)
    v_mfma_f32_32x32x16_bf16 v[64:79], v[56:59], v[48:51], v[64:79]
    v_mfma_f32_32x32x16_bf16 v[80:95], v[60:63], v[48:51], v[80:95]
    v_mfma_f32_32x32x16_bf16 v[96:111], v[56:59], v[52:55], v[96:111]
    v_mfma_f32_32x32x16_bf16 v[112:127], v[60:63], v[52:55], v[112:127]
    s_waitcnt lgkmcnt(0)
    s_waitcnt vmcnt(0)
    v_mfma_f32_32x32x16_bf16 v[64:79], v[136:139], v[128:131], v[64:79]
    ds_write_b128 v10, v[16:19] offset:0
    ds_write_b128 v10, v[20:23] offset:4608
    v_mfma_f32_32x32x16_bf16 v[80:95], v[140:143], v[128:131], v[80:95]
    ds_write_b128 v10, v[24:27] offset:9216
    ds_write_b128 v10, v[28:31] offset:13824
    v_mfma_f32_32x32x16_bf16 v[96:111], v[136:139], v[132:135], v[96:111]
    ds_write_b128 v10, v[32:35] offset:18432
    ds_write_b128 v10, v[36:39] offset:23040
    v_mfma_f32_32x32x16_bf16 v[112:127], v[140:143], v[132:135], v[112:127]
    ds_write_b128 v10, v[40:43] offset:27648
    ds_write_b128 v10, v[44:47] offset:32256
    s_waitcnt lgkmcnt(0)
    s_barrier
    s_add_u32 s16, s16, 128
    s_add_u32 s17, s17, 128
    s_add_u32 s25, s16, 110592
    s_add_u32 s28, s17, 110592
    s_add_u32 s26, s16, 221184
    s_add_u32 s29, s17, 221184
    s_add_u32 s27, s16, 331776
    s_add_u32 s30, s17, 331776
    buffer_load_dwordx4 v[16:19], v1, s[8:11], s16 offen offset:0
    buffer_load_dwordx4 v[20:23], v1, s[8:11], s25 offen
    buffer_load_dwordx4 v[24:27], v1, s[8:11], s26 offen
    buffer_load_dwordx4 v[28:31], v1, s[8:11], s27 offen
    buffer_load_dwordx4 v[32:35], v1, s[12:15], s17 offen
    buffer_load_dwordx4 v[36:39], v1, s[12:15], s28 offen
    buffer_load_dwordx4 v[40:43], v1, s[12:15], s29 offen
    buffer_load_dwordx4 v[44:47], v1, s[12:15], s30 offen
    ds_read_b128 v[48:51], v11 offset:0
    ds_read_b128 v[52:55], v11 offset:4608
    ds_read_b128 v[56:59], v12 offset:0
    ds_read_b128 v[60:63], v12 offset:9216
    ds_read_b128 v[128:131], v11 offset:32
    ds_read_b128 v[132:135], v11 offset:4640
    ds_read_b128 v[136:139], v12 offset:32
    ds_read_b128 v[140:143], v12 offset:9248
    s_waitcnt lgkmcnt(4)
    v_mfma_f32_32x32x16_bf16 v[64:79], v[56:59], v[48:51], v[64:79]
    v_mfma_f32_32x32x16_bf16 v[80:95], v[60:63], v[48:51], v[80:95]
    v_mfma_f32_32x32x16_bf16 v[96:111], v[56:59], v[52:55], v[96:111]
    v_mfma_f32_32x32x16_bf16 v[112:127], v[60:63], v[52:55], v[112:127]
    ds_read_b128 v[48:51], v11 offset:64
    ds_read_b128 v[52:55], v11 offset:4672
    ds_read_b128 v[56:59], v12 offset:64
    ds_read_b128 v[60:63], v12 offset:9280
    s_waitcnt lgkmcnt(4)
    v_mfma_f32_32x32x16_bf16 v[64:79], v[136:139], v[128:131], v[64:79]
    v_mfma_f32_32x32x16_bf16 v[80:95], v[140:143], v[128:131], v[80:95]
    v_mfma_f32_32x32x16_bf16 v[96:111], v[136:139], v[132:135], v[96:111]
    v_mfma_f32_32x32x16_bf16 v[112:127], v[140:143], v[132:135], v[112:127]
    ds_read_b128 v[128:131], v11 offset:96
    ds_read_b128 v[132:135], v11 offset:4704
    ds_read_b128 v[136:139], v12 offset:96
    ds_read_b128 v[140:143], v12 offset:9312
    s_waitcnt lgkmcnt(4)
    v_mfma_f32_32x32x16_bf16 v[64:79], v[56:59], v[48:51], v[64:79]
    v_mfma_f32_32x32x16_bf16 v[80:95], v[60:63], v[48:51], v[80:95]
    v_mfma_f32_32x32x16_bf16 v[96:111], v[56:59], v[52:55], v[96:111]
    v_mfma_f32_32x32x16_bf16 v[112:127], v[60:63], v[52:55], v[112:127]
    s_waitcnt lgkmcnt(0)
    s_waitcnt vmcnt(0)
    v_mfma_f32_32x32x16_bf16 v[64:79], v[136:139], v[128:131], v[64:79]
    ds_write_b128 v2, v[16:19] offset:0
    ds_write_b128 v2, v[20:23] offset:4608
    v_mfma_f32_32x32x16_bf16 v[80:95], v[140:143], v[128:131], v[80:95]
    ds_write_b128 v2, v[24:27] offset:9216
    ds_write_b128 v2, v[28:31] offset:13824
    v_mfma_f32_32x32x16_bf16 v[96:111], v[136:139], v[132:135], v[96:111]
    ds_write_b128 v2, v[32:35] offset:18432
    ds_write_b128 v2, v[36:39] offset:23040
    v_mfma_f32_32x32x16_bf16 v[112:127], v[140:143], v[132:135], v[112:127]
    ds_write_b128 v2, v[40:43] offset:27648
    ds_write_b128 v2, v[44:47] offset:32256
    s_waitcnt lgkmcnt(0)
    s_barrier
    s_add_u32 s16, s16, 128
    s_add_u32 s17, s17, 128
    s_add_u32 s25, s16, 110592
    s_add_u32 s28, s17, 110592
    s_add_u32 s26, s16, 221184
    s_add_u32 s29, s17, 221184
    s_add_u32 s27, s16, 331776
    s_add_u32 s30, s17, 331776
    buffer_load_dwordx4 v[16:19], v1, s[8:11], s16 offen offset:0
    buffer_load_dwordx4 v[20:23], v1, s[8:11], s25 offen
    buffer_load_dwordx4 v[24:27], v1, s[8:11], s26 offen
    buffer_load_dwordx4 v[28:31], v1, s[8:11], s27 offen
    buffer_load_dwordx4 v[32:35], v1, s[12:15], s17 offen
    buffer_load_dwordx4 v[36:39], v1, s[12:15], s28 offen
    buffer_load_dwordx4 v[40:43], v1, s[12:15], s29 offen
    buffer_load_dwordx4 v[44:47], v1, s[12:15], s30 offen
    ds_read_b128 v[48:51], v3 offset:0
    ds_read_b128 v[52:55], v3 offset:4608
    ds_read_b128 v[56:59], v4 offset:0
    ds_read_b128 v[60:63], v4 offset:9216
    ds_read_b128 v[128:131], v3 offset:32
    ds_read_b128 v[132:135], v3 offset:4640
    ds_read_b128 v[136:139], v4 offset:32
    ds_read_b128 v[140:143], v4 offset:9248
    s_waitcnt lgkmcnt(4)
    v_mfma_f32_32x32x16_bf16 v[64:79], v[56:59], v[48:51], v[64:79]
    v_mfma_f32_32x32x16_bf16 v[80:95], v[60:63], v[48:51], v[80:95]
    v_mfma_f32_32x32x16_bf16 v[96:111], v[56:59], v[52:55], v[96:111]
    v_mfma_f32_32x32x16_bf16 v[112:127], v[60:63], v[52:55], v[112:127]
    ds_read_b128 v[48:51], v3 offset:64
    ds_read_b128 v[52:55], v3 offset:4672
    ds_read_b128 v[56:59], v4 offset:64
    ds_read_b128 v[60:63], v4 offset:9280
    s_waitcnt lgkmcnt(4)
    v_mfma_f32_32x32x16_bf16 v[64:79], v[136:139], v[128:131], v[64:79]
    v_mfma_f32_32x32x16_bf16 v[80:95], v[140:143], v[128:131], v[80:95]
    v_mfma_f32_32x32x16_bf16 v[96:111], v[136:139], v[132:135], v[96:111]
    v_mfma_f32_32x32x16_bf16 v[112:127], v[140:143], v[132:135], v[112:127]
    ds_read_b128 v[128:131], v3 offset:96
    ds_read_b128 v[132:135], v3 offset:4704
    ds_read_b128 v[136:139], v4 offset:96
    ds_read_b128 v[140:143], v4 offset:9312
    s_waitcnt lgkmcnt(4)
    v_mfma_f32_32x32x16_bf16 v[64:79], v[56:59], v[48:51], v[64:79]
    v_mfma_f32_32x32x16_bf16 v[80:95], v[60:63], v[48:51], v[80:95]
    v_mfma_f32_32x32x16_bf16 v[96:111], v[56:59], v[52:55], v[96:111]
    v_mfma_f32_32x32x16_bf16 v[112:127], v[60:63], v[52:55], v[112:127]
    s_waitcnt lgkmcnt(0)
    s_waitcnt vmcnt(0)
    v_mfma_f32_32x32x16_bf16 v[64:79], v[136:139], v[128:131], v[64:79]
    ds_write_b128 v10, v[16:19] offset:0
    ds_write_b128 v10, v[20:23] offset:4608
    v_mfma_f32_32x32x16_bf16 v[80:95], v[140:143], v[128:131], v[80:95]
    ds_write_b128 v10, v[24:27] offset:9216
    ds_write_b128 v10, v[28:31] offset:13824
    v_mfma_f32_32x32x16_bf16 v[96:111], v[136:139], v[132:135], v[96:111]
    ds_write_b128 v10, v[32:35] offset:18432
    ds_write_b128 v10, v[36:39] offset:23040
    v_mfma_f32_32x32x16_bf16 v[112:127], v[140:143], v[132:135], v[112:127]
    ds_write_b128 v10, v[40:43] offset:27648
    ds_write_b128 v10, v[44:47] offset:32256
    s_waitcnt lgkmcnt(0)
    s_barrier
    s_add_u32 s16, s16, 128
    s_add_u32 s17, s17, 128
    s_add_u32 s25, s16, 110592
    s_add_u32 s28, s17, 110592
    s_add_u32 s26, s16, 221184
    s_add_u32 s29, s17, 221184
    s_add_u32 s27, s16, 331776
    s_add_u32 s30, s17, 331776
    buffer_load_dwordx4 v[16:19], v1, s[8:11], s16 offen offset:0
    buffer_load_dwordx4 v[20:23], v1, s[8:11], s25 offen
    buffer_load_dwordx4 v[24:27], v1, s[8:11], s26 offen
    buffer_load_dwordx4 v[28:31], v1, s[8:11], s27 offen
    buffer_load_dwordx4 v[32:35], v1, s[12:15], s17 offen
    buffer_load_dwordx4 v[36:39], v1, s[12:15], s28 offen
    buffer_load_dwordx4 v[40:43], v1, s[12:15], s29 offen
    buffer_load_dwordx4 v[44:47], v1, s[12:15], s30 offen
    ds_read_b128 v[48:51], v11 offset:0
    ds_read_b128 v[52:55], v11 offset:4608
    ds_read_b128 v[56:59], v12 offset:0
    ds_read_b128 v[60:63], v12 offset:9216
    ds_read_b128 v[128:131], v11 offset:32
    ds_read_b128 v[132:135], v11 offset:4640
    ds_read_b128 v[136:139], v12 offset:32
    ds_read_b128 v[140:143], v12 offset:9248
    s_waitcnt lgkmcnt(4)
    v_mfma_f32_32x32x16_bf16 v[64:79], v[56:59], v[48:51], v[64:79]
    v_mfma_f32_32x32x16_bf16 v[80:95], v[60:63], v[48:51], v[80:95]
    v_mfma_f32_32x32x16_bf16 v[96:111], v[56:59], v[52:55], v[96:111]
    v_mfma_f32_32x32x16_bf16 v[112:127], v[60:63], v[52:55], v[112:127]
    ds_read_b128 v[48:51], v11 offset:64
    ds_read_b128 v[52:55], v11 offset:4672
    ds_read_b128 v[56:59], v12 offset:64
    ds_read_b128 v[60:63], v12 offset:9280
    s_waitcnt lgkmcnt(4)
    v_mfma_f32_32x32x16_bf16 v[64:79], v[136:139], v[128:131], v[64:79]
    v_mfma_f32_32x32x16_bf16 v[80:95], v[140:143], v[128:131], v[80:95]
    v_mfma_f32_32x32x16_bf16 v[96:111], v[136:139], v[132:135], v[96:111]
    v_mfma_f32_32x32x16_bf16 v[112:127], v[140:143], v[132:135], v[112:127]
    ds_read_b128 v[128:131], v11 offset:96
    ds_read_b128 v[132:135], v11 offset:4704
    ds_read_b128 v[136:139], v12 offset:96
    ds_read_b128 v[140:143], v12 offset:9312
    s_waitcnt lgkmcnt(4)
    v_mfma_f32_32x32x16_bf16 v[64:79], v[56:59], v[48:51], v[64:79]
    v_mfma_f32_32x32x16_bf16 v[80:95], v[60:63], v[48:51], v[80:95]
    v_mfma_f32_32x32x16_bf16 v[96:111], v[56:59], v[52:55], v[96:111]
    v_mfma_f32_32x32x16_bf16 v[112:127], v[60:63], v[52:55], v[112:127]
    s_waitcnt lgkmcnt(0)
    s_waitcnt vmcnt(0)
    v_mfma_f32_32x32x16_bf16 v[64:79], v[136:139], v[128:131], v[64:79]
    ds_write_b128 v2, v[16:19] offset:0
    ds_write_b128 v2, v[20:23] offset:4608
    v_mfma_f32_32x32x16_bf16 v[80:95], v[140:143], v[128:131], v[80:95]
    ds_write_b128 v2, v[24:27] offset:9216
    ds_write_b128 v2, v[28:31] offset:13824
    v_mfma_f32_32x32x16_bf16 v[96:111], v[136:139], v[132:135], v[96:111]
    ds_write_b128 v2, v[32:35] offset:18432
    ds_write_b128 v2, v[36:39] offset:23040
    v_mfma_f32_32x32x16_bf16 v[112:127], v[140:143], v[132:135], v[112:127]
    ds_write_b128 v2, v[40:43] offset:27648
    ds_write_b128 v2, v[44:47] offset:32256
    s_waitcnt lgkmcnt(0)
    s_barrier
    ds_read_b128 v[48:51], v3 offset:0
    ds_read_b128 v[52:55], v3 offset:4608
    ds_read_b128 v[56:59], v4 offset:0
    ds_read_b128 v[60:63], v4 offset:9216
    ds_read_b128 v[128:131], v3 offset:32
    ds_read_b128 v[132:135], v3 offset:4640
    ds_read_b128 v[136:139], v4 offset:32
    ds_read_b128 v[140:143], v4 offset:9248
    s_waitcnt lgkmcnt(4)
    v_mfma_f32_32x32x16_bf16 v[64:79], v[56:59], v[48:51], v[64:79]
    v_mfma_f32_32x32x16_bf16 v[80:95], v[60:63], v[48:51], v[80:95]
    v_mfma_f32_32x32x16_bf16 v[96:111], v[56:59], v[52:55], v[96:111]
    v_mfma_f32_32x32x16_bf16 v[112:127], v[60:63], v[52:55], v[112:127]
    ds_read_b128 v[48:51], v3 offset:64
    ds_read_b128 v[52:55], v3 offset:4672
    ds_read_b128 v[56:59], v4 offset:64
    ds_read_b128 v[60:63], v4 offset:9280
    s_waitcnt lgkmcnt(4)
    v_mfma_f32_32x32x16_bf16 v[64:79], v[136:139], v[128:131], v[64:79]
    v_mfma_f32_32x32x16_bf16 v[80:95], v[140:143], v[128:131], v[80:95]
    v_mfma_f32_32x32x16_bf16 v[96:111], v[136:139], v[132:135], v[96:111]
    v_mfma_f32_32x32x16_bf16 v[112:127], v[140:143], v[132:135], v[112:127]
    ds_read_b128 v[128:131], v3 offset:96
    ds_read_b128 v[132:135], v3 offset:4704
    ds_read_b128 v[136:139], v4 offset:96
    ds_read_b128 v[140:143], v4 offset:9312
    s_waitcnt lgkmcnt(4)
    v_mfma_f32_32x32x16_bf16 v[64:79], v[56:59], v[48:51], v[64:79]
    v_mfma_f32_32x32x16_bf16 v[80:95], v[60:63], v[48:51], v[80:95]
    v_mfma_f32_32x32x16_bf16 v[96:111], v[56:59], v[52:55], v[96:111]
    v_mfma_f32_32x32x16_bf16 v[112:127], v[60:63], v[52:55], v[112:127]
    s_waitcnt lgkmcnt(0)
    v_mfma_f32_32x32x16_bf16 v[64:79], v[136:139], v[128:131], v[64:79]
    v_mfma_f32_32x32x16_bf16 v[80:95], v[140:143], v[128:131], v[80:95]
    v_mfma_f32_32x32x16_bf16 v[96:111], v[136:139], v[132:135], v[96:111]
    v_mfma_f32_32x32x16_bf16 v[112:127], v[140:143], v[132:135], v[112:127]
    s_nop 7
    s_nop 7
    v_lshrrev_b32 v5, 6, v0
    v_and_b32 v6, 31, v0
    v_lshrrev_b32 v7, 5, v0
    v_and_b32 v7, 1, v7
    v_lshrrev_b32 v8, 1, v5
    v_and_b32 v9, 1, v5
    v_lshl_add_u32 v8, v8, 6, v6
    s_mul_i32 s3, s23, 5242880
    s_add_u32 s3, s3, 27262976
    s_add_u32 s8, s4, s3
    s_addc_u32 s9, s5, 0
    s_mov_b32 s10, 5242880
    s_mov_b32 s11, 0x00020000
    v_mul_u32_u24 v8, 2560, v8
    v_and_b32 v9, 1, v5
    v_lshlrev_b32 v9, 7, v9
    v_lshl_add_u32 v9, v7, 4, v9
    v_add_u32 v8, v8, v9
    s_mul_i32 s16, s20, 327680
    s_lshl_b32 s17, s21, 9
    s_add_u32 s16, s16, s17
    s_add_u32 s17, s16, 0
    buffer_store_dwordx4 v[64:67], v8, s[8:11], s17 offen
    s_add_u32 s17, s16, 32
    buffer_store_dwordx4 v[68:71], v8, s[8:11], s17 offen
    s_add_u32 s17, s16, 64
    buffer_store_dwordx4 v[72:75], v8, s[8:11], s17 offen
    s_add_u32 s17, s16, 96
    buffer_store_dwordx4 v[76:79], v8, s[8:11], s17 offen
    s_add_u32 s17, s16, 256
    buffer_store_dwordx4 v[80:83], v8, s[8:11], s17 offen
    s_add_u32 s17, s16, 288
    buffer_store_dwordx4 v[84:87], v8, s[8:11], s17 offen
    s_add_u32 s17, s16, 320
    buffer_store_dwordx4 v[88:91], v8, s[8:11], s17 offen
    s_add_u32 s17, s16, 352
    buffer_store_dwordx4 v[92:95], v8, s[8:11], s17 offen
    s_add_u32 s17, s16, 81920
    buffer_store_dwordx4 v[96:99], v8, s[8:11], s17 offen
    s_add_u32 s17, s16, 81952
    buffer_store_dwordx4 v[100:103], v8, s[8:11], s17 offen
    s_add_u32 s17, s16, 81984
    buffer_store_dwordx4 v[104:107], v8, s[8:11], s17 offen
    s_add_u32 s17, s16, 82016
    buffer_store_dwordx4 v[108:111], v8, s[8:11], s17 offen
    s_add_u32 s17, s16, 82176
    buffer_store_dwordx4 v[112:115], v8, s[8:11], s17 offen
    s_add_u32 s17, s16, 82208
    buffer_store_dwordx4 v[116:119], v8, s[8:11], s17 offen
    s_add_u32 s17, s16, 82240
    buffer_store_dwordx4 v[120:123], v8, s[8:11], s17 offen
    s_add_u32 s17, s16, 82272
    buffer_store_dwordx4 v[124:127], v8, s[8:11], s17 offen
.Lg2a_kernel_end:
    s_endpgm
.globl fina_kernel
.p2align 8
.type fina_kernel,@function
fina_kernel:
    s_cmp_ge_u32 s2, 1280
    s_cbranch_scc1 .Lfina_kernel_end
    s_load_dwordx2 s[4:5], s[0:1], 72
    s_load_dwordx2 s[6:7], s[0:1], 56
    s_waitcnt lgkmcnt(0)
    s_mov_b32 s3, 27262976
    s_add_u32 s8, s4, s3
    s_addc_u32 s9, s5, 0
    s_mov_b32 s10, 15728640
    s_mov_b32 s11, 0x00020000
    s_mov_b32 s3, 12582912
    s_add_u32 s12, s4, s3
    s_addc_u32 s13, s5, 0
    s_mov_b32 s14, 2621440
    s_mov_b32 s15, 0x00020000
    s_mov_b32 s3, 52428800
    s_add_u32 s16, s4, s3
    s_addc_u32 s17, s5, 0
    s_mov_b32 s18, 2621440
    s_mov_b32 s19, 0x00020000
    s_lshl_b32 s3, s2, 8
    v_add_u32 v1, s3, v0
    v_lshlrev_b32 v2, 4, v1
    v_lshlrev_b32 v3, 3, v1
    s_mov_b32 s20, 5242880
    s_mov_b32 s21, 10485760
    buffer_load_dwordx4 v[4:7], v2, s[8:11], 0 offen
    buffer_load_dwordx4 v[8:11], v2, s[8:11], s20 offen
    buffer_load_dwordx4 v[12:15], v2, s[8:11], s21 offen
    buffer_load_dwordx2 v[16:17], v3, s[12:15], 0 offen
    s_waitcnt vmcnt(0)
    v_add_f32 v4, v4, v8
    v_add_f32 v4, v4, v12
    v_cvt_pk_bf16_f32 v4, v4, v4
    v_lshlrev_b32 v4, 16, v4
    v_add_f32 v5, v5, v9
    v_add_f32 v5, v5, v13
    v_cvt_pk_bf16_f32 v5, v5, v5
    v_lshlrev_b32 v5, 16, v5
    v_add_f32 v6, v6, v10
    v_add_f32 v6, v6, v14
    v_cvt_pk_bf16_f32 v6, v6, v6
    v_lshlrev_b32 v6, 16, v6
    v_add_f32 v7, v7, v11
    v_add_f32 v7, v7, v15
    v_cvt_pk_bf16_f32 v7, v7, v7
    v_lshlrev_b32 v7, 16, v7
    v_lshlrev_b32 v8, 16, v16
    v_and_b32 v9, 0xffff0000, v16
    v_lshlrev_b32 v10, 16, v17
    v_and_b32 v11, 0xffff0000, v17
    v_add_f32 v4, v4, v8
    v_add_f32 v5, v5, v9
    v_add_f32 v6, v6, v10
    v_add_f32 v7, v7, v11
    v_cvt_pk_bf16_f32 v12, v4, v5
    v_cvt_pk_bf16_f32 v13, v6, v7
    buffer_store_dwordx2 v[12:13], v3, s[16:19], 0 offen
.Lfina_kernel_end:
    s_endpgm
.globl k1b_kernel
.p2align 8
.type k1b_kernel,@function
k1b_kernel:
    s_cmp_ge_u32 s2, 256
    s_cbranch_scc1 .Lk1b_kernel_end
    s_load_dwordx2 s[4:5], s[0:1], 72
    s_load_dwordx2 s[6:7], s[0:1], 0
    s_load_dwordx4 s[28:31], s[0:1], 8
    s_mov_b32 s40, 0x3f3504f3
    s_mov_b32 s41, 0xbf3504f3
    s_mov_b32 s42, 0x3e9e377a
    s_mov_b32 s43, 0xbf4f1bbd
    s_mov_b32 s44, 0x3f737871
    s_mov_b32 s45, 0x3f167918
    s_mov_b32 s46, 0x3f4f1bbd
    s_mov_b32 s47, 0x3f167918
    s_mov_b32 s48, 0x3e9e377a
    s_mov_b32 s49, 0x3f737871
    s_mov_b32 s50, 0xbe9e377a
    s_mov_b32 s51, 0x3f737871
    s_mov_b32 s52, 0xbf4f1bbd
    s_mov_b32 s53, 0x3f167918
    s_waitcnt lgkmcnt(0)
    s_mov_b32 s3, 52428800
    s_add_u32 s8, s4, s3
    s_addc_u32 s9, s5, 0
    s_mov_b32 s10, 2621440
    s_mov_b32 s11, 0x00020000
    s_mov_b32 s12, s4
    s_mov_b32 s13, s5
    s_mov_b32 s14, 5259264
    s_mov_b32 s15, 0x00020000
    v_and_b32 v1, 63, v0
    v_lshrrev_b32 v2, 6, v0
    s_nop 1
    v_readfirstlane_b32 s20, v2
    s_cmp_ge_u32 s20, 4
    s_cbranch_scc1 .Lk1b_kernel_skipln
    s_lshl_b32 s21, s2, 3
    s_lshl_b32 s22, s20, 1
    s_add_u32 s21, s21, s22
    s_mul_i32 s21, s21, 1280
    v_lshlrev_b32 v3, 2, v1
    buffer_load_dword v4, v3, s[8:11], s21 offen offset:0
    buffer_load_dword v5, v3, s[8:11], s21 offen offset:256
    buffer_load_dword v6, v3, s[8:11], s21 offen offset:512
    buffer_load_dword v7, v3, s[8:11], s21 offen offset:768
    buffer_load_dword v8, v3, s[8:11], s21 offen offset:1024
    buffer_load_dword v9, v3, s[8:11], s21 offen offset:1280
    buffer_load_dword v10, v3, s[8:11], s21 offen offset:1536
    buffer_load_dword v11, v3, s[8:11], s21 offen offset:1792
    buffer_load_dword v12, v3, s[8:11], s21 offen offset:2048
    buffer_load_dword v13, v3, s[8:11], s21 offen offset:2304
    s_waitcnt vmcnt(0)
    v_lshlrev_b32 v20, 16, v4
    v_and_b32 v21, 0xffff0000, v4
    v_lshlrev_b32 v22, 16, v5
    v_and_b32 v23, 0xffff0000, v5
    v_lshlrev_b32 v24, 16, v6
    v_and_b32 v25, 0xffff0000, v6
    v_lshlrev_b32 v26, 16, v7
    v_and_b32 v27, 0xffff0000, v7
    v_lshlrev_b32 v28, 16, v8
    v_and_b32 v29, 0xffff0000, v8
    v_lshlrev_b32 v30, 16, v9
    v_and_b32 v31, 0xffff0000, v9
    v_lshlrev_b32 v32, 16, v10
    v_and_b32 v33, 0xffff0000, v10
    v_lshlrev_b32 v34, 16, v11
    v_and_b32 v35, 0xffff0000, v11
    v_lshlrev_b32 v36, 16, v12
    v_and_b32 v37, 0xffff0000, v12
    v_lshlrev_b32 v38, 16, v13
    v_and_b32 v39, 0xffff0000, v13
    v_add_f32 v40, v20, v21
    v_add_f32 v40, v40, v22
    v_add_f32 v40, v40, v23
    v_add_f32 v40, v40, v24
    v_add_f32 v40, v40, v25
    v_add_f32 v40, v40, v26
    v_add_f32 v40, v40, v27
    v_add_f32 v40, v40, v28
    v_add_f32 v40, v40, v29
    v_add_f32 v41, v30, v31
    v_add_f32 v41, v41, v32
    v_add_f32 v41, v41, v33
    v_add_f32 v41, v41, v34
    v_add_f32 v41, v41, v35
    v_add_f32 v41, v41, v36
    v_add_f32 v41, v41, v37
    v_add_f32 v41, v41, v38
    v_add_f32 v41, v41, v39
    s_nop 1
    v_add_f32_dpp v40, v40, v40 quad_perm:[1,0,3,2] row_mask:0xf bank_mask:0xf
    v_add_f32_dpp v41, v41, v41 quad_perm:[1,0,3,2] row_mask:0xf bank_mask:0xf
    s_nop 1
    v_add_f32_dpp v40, v40, v40 quad_perm:[2,3,0,1] row_mask:0xf bank_mask:0xf
    v_add_f32_dpp v41, v41, v41 quad_perm:[2,3,0,1] row_mask:0xf bank_mask:0xf
    s_nop 1
    v_add_f32_dpp v40, v40, v40 row_half_mirror row_mask:0xf bank_mask:0xf
    v_add_f32_dpp v41, v41, v41 row_half_mirror row_mask:0xf bank_mask:0xf
    s_nop 1
    v_add_f32_dpp v40, v40, v40 row_mirror row_mask:0xf bank_mask:0xf
    v_add_f32_dpp v41, v41, v41 row_mirror row_mask:0xf bank_mask:0xf
    v_mov_b32 v44, v40
    v_mov_b32 v45, v41
    s_nop 1
    v_permlane16_swap_b32 v40, v44
    v_permlane16_swap_b32 v41, v45
    s_nop 1
    v_add_f32 v40, v40, v44
    v_add_f32 v41, v41, v45
    v_mov_b32 v44, v40
    v_mov_b32 v45, v41
    s_nop 1
    v_permlane32_swap_b32 v40, v44
    v_permlane32_swap_b32 v41, v45
    s_nop 1
    v_add_f32 v40, v40, v44
    v_add_f32 v41, v41, v45
    v_mul_f32 v40, 0x3acccccd, v40
    v_mul_f32 v41, 0x3acccccd, v41
    v_sub_f32 v44, v20, v40
    v_mul_f32 v42, v44, v44
    v_sub_f32 v44, v21, v40
    v_fma_f32 v42, v44, v44, v42
    v_sub_f32 v44, v22, v40
    v_fma_f32 v42, v44, v44, v42
    v_sub_f32 v44, v23, v40
    v_fma_f32 v42, v44, v44, v42
    v_sub_f32 v44, v24, v40
    v_fma_f32 v42, v44, v44, v42
    v_sub_f32 v44, v25, v40
    v_fma_f32 v42, v44, v44, v42
    v_sub_f32 v44, v26, v40
    v_fma_f32 v42, v44, v44, v42
    v_sub_f32 v44, v27, v40
    v_fma_f32 v42, v44, v44, v42
    v_sub_f32 v44, v28, v40
    v_fma_f32 v42, v44, v44, v42
    v_sub_f32 v44, v29, v40
    v_fma_f32 v42, v44, v44, v42
    v_sub_f32 v44, v30, v41
    v_mul_f32 v43, v44, v44
    v_sub_f32 v44, v31, v41
    v_fma_f32 v43, v44, v44, v43
    v_sub_f32 v44, v32, v41
    v_fma_f32 v43, v44, v44, v43
    v_sub_f32 v44, v33, v41
    v_fma_f32 v43, v44, v44, v43
    v_sub_f32 v44, v34, v41
    v_fma_f32 v43, v44, v44, v43
    v_sub_f32 v44, v35, v41
    v_fma_f32 v43, v44, v44, v43
    v_sub_f32 v44, v36, v41
    v_fma_f32 v43, v44, v44, v43
    v_sub_f32 v44, v37, v41
    v_fma_f32 v43, v44, v44, v43
    v_sub_f32 v44, v38, v41
    v_fma_f32 v43, v44, v44, v43
    v_sub_f32 v44, v39, v41
    v_fma_f32 v43, v44, v44, v43
    s_nop 1
    v_add_f32_dpp v42, v42, v42 quad_perm:[1,0,3,2] row_mask:0xf bank_mask:0xf
    v_add_f32_dpp v43, v43, v43 quad_perm:[1,0,3,2] row_mask:0xf bank_mask:0xf
    s_nop 1
    v_add_f32_dpp v42, v42, v42 quad_perm:[2,3,0,1] row_mask:0xf bank_mask:0xf
    v_add_f32_dpp v43, v43, v43 quad_perm:[2,3,0,1] row_mask:0xf bank_mask:0xf
    s_nop 1
    v_add_f32_dpp v42, v42, v42 row_half_mirror row_mask:0xf bank_mask:0xf
    v_add_f32_dpp v43, v43, v43 row_half_mirror row_mask:0xf bank_mask:0xf
    s_nop 1
    v_add_f32_dpp v42, v42, v42 row_mirror row_mask:0xf bank_mask:0xf
    v_add_f32_dpp v43, v43, v43 row_mirror row_mask:0xf bank_mask:0xf
    v_mov_b32 v44, v42
    v_mov_b32 v45, v43
    s_nop 1
    v_permlane16_swap_b32 v42, v44
    v_permlane16_swap_b32 v43, v45
    s_nop 1
    v_add_f32 v42, v42, v44
    v_add_f32 v43, v43, v45
    v_mov_b32 v44, v42
    v_mov_b32 v45, v43
    s_nop 1
    v_permlane32_swap_b32 v42, v44
    v_permlane32_swap_b32 v43, v45
    s_nop 1
    v_add_f32 v42, v42, v44
    v_add_f32 v43, v43, v45
    v_mul_f32 v42, 0x3acccccd, v42
    v_cvt_pk_bf16_f32 v42, v42, v42
    v_lshlrev_b32 v42, 16, v42
    v_add_f32 v42, 0x3727c5ac, v42
    v_cvt_pk_bf16_f32 v42, v42, v42
    v_lshlrev_b32 v42, 16, v42
    v_sqrt_f32 v42, v42
    s_nop 0
    v_cvt_pk_bf16_f32 v42, v42, v42
    v_lshlrev_b32 v42, 16, v42
    v_rcp_f32 v44, v42
    v_cvt_pk_bf16_f32 v40, v40, v40
    v_lshlrev_b32 v40, 16, v40
    v_mul_f32 v43, 0x3acccccd, v43
    v_cvt_pk_bf16_f32 v43, v43, v43
    v_lshlrev_b32 v43, 16, v43
    v_add_f32 v43, 0x3727c5ac, v43
    v_cvt_pk_bf16_f32 v43, v43, v43
    v_lshlrev_b32 v43, 16, v43
    v_sqrt_f32 v43, v43
    s_nop 0
    v_cvt_pk_bf16_f32 v43, v43, v43
    v_lshlrev_b32 v43, 16, v43
    v_rcp_f32 v45, v43
    v_cvt_pk_bf16_f32 v41, v41, v41
    v_lshlrev_b32 v41, 16, v41
    v_sub_f32 v20, v20, v40
    v_cvt_pk_bf16_f32 v20, v20, v20
    v_lshlrev_b32 v20, 16, v20
    v_mul_f32 v46, v20, v44
    v_fma_f32 v47, -v46, v42, v20
    v_fma_f32 v20, v47, v44, v46
    v_cvt_pk_bf16_f32 v20, v20, v20
    v_lshlrev_b32 v20, 16, v20
    v_sub_f32 v21, v21, v40
    v_cvt_pk_bf16_f32 v21, v21, v21
    v_lshlrev_b32 v21, 16, v21
    v_mul_f32 v46, v21, v44
    v_fma_f32 v47, -v46, v42, v21
    v_fma_f32 v21, v47, v44, v46
    v_cvt_pk_bf16_f32 v21, v21, v21
    v_lshlrev_b32 v21, 16, v21
    v_sub_f32 v22, v22, v40
    v_cvt_pk_bf16_f32 v22, v22, v22
    v_lshlrev_b32 v22, 16, v22
    v_mul_f32 v46, v22, v44
    v_fma_f32 v47, -v46, v42, v22
    v_fma_f32 v22, v47, v44, v46
    v_cvt_pk_bf16_f32 v22, v22, v22
    v_lshlrev_b32 v22, 16, v22
    v_sub_f32 v23, v23, v40
    v_cvt_pk_bf16_f32 v23, v23, v23
    v_lshlrev_b32 v23, 16, v23
    v_mul_f32 v46, v23, v44
    v_fma_f32 v47, -v46, v42, v23
    v_fma_f32 v23, v47, v44, v46
    v_cvt_pk_bf16_f32 v23, v23, v23
    v_lshlrev_b32 v23, 16, v23
    v_sub_f32 v24, v24, v40
    v_cvt_pk_bf16_f32 v24, v24, v24
    v_lshlrev_b32 v24, 16, v24
    v_mul_f32 v46, v24, v44
    v_fma_f32 v47, -v46, v42, v24
    v_fma_f32 v24, v47, v44, v46
    v_cvt_pk_bf16_f32 v24, v24, v24
    v_lshlrev_b32 v24, 16, v24
    v_sub_f32 v25, v25, v40
    v_cvt_pk_bf16_f32 v25, v25, v25
    v_lshlrev_b32 v25, 16, v25
    v_mul_f32 v46, v25, v44
    v_fma_f32 v47, -v46, v42, v25
    v_fma_f32 v25, v47, v44, v46
    v_cvt_pk_bf16_f32 v25, v25, v25
    v_lshlrev_b32 v25, 16, v25
    v_sub_f32 v26, v26, v40
    v_cvt_pk_bf16_f32 v26, v26, v26
    v_lshlrev_b32 v26, 16, v26
    v_mul_f32 v46, v26, v44
    v_fma_f32 v47, -v46, v42, v26
    v_fma_f32 v26, v47, v44, v46
    v_cvt_pk_bf16_f32 v26, v26, v26
    v_lshlrev_b32 v26, 16, v26
    v_sub_f32 v27, v27, v40
    v_cvt_pk_bf16_f32 v27, v27, v27
    v_lshlrev_b32 v27, 16, v27
    v_mul_f32 v46, v27, v44
    v_fma_f32 v47, -v46, v42, v27
    v_fma_f32 v27, v47, v44, v46
    v_cvt_pk_bf16_f32 v27, v27, v27
    v_lshlrev_b32 v27, 16, v27
    v_sub_f32 v28, v28, v40
    v_cvt_pk_bf16_f32 v28, v28, v28
    v_lshlrev_b32 v28, 16, v28
    v_mul_f32 v46, v28, v44
    v_fma_f32 v47, -v46, v42, v28
    v_fma_f32 v28, v47, v44, v46
    v_cvt_pk_bf16_f32 v28, v28, v28
    v_lshlrev_b32 v28, 16, v28
    v_sub_f32 v29, v29, v40
    v_cvt_pk_bf16_f32 v29, v29, v29
    v_lshlrev_b32 v29, 16, v29
    v_mul_f32 v46, v29, v44
    v_fma_f32 v47, -v46, v42, v29
    v_fma_f32 v29, v47, v44, v46
    v_cvt_pk_bf16_f32 v29, v29, v29
    v_lshlrev_b32 v29, 16, v29
    v_sub_f32 v30, v30, v41
    v_cvt_pk_bf16_f32 v30, v30, v30
    v_lshlrev_b32 v30, 16, v30
    v_mul_f32 v46, v30, v45
    v_fma_f32 v47, -v46, v43, v30
    v_fma_f32 v30, v47, v45, v46
    v_cvt_pk_bf16_f32 v30, v30, v30
    v_lshlrev_b32 v30, 16, v30
    v_sub_f32 v31, v31, v41
    v_cvt_pk_bf16_f32 v31, v31, v31
    v_lshlrev_b32 v31, 16, v31
    v_mul_f32 v46, v31, v45
    v_fma_f32 v47, -v46, v43, v31
    v_fma_f32 v31, v47, v45, v46
    v_cvt_pk_bf16_f32 v31, v31, v31
    v_lshlrev_b32 v31, 16, v31
    v_sub_f32 v32, v32, v41
    v_cvt_pk_bf16_f32 v32, v32, v32
    v_lshlrev_b32 v32, 16, v32
    v_mul_f32 v46, v32, v45
    v_fma_f32 v47, -v46, v43, v32
    v_fma_f32 v32, v47, v45, v46
    v_cvt_pk_bf16_f32 v32, v32, v32
    v_lshlrev_b32 v32, 16, v32
    v_sub_f32 v33, v33, v41
    v_cvt_pk_bf16_f32 v33, v33, v33
    v_lshlrev_b32 v33, 16, v33
    v_mul_f32 v46, v33, v45
    v_fma_f32 v47, -v46, v43, v33
    v_fma_f32 v33, v47, v45, v46
    v_cvt_pk_bf16_f32 v33, v33, v33
    v_lshlrev_b32 v33, 16, v33
    v_sub_f32 v34, v34, v41
    v_cvt_pk_bf16_f32 v34, v34, v34
    v_lshlrev_b32 v34, 16, v34
    v_mul_f32 v46, v34, v45
    v_fma_f32 v47, -v46, v43, v34
    v_fma_f32 v34, v47, v45, v46
    v_cvt_pk_bf16_f32 v34, v34, v34
    v_lshlrev_b32 v34, 16, v34
    v_sub_f32 v35, v35, v41
    v_cvt_pk_bf16_f32 v35, v35, v35
    v_lshlrev_b32 v35, 16, v35
    v_mul_f32 v46, v35, v45
    v_fma_f32 v47, -v46, v43, v35
    v_fma_f32 v35, v47, v45, v46
    v_cvt_pk_bf16_f32 v35, v35, v35
    v_lshlrev_b32 v35, 16, v35
    v_sub_f32 v36, v36, v41
    v_cvt_pk_bf16_f32 v36, v36, v36
    v_lshlrev_b32 v36, 16, v36
    v_mul_f32 v46, v36, v45
    v_fma_f32 v47, -v46, v43, v36
    v_fma_f32 v36, v47, v45, v46
    v_cvt_pk_bf16_f32 v36, v36, v36
    v_lshlrev_b32 v36, 16, v36
    v_sub_f32 v37, v37, v41
    v_cvt_pk_bf16_f32 v37, v37, v37
    v_lshlrev_b32 v37, 16, v37
    v_mul_f32 v46, v37, v45
    v_fma_f32 v47, -v46, v43, v37
    v_fma_f32 v37, v47, v45, v46
    v_cvt_pk_bf16_f32 v37, v37, v37
    v_lshlrev_b32 v37, 16, v37
    v_sub_f32 v38, v38, v41
    v_cvt_pk_bf16_f32 v38, v38, v38
    v_lshlrev_b32 v38, 16, v38
    v_mul_f32 v46, v38, v45
    v_fma_f32 v47, -v46, v43, v38
    v_fma_f32 v38, v47, v45, v46
    v_cvt_pk_bf16_f32 v38, v38, v38
    v_lshlrev_b32 v38, 16, v38
    v_sub_f32 v39, v39, v41
    v_cvt_pk_bf16_f32 v39, v39, v39
    v_lshlrev_b32 v39, 16, v39
    v_mul_f32 v46, v39, v45
    v_fma_f32 v47, -v46, v43, v39
    v_fma_f32 v39, v47, v45, v46
    v_cvt_pk_bf16_f32 v39, v39, v39
    v_lshlrev_b32 v39, 16, v39
    s_mul_i32 s21, s20, 5120
    v_lshlrev_b32 v3, 4, v1
    v_add_u32 v3, s21, v3
    v_mov_b32 v4, v20
    v_mov_b32 v5, v30
    v_mov_b32 v6, v21
    v_mov_b32 v7, v31
    ds_write_b128 v3, v[4:7] offset:0
    v_mov_b32 v4, v22
    v_mov_b32 v5, v32
    v_mov_b32 v6, v23
    v_mov_b32 v7, v33
    ds_write_b128 v3, v[4:7] offset:1024
    v_mov_b32 v4, v24
    v_mov_b32 v5, v34
    v_mov_b32 v6, v25
    v_mov_b32 v7, v35
    ds_write_b128 v3, v[4:7] offset:2048
    v_mov_b32 v4, v26
    v_mov_b32 v5, v36
    v_mov_b32 v6, v27
    v_mov_b32 v7, v37
    ds_write_b128 v3, v[4:7] offset:3072
    v_mov_b32 v4, v28
    v_mov_b32 v5, v38
    v_mov_b32 v6, v29
    v_mov_b32 v7, v39
    ds_write_b128 v3, v[4:7] offset:4096
    v_cvt_f32_u32 v40, v1
    v_mul_f32 v20, 0xbacccccd, v40
    v_fract_f32 v20, v20
    v_sin_f32 v21, v20
    v_cos_f32 v20, v20
    v_mul_f32 v22, 0xbb4ccccd, v40
    v_fract_f32 v22, v22
    v_sin_f32 v23, v22
    v_cos_f32 v22, v22
    v_mul_f32 v24, 0xbb99999a, v40
    v_fract_f32 v24, v24
    v_sin_f32 v25, v24
    v_cos_f32 v24, v24
    v_mul_f32 v26, 0xbbcccccd, v40
    v_fract_f32 v26, v26
    v_sin_f32 v27, v26
    v_cos_f32 v26, v26
    v_mul_f32 v28, 0xbc000000, v40
    v_fract_f32 v28, v28
    v_sin_f32 v29, v28
    v_cos_f32 v28, v28
    v_mul_f32 v30, 0xbc19999a, v40
    v_fract_f32 v30, v30
    v_sin_f32 v31, v30
    v_cos_f32 v30, v30
    v_mul_f32 v32, 0xbc333333, v40
    v_fract_f32 v32, v32
    v_sin_f32 v33, v32
    v_cos_f32 v32, v32
    v_mul_f32 v34, 0xbc4ccccd, v40
    v_fract_f32 v34, v34
    v_sin_f32 v35, v34
    v_cos_f32 v34, v34
    v_mul_f32 v36, 0xbc666666, v40
    v_fract_f32 v36, v36
    v_sin_f32 v37, v36
    v_cos_f32 v36, v36
    s_nop 0
    v_lshlrev_b32 v3, 3, v1
    v_add_u32 v3, s21, v3
    s_waitcnt lgkmcnt(0)
    ds_read_b64 v[64:65], v3 offset:0
    ds_read_b64 v[66:67], v3 offset:512
    ds_read_b64 v[68:69], v3 offset:1024
    ds_read_b64 v[70:71], v3 offset:1536
    ds_read_b64 v[72:73], v3 offset:2048
    ds_read_b64 v[74:75], v3 offset:2560
    ds_read_b64 v[76:77], v3 offset:3072
    ds_read_b64 v[78:79], v3 offset:3584
    ds_read_b64 v[80:81], v3 offset:4096
    ds_read_b64 v[82:83], v3 offset:4608
    s_waitcnt lgkmcnt(0)
    v_add_f32 v84, v64, v74
    v_add_f32 v85, v65, v75
    v_sub_f32 v86, v64, v74
    v_sub_f32 v87, v65, v75
    v_add_f32 v88, v66, v76
    v_add_f32 v89, v67, v77
    v_sub_f32 v90, v66, v76
    v_sub_f32 v91, v67, v77
    v_add_f32 v92, v68, v78
    v_add_f32 v93, v69, v79
    v_sub_f32 v94, v68, v78
    v_sub_f32 v95, v69, v79
    v_add_f32 v96, v70, v80
    v_add_f32 v97, v71, v81
    v_sub_f32 v98, v70, v80
    v_sub_f32 v99, v71, v81
    v_add_f32 v100, v72, v82
    v_add_f32 v101, v73, v83
    v_sub_f32 v102, v72, v82
    v_sub_f32 v103, v73, v83
    v_mul_f32 v104, s47, v91
    v_fma_f32 v104, s46, v90, v104
    v_mul_f32 v105, s47, v90
    v_fma_f32 v105, s46, v91, -v105
    v_mul_f32 v106, s49, v95
    v_fma_f32 v106, s48, v94, v106
    v_mul_f32 v107, s49, v94
    v_fma_f32 v107, s48, v95, -v107
    v_mul_f32 v108, s51, v99
    v_fma_f32 v108, s50, v98, v108
    v_mul_f32 v109, s51, v98
    v_fma_f32 v109, s50, v99, -v109
    v_mul_f32 v110, s53, v103
    v_fma_f32 v110, s52, v102, v110
    v_mul_f32 v111, s53, v102
    v_fma_f32 v111, s52, v103, -v111
    v_add_f32 v64, v88, v100
    v_add_f32 v65, v89, v101
    v_add_f32 v74, v92, v96
    v_add_f32 v75, v93, v97
    v_sub_f32 v66, v88, v100
    v_sub_f32 v67, v89, v101
    v_sub_f32 v76, v92, v96
    v_sub_f32 v77, v93, v97
    v_add_f32 v68, v84, v64
    v_add_f32 v68, v68, v74
    v_fma_f32 v78, s42, v64, v84
    v_fma_f32 v78, s43, v74, v78
    v_fma_f32 v70, s43, v64, v84
    v_fma_f32 v70, s42, v74, v70
    v_add_f32 v69, v85, v65
    v_add_f32 v69, v69, v75
    v_fma_f32 v79, s42, v65, v85
    v_fma_f32 v79, s43, v75, v79
    v_fma_f32 v71, s43, v65, v85
    v_fma_f32 v71, s42, v75, v71
    v_mul_f32 v80, s44, v66
    v_fma_f32 v80, s45, v76, v80
    v_mul_f32 v72, s45, v66
    v_fma_f32 v72, -s44, v76, v72
    v_mul_f32 v81, s44, v67
    v_fma_f32 v81, s45, v77, v81
    v_mul_f32 v73, s45, v67
    v_fma_f32 v73, -s44, v77, v73
    v_add_f32 v82, v78, v81
    v_sub_f32 v83, v79, v80
    v_sub_f32 v90, v78, v81
    v_add_f32 v91, v79, v80
    v_add_f32 v94, v70, v73
    v_sub_f32 v95, v71, v72
    v_sub_f32 v98, v70, v73
    v_add_f32 v99, v71, v72
    v_add_f32 v102, v104, v110
    v_add_f32 v103, v105, v111
    v_add_f32 v88, v106, v108
    v_add_f32 v89, v107, v109
    v_sub_f32 v92, v104, v110
    v_sub_f32 v93, v105, v111
    v_sub_f32 v96, v106, v108
    v_sub_f32 v97, v107, v109
    v_add_f32 v100, v86, v102
    v_add_f32 v100, v100, v88
    v_fma_f32 v84, s42, v102, v86
    v_fma_f32 v84, s43, v88, v84
    v_fma_f32 v64, s43, v102, v86
    v_fma_f32 v64, s42, v88, v64
    v_add_f32 v101, v87, v103
    v_add_f32 v101, v101, v89
    v_fma_f32 v85, s42, v103, v87
    v_fma_f32 v85, s43, v89, v85
    v_fma_f32 v65, s43, v103, v87
    v_fma_f32 v65, s42, v89, v65
    v_mul_f32 v74, s44, v92
    v_fma_f32 v74, s45, v96, v74
    v_mul_f32 v66, s45, v92
    v_fma_f32 v66, -s44, v96, v66
    v_mul_f32 v75, s44, v93
    v_fma_f32 v75, s45, v97, v75
    v_mul_f32 v67, s45, v93
    v_fma_f32 v67, -s44, v97, v67
    v_add_f32 v76, v84, v75
    v_sub_f32 v77, v85, v74
    v_sub_f32 v78, v84, v75
    v_add_f32 v79, v85, v74
    v_add_f32 v80, v64, v67
    v_sub_f32 v81, v65, v66
    v_sub_f32 v70, v64, v67
    v_add_f32 v71, v65, v66
    v_mul_f32 v72, v101, v21
    v_fma_f32 v72, v100, v20, -v72
    v_mul_f32 v73, v100, v21
    v_fma_f32 v73, v101, v20, v73
    v_mul_f32 v104, v83, v23
    v_fma_f32 v104, v82, v22, -v104
    v_mul_f32 v105, v82, v23
    v_fma_f32 v105, v83, v22, v105
    v_mul_f32 v106, v77, v25
    v_fma_f32 v106, v76, v24, -v106
    v_mul_f32 v107, v76, v25
    v_fma_f32 v107, v77, v24, v107
    v_mul_f32 v108, v95, v27
    v_fma_f32 v108, v94, v26, -v108
    v_mul_f32 v109, v94, v27
    v_fma_f32 v109, v95, v26, v109
    v_mul_f32 v110, v81, v29
    v_fma_f32 v110, v80, v28, -v110
    v_mul_f32 v111, v80, v29
    v_fma_f32 v111, v81, v28, v111
    v_mul_f32 v86, v99, v31
    v_fma_f32 v86, v98, v30, -v86
    v_mul_f32 v87, v98, v31
    v_fma_f32 v87, v99, v30, v87
    v_mul_f32 v102, v71, v33
    v_fma_f32 v102, v70, v32, -v102
    v_mul_f32 v103, v70, v33
    v_fma_f32 v103, v71, v32, v103
    v_mul_f32 v88, v91, v35
    v_fma_f32 v88, v90, v34, -v88
    v_mul_f32 v89, v90, v35
    v_fma_f32 v89, v91, v34, v89
    v_mul_f32 v92, v79, v37
    v_fma_f32 v92, v78, v36, -v92
    v_mul_f32 v93, v78, v37
    v_fma_f32 v93, v79, v36, v93
    s_mul_i32 s21, s20, 5760
    v_lshlrev_b32 v3, 3, v1
    v_add_u32 v3, s21, v3
    ds_write_b64 v3, v[68:69] offset:23040
    ds_write_b64 v3, v[72:73] offset:23616
    ds_write_b64 v3, v[104:105] offset:24192
    ds_write_b64 v3, v[106:107] offset:24768
    ds_write_b64 v3, v[108:109] offset:25344
    ds_write_b64 v3, v[110:111] offset:25920
    ds_write_b64 v3, v[86:87] offset:26496
    ds_write_b64 v3, v[102:103] offset:27072
    ds_write_b64 v3, v[88:89] offset:27648
    ds_write_b64 v3, v[92:93] offset:28224
.Lk1b_kernel_skipln:
    s_waitcnt lgkmcnt(0)
    s_barrier
    v_lshrrev_b32 v4, 3, v0
    v_and_b32 v5, 7, v0
    v_cvt_f32_u32 v40, v5
    v_mul_f32 v20, 0xbc800000, v40
    v_fract_f32 v20, v20
    v_sin_f32 v21, v20
    v_cos_f32 v20, v20
    v_mul_f32 v22, 0xbd000000, v40
    v_fract_f32 v22, v22
    v_sin_f32 v23, v22
    v_cos_f32 v22, v22
    v_mul_f32 v24, 0xbd400000, v40
    v_fract_f32 v24, v24
    v_sin_f32 v25, v24
    v_cos_f32 v24, v24
    v_mul_f32 v26, 0xbd800000, v40
    v_fract_f32 v26, v26
    v_sin_f32 v27, v26
    v_cos_f32 v26, v26
    v_mul_f32 v28, 0xbda00000, v40
    v_fract_f32 v28, v28
    v_sin_f32 v29, v28
    v_cos_f32 v28, v28
    v_mul_f32 v30, 0xbdc00000, v40
    v_fract_f32 v30, v30
    v_sin_f32 v31, v30
    v_cos_f32 v30, v30
    v_mul_f32 v32, 0xbde00000, v40
    v_fract_f32 v32, v32
    v_sin_f32 v33, v32
    v_cos_f32 v32, v32
    s_nop 0
    v_mul_u32_u24 v3, 576, v4
    v_lshl_add_u32 v3, v5, 3, v3
    ds_read_b64 v[96:97], v3 offset:23040
    ds_read_b64 v[84:85], v3 offset:23104
    ds_read_b64 v[74:75], v3 offset:23168
    ds_read_b64 v[64:65], v3 offset:23232
    ds_read_b64 v[66:67], v3 offset:23296
    ds_read_b64 v[100:101], v3 offset:23360
    ds_read_b64 v[82:83], v3 offset:23424
    ds_read_b64 v[76:77], v3 offset:23488
    s_waitcnt lgkmcnt(0)
    v_add_f32 v94, v96, v66
    v_add_f32 v95, v97, v67
    v_sub_f32 v80, v96, v66
    v_sub_f32 v81, v97, v67
    v_add_f32 v98, v84, v100
    v_add_f32 v99, v85, v101
    v_sub_f32 v70, v84, v100
    v_sub_f32 v71, v85, v101
    v_add_f32 v90, v74, v82
    v_add_f32 v91, v75, v83
    v_sub_f32 v78, v74, v82
    v_sub_f32 v79, v75, v83
    v_add_f32 v68, v64, v76
    v_add_f32 v69, v65, v77
    v_sub_f32 v72, v64, v76
    v_sub_f32 v73, v65, v77
    v_add_f32 v104, v70, v71
    v_sub_f32 v105, v71, v70
    v_mul_f32 v104, s40, v104
    v_mul_f32 v105, s40, v105
    v_sub_f32 v106, v73, v72
    v_add_f32 v107, v72, v73
    v_mul_f32 v106, s40, v106
    v_mul_f32 v107, s41, v107
    v_mov_b32 v108, v79
    v_sub_f32 v109, 0, v78
    v_add_f32 v110, v94, v90
    v_add_f32 v111, v95, v91
    v_sub_f32 v86, v94, v90
    v_sub_f32 v87, v95, v91
    v_add_f32 v102, v98, v68
    v_add_f32 v103, v99, v69
    v_sub_f32 v88, v98, v68
    v_sub_f32 v89, v99, v69
    v_add_f32 v92, v110, v102
    v_add_f32 v93, v111, v103
    v_sub_f32 v96, v110, v102
    v_sub_f32 v97, v111, v103
    v_add_f32 v66, v86, v89
    v_sub_f32 v67, v87, v88
    v_sub_f32 v84, v86, v89
    v_add_f32 v85, v87, v88
    v_add_f32 v100, v80, v108
    v_add_f32 v101, v81, v109
    v_sub_f32 v74, v80, v108
    v_sub_f32 v75, v81, v109
    v_add_f32 v82, v104, v106
    v_add_f32 v83, v105, v107
    v_sub_f32 v64, v104, v106
    v_sub_f32 v65, v105, v107
    v_add_f32 v76, v100, v82
    v_add_f32 v77, v101, v83
    v_sub_f32 v70, v100, v82
    v_sub_f32 v71, v101, v83
    v_add_f32 v72, v74, v65
    v_sub_f32 v73, v75, v64
    v_sub_f32 v78, v74, v65
    v_add_f32 v79, v75, v64
    v_mul_f32 v94, v77, v21
    v_fma_f32 v94, v76, v20, -v94
    v_mul_f32 v95, v76, v21
    v_fma_f32 v95, v77, v20, v95
    v_mul_f32 v98, v67, v23
    v_fma_f32 v98, v66, v22, -v98
    v_mul_f32 v99, v66, v23
    v_fma_f32 v99, v67, v22, v99
    v_mul_f32 v90, v73, v25
    v_fma_f32 v90, v72, v24, -v90
    v_mul_f32 v91, v72, v25
    v_fma_f32 v91, v73, v24, v91
    v_mul_f32 v68, v97, v27
    v_fma_f32 v68, v96, v26, -v68
    v_mul_f32 v69, v96, v27
    v_fma_f32 v69, v97, v26, v69
    v_mul_f32 v110, v71, v29
    v_fma_f32 v110, v70, v28, -v110
    v_mul_f32 v111, v70, v29
    v_fma_f32 v111, v71, v28, v111
    v_mul_f32 v102, v85, v31
    v_fma_f32 v102, v84, v30, -v102
    v_mul_f32 v103, v84, v31
    v_fma_f32 v103, v85, v30, v103
    v_mul_f32 v86, v79, v33
    v_fma_f32 v86, v78, v32, -v86
    v_mul_f32 v87, v78, v33
    v_fma_f32 v87, v79, v32, v87
    v_mul_u32_u24 v3, 576, v4
    v_lshl_add_u32 v3, v5, 3, v3
    ds_write_b64 v3, v[92:93] offset:0
    ds_write_b64 v3, v[94:95] offset:72
    ds_write_b64 v3, v[98:99] offset:144
    ds_write_b64 v3, v[90:91] offset:216
    ds_write_b64 v3, v[68:69] offset:288
    ds_write_b64 v3, v[110:111] offset:360
    ds_write_b64 v3, v[102:103] offset:432
    ds_write_b64 v3, v[86:87] offset:504
    s_waitcnt lgkmcnt(0)
    s_barrier
    v_mul_u32_u24 v3, 72, v0
    ds_read_b64 v[88:89], v3 offset:0
    ds_read_b64 v[80:81], v3 offset:8
    ds_read_b64 v[104:105], v3 offset:16
    ds_read_b64 v[108:109], v3 offset:24
    ds_read_b64 v[106:107], v3 offset:32
    ds_read_b64 v[100:101], v3 offset:40
    ds_read_b64 v[82:83], v3 offset:48
    ds_read_b64 v[74:75], v3 offset:56
    s_waitcnt lgkmcnt(0)
    v_add_f32 v64, v88, v106
    v_add_f32 v65, v89, v107
    v_sub_f32 v76, v88, v106
    v_sub_f32 v77, v89, v107
    v_add_f32 v66, v80, v100
    v_add_f32 v67, v81, v101
    v_sub_f32 v72, v80, v100
    v_sub_f32 v73, v81, v101
    v_add_f32 v96, v104, v82
    v_add_f32 v97, v105, v83
    v_sub_f32 v70, v104, v82
    v_sub_f32 v71, v105, v83
    v_add_f32 v84, v108, v74
    v_add_f32 v85, v109, v75
    v_sub_f32 v78, v108, v74
    v_sub_f32 v79, v109, v75
    v_add_f32 v92, v72, v73
    v_sub_f32 v93, v73, v72
    v_mul_f32 v92, s40, v92
    v_mul_f32 v93, s40, v93
    v_sub_f32 v94, v79, v78
    v_add_f32 v95, v78, v79
    v_mul_f32 v94, s40, v94
    v_mul_f32 v95, s41, v95
    v_mov_b32 v98, v71
    v_sub_f32 v99, 0, v70
    v_add_f32 v90, v64, v96
    v_add_f32 v91, v65, v97
    v_sub_f32 v68, v64, v96
    v_sub_f32 v69, v65, v97
    v_add_f32 v110, v66, v84
    v_add_f32 v111, v67, v85
    v_sub_f32 v102, v66, v84
    v_sub_f32 v103, v67, v85
    v_add_f32 v86, v90, v110
    v_add_f32 v87, v91, v111
    v_sub_f32 v88, v90, v110
    v_sub_f32 v89, v91, v111
    v_add_f32 v106, v68, v103
    v_sub_f32 v107, v69, v102
    v_sub_f32 v80, v68, v103
    v_add_f32 v81, v69, v102
    v_add_f32 v100, v76, v98
    v_add_f32 v101, v77, v99
    v_sub_f32 v104, v76, v98
    v_sub_f32 v105, v77, v99
    v_add_f32 v82, v92, v94
    v_add_f32 v83, v93, v95
    v_sub_f32 v108, v92, v94
    v_sub_f32 v109, v93, v95
    v_add_f32 v74, v100, v82
    v_add_f32 v75, v101, v83
    v_sub_f32 v72, v100, v82
    v_sub_f32 v73, v101, v83
    v_add_f32 v78, v104, v109
    v_sub_f32 v79, v105, v108
    v_sub_f32 v70, v104, v109
    v_add_f32 v71, v105, v108
    v_mul_u32_u24 v6, 205, v4
    v_lshrrev_b32 v6, 11, v6
    v_mul_u32_u24 v7, 10, v6
    v_sub_u32 v7, v4, v7
    v_mul_u32_u24 v3, 10, v5
    v_add_u32 v7, v7, v3
    v_mul_u32_u24 v3, 648, v6
    v_add_u32 v3, v3, v7
    v_lshlrev_b32 v3, 3, v3
    ds_write_b64 v3, v[86:87] offset:23040
    ds_write_b64 v3, v[74:75] offset:23680
    ds_write_b64 v3, v[106:107] offset:24320
    ds_write_b64 v3, v[78:79] offset:24960
    ds_write_b64 v3, v[88:89] offset:25600
    ds_write_b64 v3, v[72:73] offset:26240
    ds_write_b64 v3, v[80:81] offset:26880
    ds_write_b64 v3, v[70:71] offset:27520
    s_waitcnt lgkmcnt(0)
    s_barrier
    v_and_b32 v4, 3, v0
    v_lshrrev_b32 v5, 2, v0
    v_mul_u32_u24 v6, 5184, v4
    s_lshl_b32 s21, s2, 6
    v_lshlrev_b32 v7, 4, v4
    v_add_u32 v7, s21, v7
    v_lshl_add_u32 v8, v5, 3, v6
    v_sub_u32 v9, 640, v5
    v_cmp_eq_u32 vcc, 0, v5
    s_nop 1
    v_cndmask_b32 v9, v9, 0, vcc
    v_lshl_add_u32 v9, v9, 3, v6
    ds_read_b64 v[10:11], v8 offset:23040
    ds_read_b64 v[12:13], v9 offset:23040
    v_lshl_add_u32 v14, v5, 14, v7
    s_waitcnt lgkmcnt(0)
    v_add_f32 v16, v10, v12
    v_sub_f32 v17, v11, v13
    v_add_f32 v18, v11, v13
    v_sub_f32 v19, v12, v10
    buffer_store_dwordx4 v[16:19], v14, s[12:15], 0 offen
    v_add_u32 v5, 80, v5
    v_lshl_add_u32 v8, v5, 3, v6
    v_sub_u32 v9, 640, v5
    v_cmp_eq_u32 vcc, 0, v5
    s_nop 1
    v_cndmask_b32 v9, v9, 0, vcc
    v_lshl_add_u32 v9, v9, 3, v6
    ds_read_b64 v[10:11], v8 offset:23040
    ds_read_b64 v[12:13], v9 offset:23040
    v_lshl_add_u32 v14, v5, 14, v7
    s_waitcnt lgkmcnt(0)
    v_add_f32 v16, v10, v12
    v_sub_f32 v17, v11, v13
    v_add_f32 v18, v11, v13
    v_sub_f32 v19, v12, v10
    buffer_store_dwordx4 v[16:19], v14, s[12:15], 0 offen
    v_add_u32 v5, 80, v5
    v_lshl_add_u32 v8, v5, 3, v6
    v_sub_u32 v9, 640, v5
    v_cmp_eq_u32 vcc, 0, v5
    s_nop 1
    v_cndmask_b32 v9, v9, 0, vcc
    v_lshl_add_u32 v9, v9, 3, v6
    ds_read_b64 v[10:11], v8 offset:23040
    ds_read_b64 v[12:13], v9 offset:23040
    v_lshl_add_u32 v14, v5, 14, v7
    s_waitcnt lgkmcnt(0)
    v_add_f32 v16, v10, v12
    v_sub_f32 v17, v11, v13
    v_add_f32 v18, v11, v13
    v_sub_f32 v19, v12, v10
    buffer_store_dwordx4 v[16:19], v14, s[12:15], 0 offen
    v_add_u32 v5, 80, v5
    v_lshl_add_u32 v8, v5, 3, v6
    v_sub_u32 v9, 640, v5
    v_cmp_eq_u32 vcc, 0, v5
    s_nop 1
    v_cndmask_b32 v9, v9, 0, vcc
    v_lshl_add_u32 v9, v9, 3, v6
    ds_read_b64 v[10:11], v8 offset:23040
    ds_read_b64 v[12:13], v9 offset:23040
    v_lshl_add_u32 v14, v5, 14, v7
    s_waitcnt lgkmcnt(0)
    v_add_f32 v16, v10, v12
    v_sub_f32 v17, v11, v13
    v_add_f32 v18, v11, v13
    v_sub_f32 v19, v12, v10
    buffer_store_dwordx4 v[16:19], v14, s[12:15], 0 offen
    v_add_u32 v5, 80, v5
    v_cmp_ge_u32 vcc, 320, v5
    s_and_saveexec_b64 s[22:23], vcc
    v_lshl_add_u32 v8, v5, 3, v6
    v_sub_u32 v9, 640, v5
    v_cmp_eq_u32 vcc, 0, v5
    s_nop 1
    v_cndmask_b32 v9, v9, 0, vcc
    v_lshl_add_u32 v9, v9, 3, v6
    ds_read_b64 v[10:11], v8 offset:23040
    ds_read_b64 v[12:13], v9 offset:23040
    v_lshl_add_u32 v14, v5, 14, v7
    s_waitcnt lgkmcnt(0)
    v_add_f32 v16, v10, v12
    v_sub_f32 v17, v11, v13
    v_add_f32 v18, v11, v13
    v_sub_f32 v19, v12, v10
    buffer_store_dwordx4 v[16:19], v14, s[12:15], 0 offen
    s_mov_b64 exec, s[22:23]
.Lk1b_kernel_end:
    s_endpgm
.globl k2b_kernel
.p2align 8
.type k2b_kernel,@function
k2b_kernel:
    s_cmp_ge_u32 s2, 321
    s_cbranch_scc1 .Lk2b_kernel_end
    s_load_dwordx2 s[4:5], s[0:1], 72
    s_lshl_b32 s3, s2, 14
    s_add_u32 s6, s3, 6291456
    s_waitcnt lgkmcnt(0)
    s_add_u32 s8, s4, s3
    s_addc_u32 s9, s5, 0
    s_mov_b32 s10, 16384
    s_mov_b32 s11, 0x00020000
    s_add_u32 s12, s4, s6
    s_addc_u32 s13, s5, 0
    s_mov_b32 s14, 16384
    s_mov_b32 s15, 0x00020000
    s_mov_b32 s16, 0x3f3504f3
    s_mov_b32 s17, 0xbf3504f3
    s_mov_b32 s18, 4096
    s_mov_b32 s19, 8192
    s_mov_b32 s20, 12288
    v_lshlrev_b32 v1, 3, v0
    buffer_load_dwordx2 v[66:67], v1, s[8:11], 0 offen offset:0
    buffer_load_dwordx2 v[68:69], v1, s[8:11], 0 offen offset:2048
    buffer_load_dwordx2 v[70:71], v1, s[8:11], s18 offen offset:0
    buffer_load_dwordx2 v[72:73], v1, s[8:11], s18 offen offset:2048
    buffer_load_dwordx2 v[74:75], v1, s[8:11], s19 offen offset:0
    buffer_load_dwordx2 v[76:77], v1, s[8:11], s19 offen offset:2048
    buffer_load_dwordx2 v[78:79], v1, s[8:11], s20 offen offset:0
    buffer_load_dwordx2 v[80:81], v1, s[8:11], s20 offen offset:2048
    v_lshlrev_b32 v6, 6, v0
    buffer_load_dwordx4 v[50:53], v6, s[12:15], 0 offen offset:0
    buffer_load_dwordx4 v[54:57], v6, s[12:15], 0 offen offset:16
    buffer_load_dwordx4 v[58:61], v6, s[12:15], 0 offen offset:32
    buffer_load_dwordx4 v[62:65], v6, s[12:15], 0 offen offset:48
    v_lshrrev_b32 v6, 5, v0
    v_and_b32 v2, 31, v0
    v_lshlrev_b32 v3, 3, v2
    v_lshl_add_u32 v2, v6, 11, v3
    v_mul_u32_u24 v6, 2304, v6
    v_add_u32 v3, v6, v3
    v_lshrrev_b32 v6, 2, v0
    v_mul_u32_u24 v4, 288, v6
    v_and_b32 v6, 3, v0
    v_lshl_add_u32 v4, v6, 3, v4
    v_lshrrev_b32 v5, 2, v0
    v_mul_u32_u24 v5, 288, v5
    v_lshl_add_u32 v5, v6, 6, v5
    v_cvt_f32_u32 v6, v0
    v_mul_f32 v8, 0xba000000, v6
    v_fract_f32 v8, v8
    v_sin_f32 v9, v8
    v_cos_f32 v8, v8
    v_mul_f32 v10, 0xba800000, v6
    v_fract_f32 v10, v10
    v_sin_f32 v11, v10
    v_cos_f32 v10, v10
    v_mul_f32 v12, 0xbac00000, v6
    v_fract_f32 v12, v12
    v_sin_f32 v13, v12
    v_cos_f32 v12, v12
    v_mul_f32 v14, 0xbb000000, v6
    v_fract_f32 v14, v14
    v_sin_f32 v15, v14
    v_cos_f32 v14, v14
    v_mul_f32 v16, 0xbb200000, v6
    v_fract_f32 v16, v16
    v_sin_f32 v17, v16
    v_cos_f32 v16, v16
    v_mul_f32 v18, 0xbb400000, v6
    v_fract_f32 v18, v18
    v_sin_f32 v19, v18
    v_cos_f32 v18, v18
    v_mul_f32 v20, 0xbb600000, v6
    v_fract_f32 v20, v20
    v_sin_f32 v21, v20
    v_cos_f32 v20, v20
    s_nop 0
    v_and_b32 v7, 31, v0
    v_cvt_f32_u32 v6, v7
    v_mul_f32 v22, 0xbb800000, v6
    v_fract_f32 v22, v22
    v_sin_f32 v23, v22
    v_cos_f32 v22, v22
    v_mul_f32 v24, 0xbc000000, v6
    v_fract_f32 v24, v24
    v_sin_f32 v25, v24
    v_cos_f32 v24, v24
    v_mul_f32 v26, 0xbc400000, v6
    v_fract_f32 v26, v26
    v_sin_f32 v27, v26
    v_cos_f32 v26, v26
    v_mul_f32 v28, 0xbc800000, v6
    v_fract_f32 v28, v28
    v_sin_f32 v29, v28
    v_cos_f32 v28, v28
    v_mul_f32 v30, 0xbca00000, v6
    v_fract_f32 v30, v30
    v_sin_f32 v31, v30
    v_cos_f32 v30, v30
    v_mul_f32 v32, 0xbcc00000, v6
    v_fract_f32 v32, v32
    v_sin_f32 v33, v32
    v_cos_f32 v32, v32
    v_mul_f32 v34, 0xbce00000, v6
    v_fract_f32 v34, v34
    v_sin_f32 v35, v34
    v_cos_f32 v34, v34
    s_nop 0
    v_and_b32 v7, 3, v0
    v_cvt_f32_u32 v6, v7
    v_mul_f32 v36, 0xbd000000, v6
    v_fract_f32 v36, v36
    v_sin_f32 v37, v36
    v_cos_f32 v36, v36
    v_mul_f32 v38, 0xbd800000, v6
    v_fract_f32 v38, v38
    v_sin_f32 v39, v38
    v_cos_f32 v38, v38
    v_mul_f32 v40, 0xbdc00000, v6
    v_fract_f32 v40, v40
    v_sin_f32 v41, v40
    v_cos_f32 v40, v40
    v_mul_f32 v42, 0xbe000000, v6
    v_fract_f32 v42, v42
    v_sin_f32 v43, v42
    v_cos_f32 v42, v42
    v_mul_f32 v44, 0xbe200000, v6
    v_fract_f32 v44, v44
    v_sin_f32 v45, v44
    v_cos_f32 v44, v44
    v_mul_f32 v46, 0xbe400000, v6
    v_fract_f32 v46, v46
    v_sin_f32 v47, v46
    v_cos_f32 v46, v46
    v_mul_f32 v48, 0xbe600000, v6
    v_fract_f32 v48, v48
    v_sin_f32 v49, v48
    v_cos_f32 v48, v48
    s_nop 0
    s_waitcnt vmcnt(4)
    v_add_f32 v82, v66, v74
    v_add_f32 v83, v67, v75
    v_sub_f32 v84, v66, v74
    v_sub_f32 v85, v67, v75
    v_add_f32 v86, v68, v76
    v_add_f32 v87, v69, v77
    v_sub_f32 v88, v68, v76
    v_sub_f32 v89, v69, v77
    v_add_f32 v90, v70, v78
    v_add_f32 v91, v71, v79
    v_sub_f32 v92, v70, v78
    v_sub_f32 v93, v71, v79
    v_add_f32 v94, v72, v80
    v_add_f32 v95, v73, v81
    v_sub_f32 v96, v72, v80
    v_sub_f32 v97, v73, v81
    v_add_f32 v98, v88, v89
    v_sub_f32 v99, v89, v88
    v_mul_f32 v98, s16, v98
    v_mul_f32 v99, s16, v99
    v_sub_f32 v100, v97, v96
    v_add_f32 v101, v96, v97
    v_mul_f32 v100, s16, v100
    v_mul_f32 v101, s17, v101
    v_mov_b32 v102, v93
    v_sub_f32 v103, 0, v92
    v_add_f32 v104, v82, v90
    v_add_f32 v105, v83, v91
    v_sub_f32 v66, v82, v90
    v_sub_f32 v67, v83, v91
    v_add_f32 v74, v86, v94
    v_add_f32 v75, v87, v95
    v_sub_f32 v68, v86, v94
    v_sub_f32 v69, v87, v95
    v_add_f32 v76, v104, v74
    v_add_f32 v77, v105, v75
    v_sub_f32 v70, v104, v74
    v_sub_f32 v71, v105, v75
    v_add_f32 v78, v66, v69
    v_sub_f32 v79, v67, v68
    v_sub_f32 v72, v66, v69
    v_add_f32 v73, v67, v68
    v_add_f32 v80, v84, v102
    v_add_f32 v81, v85, v103
    v_sub_f32 v88, v84, v102
    v_sub_f32 v89, v85, v103
    v_add_f32 v96, v98, v100
    v_add_f32 v97, v99, v101
    v_sub_f32 v92, v98, v100
    v_sub_f32 v93, v99, v101
    v_add_f32 v82, v80, v96
    v_add_f32 v83, v81, v97
    v_sub_f32 v86, v80, v96
    v_sub_f32 v87, v81, v97
    v_add_f32 v90, v88, v93
    v_sub_f32 v91, v89, v92
    v_sub_f32 v94, v88, v93
    v_add_f32 v95, v89, v92
    v_mul_f32 v104, v83, v9
    v_fma_f32 v104, v82, v8, -v104
    v_mul_f32 v105, v82, v9
    v_fma_f32 v105, v83, v8, v105
    v_mul_f32 v74, v79, v11
    v_fma_f32 v74, v78, v10, -v74
    v_mul_f32 v75, v78, v11
    v_fma_f32 v75, v79, v10, v75
    v_mul_f32 v66, v91, v13
    v_fma_f32 v66, v90, v12, -v66
    v_mul_f32 v67, v90, v13
    v_fma_f32 v67, v91, v12, v67
    v_mul_f32 v68, v71, v15
    v_fma_f32 v68, v70, v14, -v68
    v_mul_f32 v69, v70, v15
    v_fma_f32 v69, v71, v14, v69
    v_mul_f32 v84, v87, v17
    v_fma_f32 v84, v86, v16, -v84
    v_mul_f32 v85, v86, v17
    v_fma_f32 v85, v87, v16, v85
    v_mul_f32 v98, v73, v19
    v_fma_f32 v98, v72, v18, -v98
    v_mul_f32 v99, v72, v19
    v_fma_f32 v99, v73, v18, v99
    v_mul_f32 v102, v95, v21
    v_fma_f32 v102, v94, v20, -v102
    v_mul_f32 v103, v94, v21
    v_fma_f32 v103, v95, v20, v103
    ds_write_b64 v1, v[76:77] offset:0
    ds_write_b64 v1, v[104:105] offset:2048
    ds_write_b64 v1, v[74:75] offset:4096
    ds_write_b64 v1, v[66:67] offset:6144
    ds_write_b64 v1, v[68:69] offset:8192
    ds_write_b64 v1, v[84:85] offset:10240
    ds_write_b64 v1, v[98:99] offset:12288
    ds_write_b64 v1, v[102:103] offset:14336
    s_waitcnt lgkmcnt(0)
    s_barrier
    ds_read_b64 v[76:77], v2 offset:0
    ds_read_b64 v[104:105], v2 offset:256
    ds_read_b64 v[74:75], v2 offset:512
    ds_read_b64 v[66:67], v2 offset:768
    ds_read_b64 v[68:69], v2 offset:1024
    ds_read_b64 v[84:85], v2 offset:1280
    ds_read_b64 v[98:99], v2 offset:1536
    ds_read_b64 v[102:103], v2 offset:1792
    s_waitcnt lgkmcnt(0)
    v_add_f32 v100, v76, v68
    v_add_f32 v101, v77, v69
    v_sub_f32 v80, v76, v68
    v_sub_f32 v81, v77, v69
    v_add_f32 v96, v104, v84
    v_add_f32 v97, v105, v85
    v_sub_f32 v88, v104, v84
    v_sub_f32 v89, v105, v85
    v_add_f32 v92, v74, v98
    v_add_f32 v93, v75, v99
    v_sub_f32 v82, v74, v98
    v_sub_f32 v83, v75, v99
    v_add_f32 v78, v66, v102
    v_add_f32 v79, v67, v103
    v_sub_f32 v90, v66, v102
    v_sub_f32 v91, v67, v103
    v_add_f32 v70, v88, v89
    v_sub_f32 v71, v89, v88
    v_mul_f32 v70, s16, v70
    v_mul_f32 v71, s16, v71
    v_sub_f32 v86, v91, v90
    v_add_f32 v87, v90, v91
    v_mul_f32 v86, s16, v86
    v_mul_f32 v87, s17, v87
    v_mov_b32 v72, v83
    v_sub_f32 v73, 0, v82
    v_add_f32 v94, v100, v92
    v_add_f32 v95, v101, v93
    v_sub_f32 v76, v100, v92
    v_sub_f32 v77, v101, v93
    v_add_f32 v68, v96, v78
    v_add_f32 v69, v97, v79
    v_sub_f32 v104, v96, v78
    v_sub_f32 v105, v97, v79
    v_add_f32 v84, v94, v68
    v_add_f32 v85, v95, v69
    v_sub_f32 v74, v94, v68
    v_sub_f32 v75, v95, v69
    v_add_f32 v98, v76, v105
    v_sub_f32 v99, v77, v104
    v_sub_f32 v66, v76, v105
    v_add_f32 v67, v77, v104
    v_add_f32 v102, v80, v72
    v_add_f32 v103, v81, v73
    v_sub_f32 v88, v80, v72
    v_sub_f32 v89, v81, v73
    v_add_f32 v90, v70, v86
    v_add_f32 v91, v71, v87
    v_sub_f32 v82, v70, v86
    v_sub_f32 v83, v71, v87
    v_add_f32 v100, v102, v90
    v_add_f32 v101, v103, v91
    v_sub_f32 v96, v102, v90
    v_sub_f32 v97, v103, v91
    v_add_f32 v92, v88, v83
    v_sub_f32 v93, v89, v82
    v_sub_f32 v78, v88, v83
    v_add_f32 v79, v89, v82
    v_mul_f32 v94, v101, v23
    v_fma_f32 v94, v100, v22, -v94
    v_mul_f32 v95, v100, v23
    v_fma_f32 v95, v101, v22, v95
    v_mul_f32 v68, v99, v25
    v_fma_f32 v68, v98, v24, -v68
    v_mul_f32 v69, v98, v25
    v_fma_f32 v69, v99, v24, v69
    v_mul_f32 v76, v93, v27
    v_fma_f32 v76, v92, v26, -v76
    v_mul_f32 v77, v92, v27
    v_fma_f32 v77, v93, v26, v77
    v_mul_f32 v104, v75, v29
    v_fma_f32 v104, v74, v28, -v104
    v_mul_f32 v105, v74, v29
    v_fma_f32 v105, v75, v28, v105
    v_mul_f32 v80, v97, v31
    v_fma_f32 v80, v96, v30, -v80
    v_mul_f32 v81, v96, v31
    v_fma_f32 v81, v97, v30, v81
    v_mul_f32 v70, v67, v33
    v_fma_f32 v70, v66, v32, -v70
    v_mul_f32 v71, v66, v33
    v_fma_f32 v71, v67, v32, v71
    v_mul_f32 v72, v79, v35
    v_fma_f32 v72, v78, v34, -v72
    v_mul_f32 v73, v78, v35
    v_fma_f32 v73, v79, v34, v73
    ds_write_b64 v3, v[84:85] offset:18432
    ds_write_b64 v3, v[94:95] offset:18720
    ds_write_b64 v3, v[68:69] offset:19008
    ds_write_b64 v3, v[76:77] offset:19296
    ds_write_b64 v3, v[104:105] offset:19584
    ds_write_b64 v3, v[80:81] offset:19872
    ds_write_b64 v3, v[70:71] offset:20160
    ds_write_b64 v3, v[72:73] offset:20448
    s_waitcnt lgkmcnt(0)
    s_barrier
    ds_read_b64 v[84:85], v4 offset:18432
    ds_read_b64 v[94:95], v4 offset:18464
    ds_read_b64 v[68:69], v4 offset:18496
    ds_read_b64 v[76:77], v4 offset:18528
    ds_read_b64 v[104:105], v4 offset:18560
    ds_read_b64 v[80:81], v4 offset:18592
    ds_read_b64 v[70:71], v4 offset:18624
    ds_read_b64 v[72:73], v4 offset:18656
    s_waitcnt lgkmcnt(0)
    v_add_f32 v86, v84, v104
    v_add_f32 v87, v85, v105
    v_sub_f32 v102, v84, v104
    v_sub_f32 v103, v85, v105
    v_add_f32 v90, v94, v80
    v_add_f32 v91, v95, v81
    v_sub_f32 v88, v94, v80
    v_sub_f32 v89, v95, v81
    v_add_f32 v82, v68, v70
    v_add_f32 v83, v69, v71
    v_sub_f32 v100, v68, v70
    v_sub_f32 v101, v69, v71
    v_add_f32 v98, v76, v72
    v_add_f32 v99, v77, v73
    v_sub_f32 v92, v76, v72
    v_sub_f32 v93, v77, v73
    v_add_f32 v74, v88, v89
    v_sub_f32 v75, v89, v88
    v_mul_f32 v74, s16, v74
    v_mul_f32 v75, s16, v75
    v_sub_f32 v96, v93, v92
    v_add_f32 v97, v92, v93
    v_mul_f32 v96, s16, v96
    v_mul_f32 v97, s17, v97
    v_mov_b32 v66, v101
    v_sub_f32 v67, 0, v100
    v_add_f32 v78, v86, v82
    v_add_f32 v79, v87, v83
    v_sub_f32 v84, v86, v82
    v_sub_f32 v85, v87, v83
    v_add_f32 v104, v90, v98
    v_add_f32 v105, v91, v99
    v_sub_f32 v94, v90, v98
    v_sub_f32 v95, v91, v99
    v_add_f32 v80, v78, v104
    v_add_f32 v81, v79, v105
    v_sub_f32 v68, v78, v104
    v_sub_f32 v69, v79, v105
    v_add_f32 v70, v84, v95
    v_sub_f32 v71, v85, v94
    v_sub_f32 v76, v84, v95
    v_add_f32 v77, v85, v94
    v_add_f32 v72, v102, v66
    v_add_f32 v73, v103, v67
    v_sub_f32 v88, v102, v66
    v_sub_f32 v89, v103, v67
    v_add_f32 v92, v74, v96
    v_add_f32 v93, v75, v97
    v_sub_f32 v100, v74, v96
    v_sub_f32 v101, v75, v97
    v_add_f32 v86, v72, v92
    v_add_f32 v87, v73, v93
    v_sub_f32 v90, v72, v92
    v_sub_f32 v91, v73, v93
    v_add_f32 v82, v88, v101
    v_sub_f32 v83, v89, v100
    v_sub_f32 v98, v88, v101
    v_add_f32 v99, v89, v100
    v_mul_f32 v78, v87, v37
    v_fma_f32 v78, v86, v36, -v78
    v_mul_f32 v79, v86, v37
    v_fma_f32 v79, v87, v36, v79
    v_mul_f32 v104, v71, v39
    v_fma_f32 v104, v70, v38, -v104
    v_mul_f32 v105, v70, v39
    v_fma_f32 v105, v71, v38, v105
    v_mul_f32 v84, v83, v41
    v_fma_f32 v84, v82, v40, -v84
    v_mul_f32 v85, v82, v41
    v_fma_f32 v85, v83, v40, v85
    v_mul_f32 v94, v69, v43
    v_fma_f32 v94, v68, v42, -v94
    v_mul_f32 v95, v68, v43
    v_fma_f32 v95, v69, v42, v95
    v_mul_f32 v102, v91, v45
    v_fma_f32 v102, v90, v44, -v102
    v_mul_f32 v103, v90, v45
    v_fma_f32 v103, v91, v44, v103
    v_mul_f32 v74, v77, v47
    v_fma_f32 v74, v76, v46, -v74
    v_mul_f32 v75, v76, v47
    v_fma_f32 v75, v77, v46, v75
    v_mul_f32 v66, v99, v49
    v_fma_f32 v66, v98, v48, -v66
    v_mul_f32 v67, v98, v49
    v_fma_f32 v67, v99, v48, v67
    ds_write_b64 v4, v[80:81] offset:0
    ds_write_b64 v4, v[78:79] offset:32
    ds_write_b64 v4, v[104:105] offset:64
    ds_write_b64 v4, v[84:85] offset:96
    ds_write_b64 v4, v[94:95] offset:128
    ds_write_b64 v4, v[102:103] offset:160
    ds_write_b64 v4, v[74:75] offset:192
    ds_write_b64 v4, v[66:67] offset:224
    s_waitcnt lgkmcnt(0)
    s_barrier
    ds_read_b64 v[80:81], v5 offset:0
    ds_read_b64 v[78:79], v5 offset:8
    ds_read_b64 v[104:105], v5 offset:16
    ds_read_b64 v[84:85], v5 offset:24
    ds_read_b64 v[94:95], v5 offset:32
    ds_read_b64 v[102:103], v5 offset:40
    ds_read_b64 v[74:75], v5 offset:48
    ds_read_b64 v[66:67], v5 offset:56
    s_waitcnt lgkmcnt(0)
    s_waitcnt vmcnt(0)
    v_add_f32 v96, v80, v104
    v_add_f32 v97, v81, v105
    v_sub_f32 v72, v80, v104
    v_sub_f32 v73, v81, v105
    v_add_f32 v92, v78, v84
    v_add_f32 v93, v79, v85
    v_sub_f32 v88, v78, v84
    v_sub_f32 v89, v79, v85
    v_add_f32 v100, v96, v92
    v_add_f32 v101, v97, v93
    v_sub_f32 v86, v96, v92
    v_sub_f32 v87, v97, v93
    v_add_f32 v70, v72, v89
    v_sub_f32 v71, v73, v88
    v_sub_f32 v82, v72, v89
    v_add_f32 v83, v73, v88
    v_mul_f32 v68, v101, v51
    v_fma_f32 v68, v100, v50, -v68
    v_mul_f32 v69, v100, v51
    v_fma_f32 v69, v101, v50, v69
    v_mul_f32 v90, v71, v53
    v_fma_f32 v90, v70, v52, -v90
    v_mul_f32 v91, v70, v53
    v_fma_f32 v91, v71, v52, v91
    v_mul_f32 v76, v87, v55
    v_fma_f32 v76, v86, v54, -v76
    v_mul_f32 v77, v86, v55
    v_fma_f32 v77, v87, v54, v77
    v_mul_f32 v98, v83, v57
    v_fma_f32 v98, v82, v56, -v98
    v_mul_f32 v99, v82, v57
    v_fma_f32 v99, v83, v56, v99
    v_add_f32 v80, v68, v76
    v_add_f32 v81, v69, v77
    v_sub_f32 v78, v68, v76
    v_sub_f32 v79, v69, v77
    v_add_f32 v104, v90, v98
    v_add_f32 v105, v91, v99
    v_sub_f32 v84, v90, v98
    v_sub_f32 v85, v91, v99
    v_add_f32 v96, v80, v104
    v_add_f32 v97, v81, v105
    v_sub_f32 v92, v80, v104
    v_sub_f32 v93, v81, v105
    v_sub_f32 v72, v78, v85
    v_add_f32 v73, v79, v84
    v_add_f32 v88, v78, v85
    v_sub_f32 v89, v79, v84
    v_add_f32 v100, v94, v74
    v_add_f32 v101, v95, v75
    v_sub_f32 v70, v94, v74
    v_sub_f32 v71, v95, v75
    v_add_f32 v86, v102, v66
    v_add_f32 v87, v103, v67
    v_sub_f32 v82, v102, v66
    v_sub_f32 v83, v103, v67
    v_add_f32 v68, v100, v86
    v_add_f32 v69, v101, v87
    v_sub_f32 v90, v100, v86
    v_sub_f32 v91, v101, v87
    v_add_f32 v76, v70, v83
    v_sub_f32 v77, v71, v82
    v_sub_f32 v98, v70, v83
    v_add_f32 v99, v71, v82
    v_mul_f32 v80, v69, v59
    v_fma_f32 v80, v68, v58, -v80
    v_mul_f32 v81, v68, v59
    v_fma_f32 v81, v69, v58, v81
    v_mul_f32 v104, v77, v61
    v_fma_f32 v104, v76, v60, -v104
    v_mul_f32 v105, v76, v61
    v_fma_f32 v105, v77, v60, v105
    v_mul_f32 v78, v91, v63
    v_fma_f32 v78, v90, v62, -v78
    v_mul_f32 v79, v90, v63
    v_fma_f32 v79, v91, v62, v79
    v_mul_f32 v84, v99, v65
    v_fma_f32 v84, v98, v64, -v84
    v_mul_f32 v85, v98, v65
    v_fma_f32 v85, v99, v64, v85
    v_add_f32 v94, v80, v78
    v_add_f32 v95, v81, v79
    v_sub_f32 v102, v80, v78
    v_sub_f32 v103, v81, v79
    v_add_f32 v74, v104, v84
    v_add_f32 v75, v105, v85
    v_sub_f32 v66, v104, v84
    v_sub_f32 v67, v105, v85
    v_add_f32 v100, v94, v74
    v_add_f32 v101, v95, v75
    v_sub_f32 v86, v94, v74
    v_sub_f32 v87, v95, v75
    v_sub_f32 v70, v102, v67
    v_add_f32 v71, v103, v66
    v_add_f32 v82, v102, v67
    v_sub_f32 v83, v103, v66
    ds_write_b64 v5, v[96:97] offset:18432
    ds_write_b64 v5, v[72:73] offset:18440
    ds_write_b64 v5, v[92:93] offset:18448
    ds_write_b64 v5, v[88:89] offset:18456
    ds_write_b64 v5, v[100:101] offset:18464
    ds_write_b64 v5, v[70:71] offset:18472
    ds_write_b64 v5, v[86:87] offset:18480
    ds_write_b64 v5, v[82:83] offset:18488
    s_waitcnt lgkmcnt(0)
    s_barrier
    ds_read_b64 v[96:97], v4 offset:18432
    ds_read_b64 v[72:73], v4 offset:18464
    ds_read_b64 v[92:93], v4 offset:18496
    ds_read_b64 v[88:89], v4 offset:18528
    ds_read_b64 v[100:101], v4 offset:18560
    ds_read_b64 v[70:71], v4 offset:18592
    ds_read_b64 v[86:87], v4 offset:18624
    ds_read_b64 v[82:83], v4 offset:18656
    s_waitcnt lgkmcnt(0)
    v_mul_f32 v68, v73, v37
    v_fma_f32 v68, v72, v36, v68
    v_mul_f32 v69, v72, v37
    v_fma_f32 v69, v73, v36, -v69
    v_mul_f32 v76, v93, v39
    v_fma_f32 v76, v92, v38, v76
    v_mul_f32 v77, v92, v39
    v_fma_f32 v77, v93, v38, -v77
    v_mul_f32 v90, v89, v41
    v_fma_f32 v90, v88, v40, v90
    v_mul_f32 v91, v88, v41
    v_fma_f32 v91, v89, v40, -v91
    v_mul_f32 v98, v101, v43
    v_fma_f32 v98, v100, v42, v98
    v_mul_f32 v99, v100, v43
    v_fma_f32 v99, v101, v42, -v99
    v_mul_f32 v80, v71, v45
    v_fma_f32 v80, v70, v44, v80
    v_mul_f32 v81, v70, v45
    v_fma_f32 v81, v71, v44, -v81
    v_mul_f32 v104, v87, v47
    v_fma_f32 v104, v86, v46, v104
    v_mul_f32 v105, v86, v47
    v_fma_f32 v105, v87, v46, -v105
    v_mul_f32 v78, v83, v49
    v_fma_f32 v78, v82, v48, v78
    v_mul_f32 v79, v82, v49
    v_fma_f32 v79, v83, v48, -v79
    v_add_f32 v84, v96, v98
    v_add_f32 v85, v97, v99
    v_sub_f32 v94, v96, v98
    v_sub_f32 v95, v97, v99
    v_add_f32 v74, v68, v80
    v_add_f32 v75, v69, v81
    v_sub_f32 v102, v68, v80
    v_sub_f32 v103, v69, v81
    v_add_f32 v66, v76, v104
    v_add_f32 v67, v77, v105
    v_sub_f32 v72, v76, v104
    v_sub_f32 v73, v77, v105
    v_add_f32 v92, v90, v78
    v_add_f32 v93, v91, v79
    v_sub_f32 v88, v90, v78
    v_sub_f32 v89, v91, v79
    v_sub_f32 v100, v102, v103
    v_add_f32 v101, v102, v103
    v_mul_f32 v100, s16, v100
    v_mul_f32 v101, s16, v101
    v_add_f32 v70, v88, v89
    v_sub_f32 v71, v88, v89
    v_mul_f32 v70, s17, v70
    v_mul_f32 v71, s16, v71
    v_sub_f32 v86, 0, v73
    v_mov_b32 v87, v72
    v_add_f32 v82, v84, v66
    v_add_f32 v83, v85, v67
    v_sub_f32 v96, v84, v66
    v_sub_f32 v97, v85, v67
    v_add_f32 v98, v74, v92
    v_add_f32 v99, v75, v93
    v_sub_f32 v68, v74, v92
    v_sub_f32 v69, v75, v93
    v_add_f32 v80, v82, v98
    v_add_f32 v81, v83, v99
    v_sub_f32 v76, v82, v98
    v_sub_f32 v77, v83, v99
    v_sub_f32 v104, v96, v69
    v_add_f32 v105, v97, v68
    v_add_f32 v90, v96, v69
    v_sub_f32 v91, v97, v68
    v_add_f32 v78, v94, v86
    v_add_f32 v79, v95, v87
    v_sub_f32 v102, v94, v86
    v_sub_f32 v103, v95, v87
    v_add_f32 v88, v100, v70
    v_add_f32 v89, v101, v71
    v_sub_f32 v72, v100, v70
    v_sub_f32 v73, v101, v71
    v_add_f32 v84, v78, v88
    v_add_f32 v85, v79, v89
    v_sub_f32 v74, v78, v88
    v_sub_f32 v75, v79, v89
    v_sub_f32 v66, v102, v73
    v_add_f32 v67, v103, v72
    v_add_f32 v92, v102, v73
    v_sub_f32 v93, v103, v72
    ds_write_b64 v4, v[80:81] offset:0
    ds_write_b64 v4, v[84:85] offset:32
    ds_write_b64 v4, v[104:105] offset:64
    ds_write_b64 v4, v[66:67] offset:96
    ds_write_b64 v4, v[76:77] offset:128
    ds_write_b64 v4, v[74:75] offset:160
    ds_write_b64 v4, v[90:91] offset:192
    ds_write_b64 v4, v[92:93] offset:224
    s_waitcnt lgkmcnt(0)
    s_barrier
    ds_read_b64 v[80:81], v3 offset:0
    ds_read_b64 v[84:85], v3 offset:288
    ds_read_b64 v[104:105], v3 offset:576
    ds_read_b64 v[66:67], v3 offset:864
    ds_read_b64 v[76:77], v3 offset:1152
    ds_read_b64 v[74:75], v3 offset:1440
    ds_read_b64 v[90:91], v3 offset:1728
    ds_read_b64 v[92:93], v3 offset:2016
    s_waitcnt lgkmcnt(0)
    v_mul_f32 v82, v85, v23
    v_fma_f32 v82, v84, v22, v82
    v_mul_f32 v83, v84, v23
    v_fma_f32 v83, v85, v22, -v83
    v_mul_f32 v98, v105, v25
    v_fma_f32 v98, v104, v24, v98
    v_mul_f32 v99, v104, v25
    v_fma_f32 v99, v105, v24, -v99
    v_mul_f32 v96, v67, v27
    v_fma_f32 v96, v66, v26, v96
    v_mul_f32 v97, v66, v27
    v_fma_f32 v97, v67, v26, -v97
    v_mul_f32 v68, v77, v29
    v_fma_f32 v68, v76, v28, v68
    v_mul_f32 v69, v76, v29
    v_fma_f32 v69, v77, v28, -v69
    v_mul_f32 v94, v75, v31
    v_fma_f32 v94, v74, v30, v94
    v_mul_f32 v95, v74, v31
    v_fma_f32 v95, v75, v30, -v95
    v_mul_f32 v100, v91, v33
    v_fma_f32 v100, v90, v32, v100
    v_mul_f32 v101, v90, v33
    v_fma_f32 v101, v91, v32, -v101
    v_mul_f32 v86, v93, v35
    v_fma_f32 v86, v92, v34, v86
    v_mul_f32 v87, v92, v35
    v_fma_f32 v87, v93, v34, -v87
    v_add_f32 v70, v80, v68
    v_add_f32 v71, v81, v69
    v_sub_f32 v78, v80, v68
    v_sub_f32 v79, v81, v69
    v_add_f32 v88, v82, v94
    v_add_f32 v89, v83, v95
    v_sub_f32 v102, v82, v94
    v_sub_f32 v103, v83, v95
    v_add_f32 v72, v98, v100
    v_add_f32 v73, v99, v101
    v_sub_f32 v84, v98, v100
    v_sub_f32 v85, v99, v101
    v_add_f32 v104, v96, v86
    v_add_f32 v105, v97, v87
    v_sub_f32 v66, v96, v86
    v_sub_f32 v67, v97, v87
    v_sub_f32 v76, v102, v103
    v_add_f32 v77, v102, v103
    v_mul_f32 v76, s16, v76
    v_mul_f32 v77, s16, v77
    v_add_f32 v74, v66, v67
    v_sub_f32 v75, v66, v67
    v_mul_f32 v74, s17, v74
    v_mul_f32 v75, s16, v75
    v_sub_f32 v90, 0, v85
    v_mov_b32 v91, v84
    v_add_f32 v92, v70, v72
    v_add_f32 v93, v71, v73
    v_sub_f32 v80, v70, v72
    v_sub_f32 v81, v71, v73
    v_add_f32 v68, v88, v104
    v_add_f32 v69, v89, v105
    v_sub_f32 v82, v88, v104
    v_sub_f32 v83, v89, v105
    v_add_f32 v94, v92, v68
    v_add_f32 v95, v93, v69
    v_sub_f32 v98, v92, v68
    v_sub_f32 v99, v93, v69
    v_sub_f32 v100, v80, v83
    v_add_f32 v101, v81, v82
    v_add_f32 v96, v80, v83
    v_sub_f32 v97, v81, v82
    v_add_f32 v86, v78, v90
    v_add_f32 v87, v79, v91
    v_sub_f32 v102, v78, v90
    v_sub_f32 v103, v79, v91
    v_add_f32 v66, v76, v74
    v_add_f32 v67, v77, v75
    v_sub_f32 v84, v76, v74
    v_sub_f32 v85, v77, v75
    v_add_f32 v70, v86, v66
    v_add_f32 v71, v87, v67
    v_sub_f32 v88, v86, v66
    v_sub_f32 v89, v87, v67
    v_sub_f32 v72, v102, v85
    v_add_f32 v73, v103, v84
    v_add_f32 v104, v102, v85
    v_sub_f32 v105, v103, v84
    ds_write_b64 v2, v[94:95] offset:18432
    ds_write_b64 v2, v[70:71] offset:18688
    ds_write_b64 v2, v[100:101] offset:18944
    ds_write_b64 v2, v[72:73] offset:19200
    ds_write_b64 v2, v[98:99] offset:19456
    ds_write_b64 v2, v[88:89] offset:19712
    ds_write_b64 v2, v[96:97] offset:19968
    ds_write_b64 v2, v[104:105] offset:20224
    s_waitcnt lgkmcnt(0)
    s_barrier
    ds_read_b64 v[94:95], v1 offset:18432
    ds_read_b64 v[70:71], v1 offset:20480
    ds_read_b64 v[100:101], v1 offset:22528
    ds_read_b64 v[72:73], v1 offset:24576
    ds_read_b64 v[98:99], v1 offset:26624
    ds_read_b64 v[88:89], v1 offset:28672
    ds_read_b64 v[96:97], v1 offset:30720
    ds_read_b64 v[104:105], v1 offset:32768
    s_waitcnt lgkmcnt(0)
    v_mul_f32 v92, v71, v9
    v_fma_f32 v92, v70, v8, v92
    v_mul_f32 v93, v70, v9
    v_fma_f32 v93, v71, v8, -v93
    v_mul_f32 v68, v101, v11
    v_fma_f32 v68, v100, v10, v68
    v_mul_f32 v69, v100, v11
    v_fma_f32 v69, v101, v10, -v69
    v_mul_f32 v80, v73, v13
    v_fma_f32 v80, v72, v12, v80
    v_mul_f32 v81, v72, v13
    v_fma_f32 v81, v73, v12, -v81
    v_mul_f32 v82, v99, v15
    v_fma_f32 v82, v98, v14, v82
    v_mul_f32 v83, v98, v15
    v_fma_f32 v83, v99, v14, -v83
    v_mul_f32 v78, v89, v17
    v_fma_f32 v78, v88, v16, v78
    v_mul_f32 v79, v88, v17
    v_fma_f32 v79, v89, v16, -v79
    v_mul_f32 v76, v97, v19
    v_fma_f32 v76, v96, v18, v76
    v_mul_f32 v77, v96, v19
    v_fma_f32 v77, v97, v18, -v77
    v_mul_f32 v90, v105, v21
    v_fma_f32 v90, v104, v20, v90
    v_mul_f32 v91, v104, v21
    v_fma_f32 v91, v105, v20, -v91
    v_add_f32 v74, v94, v82
    v_add_f32 v75, v95, v83
    v_sub_f32 v86, v94, v82
    v_sub_f32 v87, v95, v83
    v_add_f32 v66, v92, v78
    v_add_f32 v67, v93, v79
    v_sub_f32 v102, v92, v78
    v_sub_f32 v103, v93, v79
    v_add_f32 v84, v68, v76
    v_add_f32 v85, v69, v77
    v_sub_f32 v70, v68, v76
    v_sub_f32 v71, v69, v77
    v_add_f32 v100, v80, v90
    v_add_f32 v101, v81, v91
    v_sub_f32 v72, v80, v90
    v_sub_f32 v73, v81, v91
    v_sub_f32 v98, v102, v103
    v_add_f32 v99, v102, v103
    v_mul_f32 v98, s16, v98
    v_mul_f32 v99, s16, v99
    v_add_f32 v88, v72, v73
    v_sub_f32 v89, v72, v73
    v_mul_f32 v88, s17, v88
    v_mul_f32 v89, s16, v89
    v_sub_f32 v96, 0, v71
    v_mov_b32 v97, v70
    v_add_f32 v104, v74, v84
    v_add_f32 v105, v75, v85
    v_sub_f32 v94, v74, v84
    v_sub_f32 v95, v75, v85
    v_add_f32 v82, v66, v100
    v_add_f32 v83, v67, v101
    v_sub_f32 v92, v66, v100
    v_sub_f32 v93, v67, v101
    v_add_f32 v78, v104, v82
    v_add_f32 v79, v105, v83
    v_sub_f32 v68, v104, v82
    v_sub_f32 v69, v105, v83
    v_sub_f32 v76, v94, v93
    v_add_f32 v77, v95, v92
    v_add_f32 v80, v94, v93
    v_sub_f32 v81, v95, v92
    v_add_f32 v90, v86, v96
    v_add_f32 v91, v87, v97
    v_sub_f32 v102, v86, v96
    v_sub_f32 v103, v87, v97
    v_add_f32 v72, v98, v88
    v_add_f32 v73, v99, v89
    v_sub_f32 v70, v98, v88
    v_sub_f32 v71, v99, v89
    v_add_f32 v74, v90, v72
    v_add_f32 v75, v91, v73
    v_sub_f32 v66, v90, v72
    v_sub_f32 v67, v91, v73
    v_sub_f32 v84, v102, v71
    v_add_f32 v85, v103, v70
    v_add_f32 v100, v102, v71
    v_sub_f32 v101, v103, v70
    buffer_store_dwordx2 v[78:79], v1, s[8:11], 0 offen offset:0
    buffer_store_dwordx2 v[74:75], v1, s[8:11], 0 offen offset:2048
    buffer_store_dwordx2 v[76:77], v1, s[8:11], s18 offen offset:0
    buffer_store_dwordx2 v[84:85], v1, s[8:11], s18 offen offset:2048
    buffer_store_dwordx2 v[68:69], v1, s[8:11], s19 offen offset:0
    buffer_store_dwordx2 v[66:67], v1, s[8:11], s19 offen offset:2048
    buffer_store_dwordx2 v[80:81], v1, s[8:11], s20 offen offset:0
    buffer_store_dwordx2 v[100:101], v1, s[8:11], s20 offen offset:2048
.Lk2b_kernel_end:
    s_endpgm
.globl k3b_kernel
.p2align 8
.type k3b_kernel,@function
k3b_kernel:
    s_cmp_ge_u32 s2, 256
    s_cbranch_scc1 .Lk3b_kernel_end
    s_load_dwordx2 s[4:5], s[0:1], 72
    s_load_dwordx2 s[6:7], s[0:1], 0
    s_mov_b32 s40, 0x3f3504f3
    s_mov_b32 s41, 0xbf3504f3
    s_mov_b32 s42, 0x3e9e377a
    s_mov_b32 s43, 0xbf4f1bbd
    s_mov_b32 s44, 0x3f737871
    s_mov_b32 s45, 0x3f167918
    s_mov_b32 s46, 0x3f4f1bbd
    s_mov_b32 s47, 0x3f167918
    s_mov_b32 s48, 0x3e9e377a
    s_mov_b32 s49, 0x3f737871
    s_mov_b32 s50, 0xbe9e377a
    s_mov_b32 s51, 0x3f737871
    s_mov_b32 s52, 0xbf4f1bbd
    s_mov_b32 s53, 0x3f167918
    s_waitcnt lgkmcnt(0)
    s_mov_b32 s3, 52428800
    s_add_u32 s8, s4, s3
    s_addc_u32 s9, s5, 0
    s_mov_b32 s10, 2621440
    s_mov_b32 s11, 0x00020000
    s_mov_b32 s12, s4
    s_mov_b32 s13, s5
    s_mov_b32 s14, 5259264
    s_mov_b32 s15, 0x00020000
    s_mov_b32 s3, 12582912
    s_add_u32 s24, s4, s3
    s_addc_u32 s25, s5, 0
    s_mov_b32 s26, 2621440
    s_mov_b32 s27, 0x00020000
    s_mov_b32 s3, 15728640
    s_add_u32 s28, s4, s3
    s_addc_u32 s29, s5, 0
    s_mov_b32 s30, 2621440
    s_mov_b32 s31, 0x00020000
    v_and_b32 v1, 63, v0
    v_lshrrev_b32 v2, 6, v0
    s_nop 1
    v_readfirstlane_b32 s20, v2
    v_and_b32 v4, 3, v0
    v_lshrrev_b32 v5, 2, v0
    v_mul_u32_u24 v6, 5184, v4
    s_lshl_b32 s21, s2, 6
    v_lshlrev_b32 v7, 4, v4
    v_add_u32 v7, s21, v7
    v_lshl_add_u32 v14, v5, 14, v7
    buffer_load_dwordx4 v[16:19], v14, s[12:15], 0 offen
    v_lshl_add_u32 v8, v5, 3, v6
    v_sub_u32 v9, 640, v5
    v_cmp_eq_u32 vcc, 0, v5
    s_nop 1
    v_cndmask_b32 v9, v9, 0, vcc
    v_lshl_add_u32 v9, v9, 3, v6
    s_waitcnt vmcnt(0)
    v_cmp_eq_u32 vcc, 0, v5
    s_nop 1
    v_cndmask_b32 v17, v17, 0, vcc
    v_cndmask_b32 v19, v19, 0, vcc
    v_sub_f32 v10, v16, v19
    v_add_f32 v11, v17, v18
    v_add_f32 v12, v16, v19
    v_sub_f32 v13, v18, v17
    ds_write_b64 v8, v[10:11] offset:23040
    ds_write_b64 v9, v[12:13] offset:23040
    v_add_u32 v5, 80, v5
    v_lshl_add_u32 v14, v5, 14, v7
    buffer_load_dwordx4 v[16:19], v14, s[12:15], 0 offen
    v_lshl_add_u32 v8, v5, 3, v6
    v_sub_u32 v9, 640, v5
    v_cmp_eq_u32 vcc, 0, v5
    s_nop 1
    v_cndmask_b32 v9, v9, 0, vcc
    v_lshl_add_u32 v9, v9, 3, v6
    s_waitcnt vmcnt(0)
    v_sub_f32 v10, v16, v19
    v_add_f32 v11, v17, v18
    v_add_f32 v12, v16, v19
    v_sub_f32 v13, v18, v17
    ds_write_b64 v8, v[10:11] offset:23040
    ds_write_b64 v9, v[12:13] offset:23040
    v_add_u32 v5, 80, v5
    v_lshl_add_u32 v14, v5, 14, v7
    buffer_load_dwordx4 v[16:19], v14, s[12:15], 0 offen
    v_lshl_add_u32 v8, v5, 3, v6
    v_sub_u32 v9, 640, v5
    v_cmp_eq_u32 vcc, 0, v5
    s_nop 1
    v_cndmask_b32 v9, v9, 0, vcc
    v_lshl_add_u32 v9, v9, 3, v6
    s_waitcnt vmcnt(0)
    v_sub_f32 v10, v16, v19
    v_add_f32 v11, v17, v18
    v_add_f32 v12, v16, v19
    v_sub_f32 v13, v18, v17
    ds_write_b64 v8, v[10:11] offset:23040
    ds_write_b64 v9, v[12:13] offset:23040
    v_add_u32 v5, 80, v5
    v_lshl_add_u32 v14, v5, 14, v7
    buffer_load_dwordx4 v[16:19], v14, s[12:15], 0 offen
    v_lshl_add_u32 v8, v5, 3, v6
    v_sub_u32 v9, 640, v5
    v_cmp_eq_u32 vcc, 0, v5
    s_nop 1
    v_cndmask_b32 v9, v9, 0, vcc
    v_lshl_add_u32 v9, v9, 3, v6
    s_waitcnt vmcnt(0)
    v_sub_f32 v10, v16, v19
    v_add_f32 v11, v17, v18
    v_add_f32 v12, v16, v19
    v_sub_f32 v13, v18, v17
    ds_write_b64 v8, v[10:11] offset:23040
    ds_write_b64 v9, v[12:13] offset:23040
    v_add_u32 v5, 80, v5
    v_cmp_ge_u32 vcc, 320, v5
    s_and_saveexec_b64 s[22:23], vcc
    v_lshl_add_u32 v14, v5, 14, v7
    buffer_load_dwordx4 v[16:19], v14, s[12:15], 0 offen
    v_lshl_add_u32 v8, v5, 3, v6
    v_sub_u32 v9, 640, v5
    v_cmp_eq_u32 vcc, 0, v5
    s_nop 1
    v_cndmask_b32 v9, v9, 0, vcc
    v_lshl_add_u32 v9, v9, 3, v6
    s_waitcnt vmcnt(0)
    v_cmp_eq_u32 vcc, 320, v5
    s_nop 1
    v_cndmask_b32 v17, v17, 0, vcc
    v_cndmask_b32 v19, v19, 0, vcc
    v_sub_f32 v10, v16, v19
    v_add_f32 v11, v17, v18
    v_add_f32 v12, v16, v19
    v_sub_f32 v13, v18, v17
    ds_write_b64 v8, v[10:11] offset:23040
    ds_write_b64 v9, v[12:13] offset:23040
    s_mov_b64 exec, s[22:23]
    s_waitcnt lgkmcnt(0)
    s_barrier
    v_lshrrev_b32 v4, 3, v0
    v_and_b32 v5, 7, v0
    v_cvt_f32_u32 v40, v5
    v_mul_f32 v20, 0xbc800000, v40
    v_fract_f32 v20, v20
    v_sin_f32 v21, v20
    v_cos_f32 v20, v20
    v_mul_f32 v22, 0xbd000000, v40
    v_fract_f32 v22, v22
    v_sin_f32 v23, v22
    v_cos_f32 v22, v22
    v_mul_f32 v24, 0xbd400000, v40
    v_fract_f32 v24, v24
    v_sin_f32 v25, v24
    v_cos_f32 v24, v24
    v_mul_f32 v26, 0xbd800000, v40
    v_fract_f32 v26, v26
    v_sin_f32 v27, v26
    v_cos_f32 v26, v26
    v_mul_f32 v28, 0xbda00000, v40
    v_fract_f32 v28, v28
    v_sin_f32 v29, v28
    v_cos_f32 v28, v28
    v_mul_f32 v30, 0xbdc00000, v40
    v_fract_f32 v30, v30
    v_sin_f32 v31, v30
    v_cos_f32 v30, v30
    v_mul_f32 v32, 0xbde00000, v40
    v_fract_f32 v32, v32
    v_sin_f32 v33, v32
    v_cos_f32 v32, v32
    s_nop 0
    v_mul_u32_u24 v6, 205, v4
    v_lshrrev_b32 v6, 11, v6
    v_mul_u32_u24 v7, 10, v6
    v_sub_u32 v7, v4, v7
    v_mul_u32_u24 v3, 10, v5
    v_add_u32 v8, v7, v3
    v_mul_u32_u24 v3, 648, v6
    v_add_u32 v3, v3, v8
    v_lshlrev_b32 v3, 3, v3
    ds_read_b64 v[64:65], v3 offset:23040
    ds_read_b64 v[66:67], v3 offset:23680
    ds_read_b64 v[68:69], v3 offset:24320
    ds_read_b64 v[70:71], v3 offset:24960
    ds_read_b64 v[72:73], v3 offset:25600
    ds_read_b64 v[74:75], v3 offset:26240
    ds_read_b64 v[76:77], v3 offset:26880
    ds_read_b64 v[78:79], v3 offset:27520
    s_waitcnt lgkmcnt(0)
    v_add_f32 v80, v64, v72
    v_add_f32 v81, v65, v73
    v_sub_f32 v82, v64, v72
    v_sub_f32 v83, v65, v73
    v_add_f32 v84, v66, v74
    v_add_f32 v85, v67, v75
    v_sub_f32 v86, v66, v74
    v_sub_f32 v87, v67, v75
    v_add_f32 v88, v68, v76
    v_add_f32 v89, v69, v77
    v_sub_f32 v90, v68, v76
    v_sub_f32 v91, v69, v77
    v_add_f32 v92, v70, v78
    v_add_f32 v93, v71, v79
    v_sub_f32 v94, v70, v78
    v_sub_f32 v95, v71, v79
    v_sub_f32 v96, v86, v87
    v_add_f32 v97, v86, v87
    v_mul_f32 v96, s40, v96
    v_mul_f32 v97, s40, v97
    v_add_f32 v98, v94, v95
    v_sub_f32 v99, v94, v95
    v_mul_f32 v98, s41, v98
    v_mul_f32 v99, s40, v99
    v_sub_f32 v100, 0, v91
    v_mov_b32 v101, v90
    v_add_f32 v102, v80, v88
    v_add_f32 v103, v81, v89
    v_sub_f32 v104, v80, v88
    v_sub_f32 v105, v81, v89
    v_add_f32 v106, v84, v92
    v_add_f32 v107, v85, v93
    v_sub_f32 v108, v84, v92
    v_sub_f32 v109, v85, v93
    v_add_f32 v110, v102, v106
    v_add_f32 v111, v103, v107
    v_sub_f32 v64, v102, v106
    v_sub_f32 v65, v103, v107
    v_sub_f32 v72, v104, v109
    v_add_f32 v73, v105, v108
    v_add_f32 v66, v104, v109
    v_sub_f32 v67, v105, v108
    v_add_f32 v74, v82, v100
    v_add_f32 v75, v83, v101
    v_sub_f32 v68, v82, v100
    v_sub_f32 v69, v83, v101
    v_add_f32 v76, v96, v98
    v_add_f32 v77, v97, v99
    v_sub_f32 v70, v96, v98
    v_sub_f32 v71, v97, v99
    v_add_f32 v78, v74, v76
    v_add_f32 v79, v75, v77
    v_sub_f32 v86, v74, v76
    v_sub_f32 v87, v75, v77
    v_sub_f32 v94, v68, v71
    v_add_f32 v95, v69, v70
    v_add_f32 v90, v68, v71
    v_sub_f32 v91, v69, v70
    v_mul_f32 v80, v79, v21
    v_fma_f32 v80, v78, v20, v80
    v_mul_f32 v81, v78, v21
    v_fma_f32 v81, v79, v20, -v81
    v_mul_f32 v84, v73, v23
    v_fma_f32 v84, v72, v22, v84
    v_mul_f32 v85, v72, v23
    v_fma_f32 v85, v73, v22, -v85
    v_mul_f32 v88, v95, v25
    v_fma_f32 v88, v94, v24, v88
    v_mul_f32 v89, v94, v25
    v_fma_f32 v89, v95, v24, -v89
    v_mul_f32 v92, v65, v27
    v_fma_f32 v92, v64, v26, v92
    v_mul_f32 v93, v64, v27
    v_fma_f32 v93, v65, v26, -v93
    v_mul_f32 v102, v87, v29
    v_fma_f32 v102, v86, v28, v102
    v_mul_f32 v103, v86, v29
    v_fma_f32 v103, v87, v28, -v103
    v_mul_f32 v106, v67, v31
    v_fma_f32 v106, v66, v30, v106
    v_mul_f32 v107, v66, v31
    v_fma_f32 v107, v67, v30, -v107
    v_mul_f32 v104, v91, v33
    v_fma_f32 v104, v90, v32, v104
    v_mul_f32 v105, v90, v33
    v_fma_f32 v105, v91, v32, -v105
    v_mul_u32_u24 v3, 72, v0
    ds_write_b64 v3, v[110:111] offset:0
    ds_write_b64 v3, v[80:81] offset:8
    ds_write_b64 v3, v[84:85] offset:16
    ds_write_b64 v3, v[88:89] offset:24
    ds_write_b64 v3, v[92:93] offset:32
    ds_write_b64 v3, v[102:103] offset:40
    ds_write_b64 v3, v[106:107] offset:48
    ds_write_b64 v3, v[104:105] offset:56
    s_waitcnt lgkmcnt(0)
    s_barrier
    v_cvt_f32_u32 v40, v7
    v_cvt_f32_u32 v41, v5
    v_add_f32 v20, 0x00000000, v41
    v_mul_f32 v20, v20, v40
    v_mul_f32 v20, 0xbacccccd, v20
    v_fract_f32 v20, v20
    v_sin_f32 v21, v20
    v_cos_f32 v20, v20
    v_add_f32 v22, 0x41000000, v41
    v_mul_f32 v22, v22, v40
    v_mul_f32 v22, 0xbacccccd, v22
    v_fract_f32 v22, v22
    v_sin_f32 v23, v22
    v_cos_f32 v22, v22
    v_add_f32 v24, 0x41800000, v41
    v_mul_f32 v24, v24, v40
    v_mul_f32 v24, 0xbacccccd, v24
    v_fract_f32 v24, v24
    v_sin_f32 v25, v24
    v_cos_f32 v24, v24
    v_add_f32 v26, 0x41c00000, v41
    v_mul_f32 v26, v26, v40
    v_mul_f32 v26, 0xbacccccd, v26
    v_fract_f32 v26, v26
    v_sin_f32 v27, v26
    v_cos_f32 v26, v26
    v_add_f32 v28, 0x42000000, v41
    v_mul_f32 v28, v28, v40
    v_mul_f32 v28, 0xbacccccd, v28
    v_fract_f32 v28, v28
    v_sin_f32 v29, v28
    v_cos_f32 v28, v28
    v_add_f32 v30, 0x42200000, v41
    v_mul_f32 v30, v30, v40
    v_mul_f32 v30, 0xbacccccd, v30
    v_fract_f32 v30, v30
    v_sin_f32 v31, v30
    v_cos_f32 v30, v30
    v_add_f32 v32, 0x42400000, v41
    v_mul_f32 v32, v32, v40
    v_mul_f32 v32, 0xbacccccd, v32
    v_fract_f32 v32, v32
    v_sin_f32 v33, v32
    v_cos_f32 v32, v32
    v_add_f32 v34, 0x42600000, v41
    v_mul_f32 v34, v34, v40
    v_mul_f32 v34, 0xbacccccd, v34
    v_fract_f32 v34, v34
    v_sin_f32 v35, v34
    v_cos_f32 v34, v34
    s_nop 0
    v_mul_u32_u24 v3, 576, v4
    v_lshl_add_u32 v3, v5, 3, v3
    ds_read_b64 v[108:109], v3 offset:0
    ds_read_b64 v[82:83], v3 offset:72
    ds_read_b64 v[96:97], v3 offset:144
    ds_read_b64 v[100:101], v3 offset:216
    ds_read_b64 v[98:99], v3 offset:288
    ds_read_b64 v[74:75], v3 offset:360
    ds_read_b64 v[76:77], v3 offset:432
    ds_read_b64 v[68:69], v3 offset:504
    s_waitcnt lgkmcnt(0)
    v_add_f32 v70, v108, v98
    v_add_f32 v71, v109, v99
    v_sub_f32 v78, v108, v98
    v_sub_f32 v79, v109, v99
    v_add_f32 v72, v82, v74
    v_add_f32 v73, v83, v75
    v_sub_f32 v94, v82, v74
    v_sub_f32 v95, v83, v75
    v_add_f32 v64, v96, v76
    v_add_f32 v65, v97, v77
    v_sub_f32 v86, v96, v76
    v_sub_f32 v87, v97, v77
    v_add_f32 v66, v100, v68
    v_add_f32 v67, v101, v69
    v_sub_f32 v90, v100, v68
    v_sub_f32 v91, v101, v69
    v_sub_f32 v110, v94, v95
    v_add_f32 v111, v94, v95
    v_mul_f32 v110, s40, v110
    v_mul_f32 v111, s40, v111
    v_add_f32 v80, v90, v91
    v_sub_f32 v81, v90, v91
    v_mul_f32 v80, s41, v80
    v_mul_f32 v81, s40, v81
    v_sub_f32 v84, 0, v87
    v_mov_b32 v85, v86
    v_add_f32 v88, v70, v64
    v_add_f32 v89, v71, v65
    v_sub_f32 v92, v70, v64
    v_sub_f32 v93, v71, v65
    v_add_f32 v102, v72, v66
    v_add_f32 v103, v73, v67
    v_sub_f32 v106, v72, v66
    v_sub_f32 v107, v73, v67
    v_add_f32 v104, v88, v102
    v_add_f32 v105, v89, v103
    v_sub_f32 v108, v88, v102
    v_sub_f32 v109, v89, v103
    v_sub_f32 v98, v92, v107
    v_add_f32 v99, v93, v106
    v_add_f32 v82, v92, v107
    v_sub_f32 v83, v93, v106
    v_add_f32 v74, v78, v84
    v_add_f32 v75, v79, v85
    v_sub_f32 v96, v78, v84
    v_sub_f32 v97, v79, v85
    v_add_f32 v76, v110, v80
    v_add_f32 v77, v111, v81
    v_sub_f32 v100, v110, v80
    v_sub_f32 v101, v111, v81
    v_add_f32 v68, v74, v76
    v_add_f32 v69, v75, v77
    v_sub_f32 v94, v74, v76
    v_sub_f32 v95, v75, v77
    v_sub_f32 v90, v96, v101
    v_add_f32 v91, v97, v100
    v_add_f32 v86, v96, v101
    v_sub_f32 v87, v97, v100
    v_mul_f32 v70, v105, v21
    v_fma_f32 v70, v104, v20, v70
    v_mul_f32 v71, v104, v21
    v_fma_f32 v71, v105, v20, -v71
    v_mul_f32 v72, v69, v23
    v_fma_f32 v72, v68, v22, v72
    v_mul_f32 v73, v68, v23
    v_fma_f32 v73, v69, v22, -v73
    v_mul_f32 v64, v99, v25
    v_fma_f32 v64, v98, v24, v64
    v_mul_f32 v65, v98, v25
    v_fma_f32 v65, v99, v24, -v65
    v_mul_f32 v66, v91, v27
    v_fma_f32 v66, v90, v26, v66
    v_mul_f32 v67, v90, v27
    v_fma_f32 v67, v91, v26, -v67
    v_mul_f32 v88, v109, v29
    v_fma_f32 v88, v108, v28, v88
    v_mul_f32 v89, v108, v29
    v_fma_f32 v89, v109, v28, -v89
    v_mul_f32 v102, v95, v31
    v_fma_f32 v102, v94, v30, v102
    v_mul_f32 v103, v94, v31
    v_fma_f32 v103, v95, v30, -v103
    v_mul_f32 v92, v83, v33
    v_fma_f32 v92, v82, v32, v92
    v_mul_f32 v93, v82, v33
    v_fma_f32 v93, v83, v32, -v93
    v_mul_f32 v106, v87, v35
    v_fma_f32 v106, v86, v34, v106
    v_mul_f32 v107, v86, v35
    v_fma_f32 v107, v87, v34, -v107
    ds_write_b64 v3, v[70:71] offset:23040
    ds_write_b64 v3, v[72:73] offset:23104
    ds_write_b64 v3, v[64:65] offset:23168
    ds_write_b64 v3, v[66:67] offset:23232
    ds_write_b64 v3, v[88:89] offset:23296
    ds_write_b64 v3, v[102:103] offset:23360
    ds_write_b64 v3, v[92:93] offset:23424
    ds_write_b64 v3, v[106:107] offset:23488
    s_waitcnt lgkmcnt(0)
    s_barrier
    s_cmp_ge_u32 s20, 4
    s_cbranch_scc1 .Lk3b_kernel_end
    s_mul_i32 s21, s20, 5760
    v_lshlrev_b32 v3, 3, v1
    v_add_u32 v3, s21, v3
    ds_read_b64 v[78:79], v3 offset:23040
    ds_read_b64 v[110:111], v3 offset:23616
    ds_read_b64 v[84:85], v3 offset:24192
    ds_read_b64 v[80:81], v3 offset:24768
    ds_read_b64 v[74:75], v3 offset:25344
    ds_read_b64 v[76:77], v3 offset:25920
    ds_read_b64 v[96:97], v3 offset:26496
    ds_read_b64 v[100:101], v3 offset:27072
    ds_read_b64 v[104:105], v3 offset:27648
    ds_read_b64 v[68:69], v3 offset:28224
    s_lshl_b32 s21, s2, 3
    s_lshl_b32 s22, s20, 1
    s_add_u32 s21, s21, s22
    s_mul_i32 s21, s21, 1280
    v_lshlrev_b32 v2, 2, v1
    buffer_load_dword v4, v2, s[8:11], s21 offen offset:0
    buffer_load_dword v5, v2, s[8:11], s21 offen offset:256
    buffer_load_dword v6, v2, s[8:11], s21 offen offset:512
    buffer_load_dword v7, v2, s[8:11], s21 offen offset:768
    buffer_load_dword v8, v2, s[8:11], s21 offen offset:1024
    buffer_load_dword v9, v2, s[8:11], s21 offen offset:1280
    buffer_load_dword v10, v2, s[8:11], s21 offen offset:1536
    buffer_load_dword v11, v2, s[8:11], s21 offen offset:1792
    buffer_load_dword v12, v2, s[8:11], s21 offen offset:2048
    buffer_load_dword v13, v2, s[8:11], s21 offen offset:2304
    s_waitcnt lgkmcnt(0)
    v_add_f32 v98, v78, v76
    v_add_f32 v99, v79, v77
    v_sub_f32 v90, v78, v76
    v_sub_f32 v91, v79, v77
    v_add_f32 v108, v110, v96
    v_add_f32 v109, v111, v97
    v_sub_f32 v94, v110, v96
    v_sub_f32 v95, v111, v97
    v_add_f32 v82, v84, v100
    v_add_f32 v83, v85, v101
    v_sub_f32 v86, v84, v100
    v_sub_f32 v87, v85, v101
    v_add_f32 v70, v80, v104
    v_add_f32 v71, v81, v105
    v_sub_f32 v72, v80, v104
    v_sub_f32 v73, v81, v105
    v_add_f32 v64, v74, v68
    v_add_f32 v65, v75, v69
    v_sub_f32 v66, v74, v68
    v_sub_f32 v67, v75, v69
    v_mul_f32 v88, s47, v95
    v_fma_f32 v88, s46, v94, -v88
    v_mul_f32 v89, s47, v94
    v_fma_f32 v89, s46, v95, v89
    v_mul_f32 v102, s49, v87
    v_fma_f32 v102, s48, v86, -v102
    v_mul_f32 v103, s49, v86
    v_fma_f32 v103, s48, v87, v103
    v_mul_f32 v92, s51, v73
    v_fma_f32 v92, s50, v72, -v92
    v_mul_f32 v93, s51, v72
    v_fma_f32 v93, s50, v73, v93
    v_mul_f32 v106, s53, v67
    v_fma_f32 v106, s52, v66, -v106
    v_mul_f32 v107, s53, v66
    v_fma_f32 v107, s52, v67, v107
    v_add_f32 v78, v108, v64
    v_add_f32 v79, v109, v65
    v_add_f32 v76, v82, v70
    v_add_f32 v77, v83, v71
    v_sub_f32 v110, v108, v64
    v_sub_f32 v111, v109, v65
    v_sub_f32 v96, v82, v70
    v_sub_f32 v97, v83, v71
    v_add_f32 v84, v98, v78
    v_add_f32 v84, v84, v76
    v_fma_f32 v100, s42, v78, v98
    v_fma_f32 v100, s43, v76, v100
    v_fma_f32 v80, s43, v78, v98
    v_fma_f32 v80, s42, v76, v80
    v_add_f32 v85, v99, v79
    v_add_f32 v85, v85, v77
    v_fma_f32 v101, s42, v79, v99
    v_fma_f32 v101, s43, v77, v101
    v_fma_f32 v81, s43, v79, v99
    v_fma_f32 v81, s42, v77, v81
    v_mul_f32 v104, s44, v110
    v_fma_f32 v104, s45, v96, v104
    v_mul_f32 v74, s45, v110
    v_fma_f32 v74, -s44, v96, v74
    v_mul_f32 v105, s44, v111
    v_fma_f32 v105, s45, v97, v105
    v_mul_f32 v75, s45, v111
    v_fma_f32 v75, -s44, v97, v75
    v_add_f32 v68, v100, v105
    v_sub_f32 v69, v101, v104
    v_sub_f32 v94, v100, v105
    v_add_f32 v95, v101, v104
    v_add_f32 v86, v80, v75
    v_sub_f32 v87, v81, v74
    v_sub_f32 v72, v80, v75
    v_add_f32 v73, v81, v74
    v_add_f32 v66, v88, v106
    v_add_f32 v67, v89, v107
    v_add_f32 v108, v102, v92
    v_add_f32 v109, v103, v93
    v_sub_f32 v82, v88, v106
    v_sub_f32 v83, v89, v107
    v_sub_f32 v70, v102, v92
    v_sub_f32 v71, v103, v93
    v_add_f32 v64, v90, v66
    v_add_f32 v64, v64, v108
    v_fma_f32 v98, s42, v66, v90
    v_fma_f32 v98, s43, v108, v98
    v_fma_f32 v78, s43, v66, v90
    v_fma_f32 v78, s42, v108, v78
    v_add_f32 v65, v91, v67
    v_add_f32 v65, v65, v109
    v_fma_f32 v99, s42, v67, v91
    v_fma_f32 v99, s43, v109, v99
    v_fma_f32 v79, s43, v67, v91
    v_fma_f32 v79, s42, v109, v79
    v_mul_f32 v76, s44, v82
    v_fma_f32 v76, s45, v70, v76
    v_mul_f32 v110, s45, v82
    v_fma_f32 v110, -s44, v70, v110
    v_mul_f32 v77, s44, v83
    v_fma_f32 v77, s45, v71, v77
    v_mul_f32 v111, s45, v83
    v_fma_f32 v111, -s44, v71, v111
    v_add_f32 v96, v98, v77
    v_sub_f32 v97, v99, v76
    v_sub_f32 v100, v98, v77
    v_add_f32 v101, v99, v76
    v_add_f32 v104, v78, v111
    v_sub_f32 v105, v79, v110
    v_sub_f32 v80, v78, v111
    v_add_f32 v81, v79, v110
    s_mul_i32 s22, s20, 5120
    v_lshlrev_b32 v3, 3, v1
    v_add_u32 v3, s22, v3
    ds_write_b64 v3, v[84:85] offset:0
    ds_write_b64 v3, v[64:65] offset:512
    ds_write_b64 v3, v[94:95] offset:1024
    ds_write_b64 v3, v[100:101] offset:1536
    ds_write_b64 v3, v[72:73] offset:2048
    ds_write_b64 v3, v[80:81] offset:2560
    ds_write_b64 v3, v[86:87] offset:3072
    ds_write_b64 v3, v[104:105] offset:3584
    ds_write_b64 v3, v[68:69] offset:4096
    ds_write_b64 v3, v[96:97] offset:4608
    v_lshlrev_b32 v3, 4, v1
    v_add_u32 v3, s22, v3
    s_waitcnt lgkmcnt(0)
    ds_read_b128 v[44:47], v3 offset:0
    ds_read_b128 v[48:51], v3 offset:1024
    ds_read_b128 v[52:55], v3 offset:2048
    ds_read_b128 v[56:59], v3 offset:3072
    ds_read_b128 v[60:63], v3 offset:4096
    s_waitcnt vmcnt(0) lgkmcnt(0)
    v_cvt_pk_bf16_f32 v44, v44, v44
    v_lshlrev_b32 v44, 16, v44
    v_lshlrev_b32 v20, 16, v4
    v_add_f32 v20, v20, v44
    v_cvt_pk_bf16_f32 v46, v46, v46
    v_lshlrev_b32 v46, 16, v46
    v_and_b32 v21, 0xffff0000, v4
    v_add_f32 v21, v21, v46
    v_cvt_pk_bf16_f32 v4, v20, v21
    buffer_store_dword v4, v2, s[24:27], s21 offen offset:0
    v_lshlrev_b32 v20, 16, v4
    v_and_b32 v21, 0xffff0000, v4
    v_cvt_pk_bf16_f32 v48, v48, v48
    v_lshlrev_b32 v48, 16, v48
    v_lshlrev_b32 v22, 16, v5
    v_add_f32 v22, v22, v48
    v_cvt_pk_bf16_f32 v50, v50, v50
    v_lshlrev_b32 v50, 16, v50
    v_and_b32 v23, 0xffff0000, v5
    v_add_f32 v23, v23, v50
    v_cvt_pk_bf16_f32 v5, v22, v23
    buffer_store_dword v5, v2, s[24:27], s21 offen offset:256
    v_lshlrev_b32 v22, 16, v5
    v_and_b32 v23, 0xffff0000, v5
    v_cvt_pk_bf16_f32 v52, v52, v52
    v_lshlrev_b32 v52, 16, v52
    v_lshlrev_b32 v24, 16, v6
    v_add_f32 v24, v24, v52
    v_cvt_pk_bf16_f32 v54, v54, v54
    v_lshlrev_b32 v54, 16, v54
    v_and_b32 v25, 0xffff0000, v6
    v_add_f32 v25, v25, v54
    v_cvt_pk_bf16_f32 v6, v24, v25
    buffer_store_dword v6, v2, s[24:27], s21 offen offset:512
    v_lshlrev_b32 v24, 16, v6
    v_and_b32 v25, 0xffff0000, v6
    v_cvt_pk_bf16_f32 v56, v56, v56
    v_lshlrev_b32 v56, 16, v56
    v_lshlrev_b32 v26, 16, v7
    v_add_f32 v26, v26, v56
    v_cvt_pk_bf16_f32 v58, v58, v58
    v_lshlrev_b32 v58, 16, v58
    v_and_b32 v27, 0xffff0000, v7
    v_add_f32 v27, v27, v58
    v_cvt_pk_bf16_f32 v7, v26, v27
    buffer_store_dword v7, v2, s[24:27], s21 offen offset:768
    v_lshlrev_b32 v26, 16, v7
    v_and_b32 v27, 0xffff0000, v7
    v_cvt_pk_bf16_f32 v60, v60, v60
    v_lshlrev_b32 v60, 16, v60
    v_lshlrev_b32 v28, 16, v8
    v_add_f32 v28, v28, v60
    v_cvt_pk_bf16_f32 v62, v62, v62
    v_lshlrev_b32 v62, 16, v62
    v_and_b32 v29, 0xffff0000, v8
    v_add_f32 v29, v29, v62
    v_cvt_pk_bf16_f32 v8, v28, v29
    buffer_store_dword v8, v2, s[24:27], s21 offen offset:1024
    v_lshlrev_b32 v28, 16, v8
    v_and_b32 v29, 0xffff0000, v8
    v_cvt_pk_bf16_f32 v45, v45, v45
    v_lshlrev_b32 v45, 16, v45
    v_lshlrev_b32 v30, 16, v9
    v_add_f32 v30, v30, v45
    v_cvt_pk_bf16_f32 v47, v47, v47
    v_lshlrev_b32 v47, 16, v47
    v_and_b32 v31, 0xffff0000, v9
    v_add_f32 v31, v31, v47
    v_cvt_pk_bf16_f32 v9, v30, v31
    buffer_store_dword v9, v2, s[24:27], s21 offen offset:1280
    v_lshlrev_b32 v30, 16, v9
    v_and_b32 v31, 0xffff0000, v9
    v_cvt_pk_bf16_f32 v49, v49, v49
    v_lshlrev_b32 v49, 16, v49
    v_lshlrev_b32 v32, 16, v10
    v_add_f32 v32, v32, v49
    v_cvt_pk_bf16_f32 v51, v51, v51
    v_lshlrev_b32 v51, 16, v51
    v_and_b32 v33, 0xffff0000, v10
    v_add_f32 v33, v33, v51
    v_cvt_pk_bf16_f32 v10, v32, v33
    buffer_store_dword v10, v2, s[24:27], s21 offen offset:1536
    v_lshlrev_b32 v32, 16, v10
    v_and_b32 v33, 0xffff0000, v10
    v_cvt_pk_bf16_f32 v53, v53, v53
    v_lshlrev_b32 v53, 16, v53
    v_lshlrev_b32 v34, 16, v11
    v_add_f32 v34, v34, v53
    v_cvt_pk_bf16_f32 v55, v55, v55
    v_lshlrev_b32 v55, 16, v55
    v_and_b32 v35, 0xffff0000, v11
    v_add_f32 v35, v35, v55
    v_cvt_pk_bf16_f32 v11, v34, v35
    buffer_store_dword v11, v2, s[24:27], s21 offen offset:1792
    v_lshlrev_b32 v34, 16, v11
    v_and_b32 v35, 0xffff0000, v11
    v_cvt_pk_bf16_f32 v57, v57, v57
    v_lshlrev_b32 v57, 16, v57
    v_lshlrev_b32 v36, 16, v12
    v_add_f32 v36, v36, v57
    v_cvt_pk_bf16_f32 v59, v59, v59
    v_lshlrev_b32 v59, 16, v59
    v_and_b32 v37, 0xffff0000, v12
    v_add_f32 v37, v37, v59
    v_cvt_pk_bf16_f32 v12, v36, v37
    buffer_store_dword v12, v2, s[24:27], s21 offen offset:2048
    v_lshlrev_b32 v36, 16, v12
    v_and_b32 v37, 0xffff0000, v12
    v_cvt_pk_bf16_f32 v61, v61, v61
    v_lshlrev_b32 v61, 16, v61
    v_lshlrev_b32 v38, 16, v13
    v_add_f32 v38, v38, v61
    v_cvt_pk_bf16_f32 v63, v63, v63
    v_lshlrev_b32 v63, 16, v63
    v_and_b32 v39, 0xffff0000, v13
    v_add_f32 v39, v39, v63
    v_cvt_pk_bf16_f32 v13, v38, v39
    buffer_store_dword v13, v2, s[24:27], s21 offen offset:2304
    v_lshlrev_b32 v38, 16, v13
    v_and_b32 v39, 0xffff0000, v13
    v_add_f32 v40, v20, v21
    v_add_f32 v40, v40, v22
    v_add_f32 v40, v40, v23
    v_add_f32 v40, v40, v24
    v_add_f32 v40, v40, v25
    v_add_f32 v40, v40, v26
    v_add_f32 v40, v40, v27
    v_add_f32 v40, v40, v28
    v_add_f32 v40, v40, v29
    v_add_f32 v41, v30, v31
    v_add_f32 v41, v41, v32
    v_add_f32 v41, v41, v33
    v_add_f32 v41, v41, v34
    v_add_f32 v41, v41, v35
    v_add_f32 v41, v41, v36
    v_add_f32 v41, v41, v37
    v_add_f32 v41, v41, v38
    v_add_f32 v41, v41, v39
    s_nop 1
    v_add_f32_dpp v40, v40, v40 quad_perm:[1,0,3,2] row_mask:0xf bank_mask:0xf
    v_add_f32_dpp v41, v41, v41 quad_perm:[1,0,3,2] row_mask:0xf bank_mask:0xf
    s_nop 1
    v_add_f32_dpp v40, v40, v40 quad_perm:[2,3,0,1] row_mask:0xf bank_mask:0xf
    v_add_f32_dpp v41, v41, v41 quad_perm:[2,3,0,1] row_mask:0xf bank_mask:0xf
    s_nop 1
    v_add_f32_dpp v40, v40, v40 row_half_mirror row_mask:0xf bank_mask:0xf
    v_add_f32_dpp v41, v41, v41 row_half_mirror row_mask:0xf bank_mask:0xf
    s_nop 1
    v_add_f32_dpp v40, v40, v40 row_mirror row_mask:0xf bank_mask:0xf
    v_add_f32_dpp v41, v41, v41 row_mirror row_mask:0xf bank_mask:0xf
    v_mov_b32 v44, v40
    v_mov_b32 v45, v41
    s_nop 1
    v_permlane16_swap_b32 v40, v44
    v_permlane16_swap_b32 v41, v45
    s_nop 1
    v_add_f32 v40, v40, v44
    v_add_f32 v41, v41, v45
    v_mov_b32 v44, v40
    v_mov_b32 v45, v41
    s_nop 1
    v_permlane32_swap_b32 v40, v44
    v_permlane32_swap_b32 v41, v45
    s_nop 1
    v_add_f32 v40, v40, v44
    v_add_f32 v41, v41, v45
    v_mul_f32 v40, 0x3acccccd, v40
    v_mul_f32 v41, 0x3acccccd, v41
    v_sub_f32 v44, v20, v40
    v_mul_f32 v42, v44, v44
    v_sub_f32 v44, v21, v40
    v_fma_f32 v42, v44, v44, v42
    v_sub_f32 v44, v22, v40
    v_fma_f32 v42, v44, v44, v42
    v_sub_f32 v44, v23, v40
    v_fma_f32 v42, v44, v44, v42
    v_sub_f32 v44, v24, v40
    v_fma_f32 v42, v44, v44, v42
    v_sub_f32 v44, v25, v40
    v_fma_f32 v42, v44, v44, v42
    v_sub_f32 v44, v26, v40
    v_fma_f32 v42, v44, v44, v42
    v_sub_f32 v44, v27, v40
    v_fma_f32 v42, v44, v44, v42
    v_sub_f32 v44, v28, v40
    v_fma_f32 v42, v44, v44, v42
    v_sub_f32 v44, v29, v40
    v_fma_f32 v42, v44, v44, v42
    v_sub_f32 v44, v30, v41
    v_mul_f32 v43, v44, v44
    v_sub_f32 v44, v31, v41
    v_fma_f32 v43, v44, v44, v43
    v_sub_f32 v44, v32, v41
    v_fma_f32 v43, v44, v44, v43
    v_sub_f32 v44, v33, v41
    v_fma_f32 v43, v44, v44, v43
    v_sub_f32 v44, v34, v41
    v_fma_f32 v43, v44, v44, v43
    v_sub_f32 v44, v35, v41
    v_fma_f32 v43, v44, v44, v43
    v_sub_f32 v44, v36, v41
    v_fma_f32 v43, v44, v44, v43
    v_sub_f32 v44, v37, v41
    v_fma_f32 v43, v44, v44, v43
    v_sub_f32 v44, v38, v41
    v_fma_f32 v43, v44, v44, v43
    v_sub_f32 v44, v39, v41
    v_fma_f32 v43, v44, v44, v43
    s_nop 1
    v_add_f32_dpp v42, v42, v42 quad_perm:[1,0,3,2] row_mask:0xf bank_mask:0xf
    v_add_f32_dpp v43, v43, v43 quad_perm:[1,0,3,2] row_mask:0xf bank_mask:0xf
    s_nop 1
    v_add_f32_dpp v42, v42, v42 quad_perm:[2,3,0,1] row_mask:0xf bank_mask:0xf
    v_add_f32_dpp v43, v43, v43 quad_perm:[2,3,0,1] row_mask:0xf bank_mask:0xf
    s_nop 1
    v_add_f32_dpp v42, v42, v42 row_half_mirror row_mask:0xf bank_mask:0xf
    v_add_f32_dpp v43, v43, v43 row_half_mirror row_mask:0xf bank_mask:0xf
    s_nop 1
    v_add_f32_dpp v42, v42, v42 row_mirror row_mask:0xf bank_mask:0xf
    v_add_f32_dpp v43, v43, v43 row_mirror row_mask:0xf bank_mask:0xf
    v_mov_b32 v44, v42
    v_mov_b32 v45, v43
    s_nop 1
    v_permlane16_swap_b32 v42, v44
    v_permlane16_swap_b32 v43, v45
    s_nop 1
    v_add_f32 v42, v42, v44
    v_add_f32 v43, v43, v45
    v_mov_b32 v44, v42
    v_mov_b32 v45, v43
    s_nop 1
    v_permlane32_swap_b32 v42, v44
    v_permlane32_swap_b32 v43, v45
    s_nop 1
    v_add_f32 v42, v42, v44
    v_add_f32 v43, v43, v45
    v_mul_f32 v42, 0x3acccccd, v42
    v_cvt_pk_bf16_f32 v42, v42, v42
    v_lshlrev_b32 v42, 16, v42
    v_add_f32 v42, 0x3727c5ac, v42
    v_cvt_pk_bf16_f32 v42, v42, v42
    v_lshlrev_b32 v42, 16, v42
    v_sqrt_f32 v42, v42
    s_nop 0
    v_cvt_pk_bf16_f32 v42, v42, v42
    v_lshlrev_b32 v42, 16, v42
    v_rcp_f32 v44, v42
    v_cvt_pk_bf16_f32 v40, v40, v40
    v_lshlrev_b32 v40, 16, v40
    v_mul_f32 v43, 0x3acccccd, v43
    v_cvt_pk_bf16_f32 v43, v43, v43
    v_lshlrev_b32 v43, 16, v43
    v_add_f32 v43, 0x3727c5ac, v43
    v_cvt_pk_bf16_f32 v43, v43, v43
    v_lshlrev_b32 v43, 16, v43
    v_sqrt_f32 v43, v43
    s_nop 0
    v_cvt_pk_bf16_f32 v43, v43, v43
    v_lshlrev_b32 v43, 16, v43
    v_rcp_f32 v45, v43
    v_cvt_pk_bf16_f32 v41, v41, v41
    v_lshlrev_b32 v41, 16, v41
    v_sub_f32 v20, v20, v40
    v_cvt_pk_bf16_f32 v20, v20, v20
    v_lshlrev_b32 v20, 16, v20
    v_mul_f32 v46, v20, v44
    v_fma_f32 v47, -v46, v42, v20
    v_fma_f32 v20, v47, v44, v46
    v_cvt_pk_bf16_f32 v20, v20, v20
    v_lshlrev_b32 v20, 16, v20
    v_sub_f32 v21, v21, v40
    v_cvt_pk_bf16_f32 v21, v21, v21
    v_lshlrev_b32 v21, 16, v21
    v_mul_f32 v46, v21, v44
    v_fma_f32 v47, -v46, v42, v21
    v_fma_f32 v21, v47, v44, v46
    v_cvt_pk_bf16_f32 v21, v21, v21
    v_lshlrev_b32 v21, 16, v21
    v_sub_f32 v22, v22, v40
    v_cvt_pk_bf16_f32 v22, v22, v22
    v_lshlrev_b32 v22, 16, v22
    v_mul_f32 v46, v22, v44
    v_fma_f32 v47, -v46, v42, v22
    v_fma_f32 v22, v47, v44, v46
    v_cvt_pk_bf16_f32 v22, v22, v22
    v_lshlrev_b32 v22, 16, v22
    v_sub_f32 v23, v23, v40
    v_cvt_pk_bf16_f32 v23, v23, v23
    v_lshlrev_b32 v23, 16, v23
    v_mul_f32 v46, v23, v44
    v_fma_f32 v47, -v46, v42, v23
    v_fma_f32 v23, v47, v44, v46
    v_cvt_pk_bf16_f32 v23, v23, v23
    v_lshlrev_b32 v23, 16, v23
    v_sub_f32 v24, v24, v40
    v_cvt_pk_bf16_f32 v24, v24, v24
    v_lshlrev_b32 v24, 16, v24
    v_mul_f32 v46, v24, v44
    v_fma_f32 v47, -v46, v42, v24
    v_fma_f32 v24, v47, v44, v46
    v_cvt_pk_bf16_f32 v24, v24, v24
    v_lshlrev_b32 v24, 16, v24
    v_sub_f32 v25, v25, v40
    v_cvt_pk_bf16_f32 v25, v25, v25
    v_lshlrev_b32 v25, 16, v25
    v_mul_f32 v46, v25, v44
    v_fma_f32 v47, -v46, v42, v25
    v_fma_f32 v25, v47, v44, v46
    v_cvt_pk_bf16_f32 v25, v25, v25
    v_lshlrev_b32 v25, 16, v25
    v_sub_f32 v26, v26, v40
    v_cvt_pk_bf16_f32 v26, v26, v26
    v_lshlrev_b32 v26, 16, v26
    v_mul_f32 v46, v26, v44
    v_fma_f32 v47, -v46, v42, v26
    v_fma_f32 v26, v47, v44, v46
    v_cvt_pk_bf16_f32 v26, v26, v26
    v_lshlrev_b32 v26, 16, v26
    v_sub_f32 v27, v27, v40
    v_cvt_pk_bf16_f32 v27, v27, v27
    v_lshlrev_b32 v27, 16, v27
    v_mul_f32 v46, v27, v44
    v_fma_f32 v47, -v46, v42, v27
    v_fma_f32 v27, v47, v44, v46
    v_cvt_pk_bf16_f32 v27, v27, v27
    v_lshlrev_b32 v27, 16, v27
    v_sub_f32 v28, v28, v40
    v_cvt_pk_bf16_f32 v28, v28, v28
    v_lshlrev_b32 v28, 16, v28
    v_mul_f32 v46, v28, v44
    v_fma_f32 v47, -v46, v42, v28
    v_fma_f32 v28, v47, v44, v46
    v_cvt_pk_bf16_f32 v28, v28, v28
    v_lshlrev_b32 v28, 16, v28
    v_sub_f32 v29, v29, v40
    v_cvt_pk_bf16_f32 v29, v29, v29
    v_lshlrev_b32 v29, 16, v29
    v_mul_f32 v46, v29, v44
    v_fma_f32 v47, -v46, v42, v29
    v_fma_f32 v29, v47, v44, v46
    v_cvt_pk_bf16_f32 v29, v29, v29
    v_lshlrev_b32 v29, 16, v29
    v_sub_f32 v30, v30, v41
    v_cvt_pk_bf16_f32 v30, v30, v30
    v_lshlrev_b32 v30, 16, v30
    v_mul_f32 v46, v30, v45
    v_fma_f32 v47, -v46, v43, v30
    v_fma_f32 v30, v47, v45, v46
    v_cvt_pk_bf16_f32 v30, v30, v30
    v_lshlrev_b32 v30, 16, v30
    v_sub_f32 v31, v31, v41
    v_cvt_pk_bf16_f32 v31, v31, v31
    v_lshlrev_b32 v31, 16, v31
    v_mul_f32 v46, v31, v45
    v_fma_f32 v47, -v46, v43, v31
    v_fma_f32 v31, v47, v45, v46
    v_cvt_pk_bf16_f32 v31, v31, v31
    v_lshlrev_b32 v31, 16, v31
    v_sub_f32 v32, v32, v41
    v_cvt_pk_bf16_f32 v32, v32, v32
    v_lshlrev_b32 v32, 16, v32
    v_mul_f32 v46, v32, v45
    v_fma_f32 v47, -v46, v43, v32
    v_fma_f32 v32, v47, v45, v46
    v_cvt_pk_bf16_f32 v32, v32, v32
    v_lshlrev_b32 v32, 16, v32
    v_sub_f32 v33, v33, v41
    v_cvt_pk_bf16_f32 v33, v33, v33
    v_lshlrev_b32 v33, 16, v33
    v_mul_f32 v46, v33, v45
    v_fma_f32 v47, -v46, v43, v33
    v_fma_f32 v33, v47, v45, v46
    v_cvt_pk_bf16_f32 v33, v33, v33
    v_lshlrev_b32 v33, 16, v33
    v_sub_f32 v34, v34, v41
    v_cvt_pk_bf16_f32 v34, v34, v34
    v_lshlrev_b32 v34, 16, v34
    v_mul_f32 v46, v34, v45
    v_fma_f32 v47, -v46, v43, v34
    v_fma_f32 v34, v47, v45, v46
    v_cvt_pk_bf16_f32 v34, v34, v34
    v_lshlrev_b32 v34, 16, v34
    v_sub_f32 v35, v35, v41
    v_cvt_pk_bf16_f32 v35, v35, v35
    v_lshlrev_b32 v35, 16, v35
    v_mul_f32 v46, v35, v45
    v_fma_f32 v47, -v46, v43, v35
    v_fma_f32 v35, v47, v45, v46
    v_cvt_pk_bf16_f32 v35, v35, v35
    v_lshlrev_b32 v35, 16, v35
    v_sub_f32 v36, v36, v41
    v_cvt_pk_bf16_f32 v36, v36, v36
    v_lshlrev_b32 v36, 16, v36
    v_mul_f32 v46, v36, v45
    v_fma_f32 v47, -v46, v43, v36
    v_fma_f32 v36, v47, v45, v46
    v_cvt_pk_bf16_f32 v36, v36, v36
    v_lshlrev_b32 v36, 16, v36
    v_sub_f32 v37, v37, v41
    v_cvt_pk_bf16_f32 v37, v37, v37
    v_lshlrev_b32 v37, 16, v37
    v_mul_f32 v46, v37, v45
    v_fma_f32 v47, -v46, v43, v37
    v_fma_f32 v37, v47, v45, v46
    v_cvt_pk_bf16_f32 v37, v37, v37
    v_lshlrev_b32 v37, 16, v37
    v_sub_f32 v38, v38, v41
    v_cvt_pk_bf16_f32 v38, v38, v38
    v_lshlrev_b32 v38, 16, v38
    v_mul_f32 v46, v38, v45
    v_fma_f32 v47, -v46, v43, v38
    v_fma_f32 v38, v47, v45, v46
    v_cvt_pk_bf16_f32 v38, v38, v38
    v_lshlrev_b32 v38, 16, v38
    v_sub_f32 v39, v39, v41
    v_cvt_pk_bf16_f32 v39, v39, v39
    v_lshlrev_b32 v39, 16, v39
    v_mul_f32 v46, v39, v45
    v_fma_f32 v47, -v46, v43, v39
    v_fma_f32 v39, v47, v45, v46
    v_cvt_pk_bf16_f32 v39, v39, v39
    v_lshlrev_b32 v39, 16, v39
    v_cvt_pk_bf16_f32 v4, v20, v21
    buffer_store_dword v4, v2, s[28:31], s21 offen offset:0
    v_cvt_pk_bf16_f32 v5, v22, v23
    buffer_store_dword v5, v2, s[28:31], s21 offen offset:256
    v_cvt_pk_bf16_f32 v6, v24, v25
    buffer_store_dword v6, v2, s[28:31], s21 offen offset:512
    v_cvt_pk_bf16_f32 v7, v26, v27
    buffer_store_dword v7, v2, s[28:31], s21 offen offset:768
    v_cvt_pk_bf16_f32 v8, v28, v29
    buffer_store_dword v8, v2, s[28:31], s21 offen offset:1024
    v_cvt_pk_bf16_f32 v9, v30, v31
    buffer_store_dword v9, v2, s[28:31], s21 offen offset:1280
    v_cvt_pk_bf16_f32 v10, v32, v33
    buffer_store_dword v10, v2, s[28:31], s21 offen offset:1536
    v_cvt_pk_bf16_f32 v11, v34, v35
    buffer_store_dword v11, v2, s[28:31], s21 offen offset:1792
    v_cvt_pk_bf16_f32 v12, v36, v37
    buffer_store_dword v12, v2, s[28:31], s21 offen offset:2048
    v_cvt_pk_bf16_f32 v13, v38, v39
    buffer_store_dword v13, v2, s[28:31], s21 offen offset:2304
.Lk3b_kernel_end:
    s_endpgm
.globl g1b_kernel
.p2align 8
.type g1b_kernel,@function
g1b_kernel:
    s_cmp_ge_u32 s2, 432
    s_cbranch_scc1 .Lg1b_kernel_end
    s_load_dwordx2 s[4:5], s[0:1], 72
    s_and_b32 s18, s2, 7
    s_mul_i32 s18, s18, 54
    s_lshr_b32 s19, s2, 3
    s_add_u32 s18, s18, s19
    s_and_b32 s20, s18, 15
    s_lshr_b32 s21, s18, 4
    s_waitcnt lgkmcnt(0)
    s_mov_b32 s3, 15728640
    s_add_u32 s8, s4, s3
    s_addc_u32 s9, s5, 0
    s_mov_b32 s10, 2621440
    s_mov_b32 s11, 0x00020000
    s_mov_b32 s3, 44040192
    s_add_u32 s12, s4, s3
    s_addc_u32 s13, s5, 0
    s_mov_b32 s14, 4423680
    s_mov_b32 s15, 0x00020000
    s_mul_i32 s16, s20, 163840
    s_mul_i32 s17, s21, 163840
    v_lshrrev_b32 v5, 3, v0
    v_and_b32 v6, 7, v0
    s_mov_b32 s19, 1280
    v_mul_lo_u32 v1, v5, s19
    v_lshl_add_u32 v1, v6, 4, v1
    v_mul_u32_u24 v2, 144, v5
    v_lshl_add_u32 v2, v6, 4, v2
    v_lshrrev_b32 v5, 6, v0
    v_and_b32 v6, 31, v0
    v_lshrrev_b32 v7, 5, v0
    v_and_b32 v7, 1, v7
    v_lshrrev_b32 v8, 1, v5
    v_and_b32 v9, 1, v5
    v_lshl_add_u32 v8, v8, 6, v6
    v_mul_u32_u24 v3, 144, v8
    v_lshl_add_u32 v3, v7, 4, v3
    v_lshl_add_u32 v9, v9, 5, v6
    v_mul_u32_u24 v4, 144, v9
    v_lshl_add_u32 v4, v7, 4, v4
    v_add_u32 v4, 18432, v4
    v_add_u32 v10, 36864, v2
    v_add_u32 v11, 36864, v3
    v_add_u32 v12, 36864, v4
    v_mov_b32 v64, 0
    v_mov_b32 v65, 0
    v_mov_b32 v66, 0
    v_mov_b32 v67, 0
    v_mov_b32 v68, 0
    v_mov_b32 v69, 0
    v_mov_b32 v70, 0
    v_mov_b32 v71, 0
    v_mov_b32 v72, 0
    v_mov_b32 v73, 0
    v_mov_b32 v74, 0
    v_mov_b32 v75, 0
    v_mov_b32 v76, 0
    v_mov_b32 v77, 0
    v_mov_b32 v78, 0
    v_mov_b32 v79, 0
    v_mov_b32 v80, 0
    v_mov_b32 v81, 0
    v_mov_b32 v82, 0
    v_mov_b32 v83, 0
    v_mov_b32 v84, 0
    v_mov_b32 v85, 0
    v_mov_b32 v86, 0
    v_mov_b32 v87, 0
    v_mov_b32 v88, 0
    v_mov_b32 v89, 0
    v_mov_b32 v90, 0
    v_mov_b32 v91, 0
    v_mov_b32 v92, 0
    v_mov_b32 v93, 0
    v_mov_b32 v94, 0
    v_mov_b32 v95, 0
    v_mov_b32 v96, 0
    v_mov_b32 v97, 0
    v_mov_b32 v98, 0
    v_mov_b32 v99, 0
    v_mov_b32 v100, 0
    v_mov_b32 v101, 0
    v_mov_b32 v102, 0
    v_mov_b32 v103, 0
    v_mov_b32 v104, 0
    v_mov_b32 v105, 0
    v_mov_b32 v106, 0
    v_mov_b32 v107, 0
    v_mov_b32 v108, 0
    v_mov_b32 v109, 0
    v_mov_b32 v110, 0
    v_mov_b32 v111, 0
    v_mov_b32 v112, 0
    v_mov_b32 v113, 0
    v_mov_b32 v114, 0
    v_mov_b32 v115, 0
    v_mov_b32 v116, 0
    v_mov_b32 v117, 0
    v_mov_b32 v118, 0
    v_mov_b32 v119, 0
    v_mov_b32 v120, 0
    v_mov_b32 v121, 0
    v_mov_b32 v122, 0
    v_mov_b32 v123, 0
    v_mov_b32 v124, 0
    v_mov_b32 v125, 0
    v_mov_b32 v126, 0
    v_mov_b32 v127, 0
    s_add_u32 s25, s16, 40960
    s_add_u32 s28, s17, 40960
    s_add_u32 s26, s16, 81920
    s_add_u32 s29, s17, 81920
    s_add_u32 s27, s16, 122880
    s_add_u32 s30, s17, 122880
    buffer_load_dwordx4 v[16:19], v1, s[8:11], s16 offen offset:0
    buffer_load_dwordx4 v[20:23], v1, s[8:11], s25 offen
    buffer_load_dwordx4 v[24:27], v1, s[8:11], s26 offen
    buffer_load_dwordx4 v[28:31], v1, s[8:11], s27 offen
    buffer_load_dwordx4 v[32:35], v1, s[12:15], s17 offen
    buffer_load_dwordx4 v[36:39], v1, s[12:15], s28 offen
    buffer_load_dwordx4 v[40:43], v1, s[12:15], s29 offen
    buffer_load_dwordx4 v[44:47], v1, s[12:15], s30 offen
    s_waitcnt vmcnt(0)
    ds_write_b128 v2, v[16:19] offset:0
    ds_write_b128 v2, v[20:23] offset:4608
    ds_write_b128 v2, v[24:27] offset:9216
    ds_write_b128 v2, v[28:31] offset:13824
    ds_write_b128 v2, v[32:35] offset:18432
    ds_write_b128 v2, v[36:39] offset:23040
    ds_write_b128 v2, v[40:43] offset:27648
    ds_write_b128 v2, v[44:47] offset:32256
    s_waitcnt lgkmcnt(0)
    s_barrier
    s_add_u32 s16, s16, 128
    s_add_u32 s17, s17, 128
    s_add_u32 s25, s16, 40960
    s_add_u32 s28, s17, 40960
    s_add_u32 s26, s16, 81920
    s_add_u32 s29, s17, 81920
    s_add_u32 s27, s16, 122880
    s_add_u32 s30, s17, 122880
    buffer_load_dwordx4 v[16:19], v1, s[8:11], s16 offen offset:0
    buffer_load_dwordx4 v[20:23], v1, s[8:11], s25 offen
    buffer_load_dwordx4 v[24:27], v1, s[8:11], s26 offen
    buffer_load_dwordx4 v[28:31], v1, s[8:11], s27 offen
    buffer_load_dwordx4 v[32:35], v1, s[12:15], s17 offen
    buffer_load_dwordx4 v[36:39], v1, s[12:15], s28 offen
    buffer_load_dwordx4 v[40:43], v1, s[12:15], s29 offen
    buffer_load_dwordx4 v[44:47], v1, s[12:15], s30 offen
    ds_read_b128 v[48:51], v3 offset:0
    ds_read_b128 v[52:55], v3 offset:4608
    ds_read_b128 v[56:59], v4 offset:0
    ds_read_b128 v[60:63], v4 offset:9216
    ds_read_b128 v[128:131], v3 offset:32
    ds_read_b128 v[132:135], v3 offset:4640
    ds_read_b128 v[136:139], v4 offset:32
    ds_read_b128 v[140:143], v4 offset:9248
    s_waitcnt lgkmcnt(4)
    v_mfma_f32_32x32x16_bf16 v[64:79], v[56:59], v[48:51], v[64:79]
    v_mfma_f32_32x32x16_bf16 v[80:95], v[60:63], v[48:51], v[80:95]
    v_mfma_f32_32x32x16_bf16 v[96:111], v[56:59], v[52:55], v[96:111]
    v_mfma_f32_32x32x16_bf16 v[112:127], v[60:63], v[52:55], v[112:127]
    ds_read_b128 v[48:51], v3 offset:64
    ds_read_b128 v[52:55], v3 offset:4672
    ds_read_b128 v[56:59], v4 offset:64
    ds_read_b128 v[60:63], v4 offset:9280
    s_waitcnt lgkmcnt(4)
    v_mfma_f32_32x32x16_bf16 v[64:79], v[136:139], v[128:131], v[64:79]
    v_mfma_f32_32x32x16_bf16 v[80:95], v[140:143], v[128:131], v[80:95]
    v_mfma_f32_32x32x16_bf16 v[96:111], v[136:139], v[132:135], v[96:111]
    v_mfma_f32_32x32x16_bf16 v[112:127], v[140:143], v[132:135], v[112:127]
    ds_read_b128 v[128:131], v3 offset:96
    ds_read_b128 v[132:135], v3 offset:4704
    ds_read_b128 v[136:139], v4 offset:96
    ds_read_b128 v[140:143], v4 offset:9312
    s_waitcnt lgkmcnt(4)
    v_mfma_f32_32x32x16_bf16 v[64:79], v[56:59], v[48:51], v[64:79]
    v_mfma_f32_32x32x16_bf16 v[80:95], v[60:63], v[48:51], v[80:95]
    v_mfma_f32_32x32x16_bf16 v[96:111], v[56:59], v[52:55], v[96:111]
    v_mfma_f32_32x32x16_bf16 v[112:127], v[60:63], v[52:55], v[112:127]
    s_waitcnt lgkmcnt(0)
    s_waitcnt vmcnt(0)
    v_mfma_f32_32x32x16_bf16 v[64:79], v[136:139], v[128:131], v[64:79]
    ds_write_b128 v10, v[16:19] offset:0
    ds_write_b128 v10, v[20:23] offset:4608
    v_mfma_f32_32x32x16_bf16 v[80:95], v[140:143], v[128:131], v[80:95]
    ds_write_b128 v10, v[24:27] offset:9216
    ds_write_b128 v10, v[28:31] offset:13824
    v_mfma_f32_32x32x16_bf16 v[96:111], v[136:139], v[132:135], v[96:111]
    ds_write_b128 v10, v[32:35] offset:18432
    ds_write_b128 v10, v[36:39] offset:23040
    v_mfma_f32_32x32x16_bf16 v[112:127], v[140:143], v[132:135], v[112:127]
    ds_write_b128 v10, v[40:43] offset:27648
    ds_write_b128 v10, v[44:47] offset:32256
    s_waitcnt lgkmcnt(0)
    s_barrier
    s_add_u32 s16, s16, 128
    s_add_u32 s17, s17, 128
    s_add_u32 s25, s16, 40960
    s_add_u32 s28, s17, 40960
    s_add_u32 s26, s16, 81920
    s_add_u32 s29, s17, 81920
    s_add_u32 s27, s16, 122880
    s_add_u32 s30, s17, 122880
    buffer_load_dwordx4 v[16:19], v1, s[8:11], s16 offen offset:0
    buffer_load_dwordx4 v[20:23], v1, s[8:11], s25 offen
    buffer_load_dwordx4 v[24:27], v1, s[8:11], s26 offen
    buffer_load_dwordx4 v[28:31], v1, s[8:11], s27 offen
    buffer_load_dwordx4 v[32:35], v1, s[12:15], s17 offen
    buffer_load_dwordx4 v[36:39], v1, s[12:15], s28 offen
    buffer_load_dwordx4 v[40:43], v1, s[12:15], s29 offen
    buffer_load_dwordx4 v[44:47], v1, s[12:15], s30 offen
    ds_read_b128 v[48:51], v11 offset:0
    ds_read_b128 v[52:55], v11 offset:4608
    ds_read_b128 v[56:59], v12 offset:0
    ds_read_b128 v[60:63], v12 offset:9216
    ds_read_b128 v[128:131], v11 offset:32
    ds_read_b128 v[132:135], v11 offset:4640
    ds_read_b128 v[136:139], v12 offset:32
    ds_read_b128 v[140:143], v12 offset:9248
    s_waitcnt lgkmcnt(4)
    v_mfma_f32_32x32x16_bf16 v[64:79], v[56:59], v[48:51], v[64:79]
    v_mfma_f32_32x32x16_bf16 v[80:95], v[60:63], v[48:51], v[80:95]
    v_mfma_f32_32x32x16_bf16 v[96:111], v[56:59], v[52:55], v[96:111]
    v_mfma_f32_32x32x16_bf16 v[112:127], v[60:63], v[52:55], v[112:127]
    ds_read_b128 v[48:51], v11 offset:64
    ds_read_b128 v[52:55], v11 offset:4672
    ds_read_b128 v[56:59], v12 offset:64
    ds_read_b128 v[60:63], v12 offset:9280
    s_waitcnt lgkmcnt(4)
    v_mfma_f32_32x32x16_bf16 v[64:79], v[136:139], v[128:131], v[64:79]
    v_mfma_f32_32x32x16_bf16 v[80:95], v[140:143], v[128:131], v[80:95]
    v_mfma_f32_32x32x16_bf16 v[96:111], v[136:139], v[132:135], v[96:111]
    v_mfma_f32_32x32x16_bf16 v[112:127], v[140:143], v[132:135], v[112:127]
    ds_read_b128 v[128:131], v11 offset:96
    ds_read_b128 v[132:135], v11 offset:4704
    ds_read_b128 v[136:139], v12 offset:96
    ds_read_b128 v[140:143], v12 offset:9312
    s_waitcnt lgkmcnt(4)
    v_mfma_f32_32x32x16_bf16 v[64:79], v[56:59], v[48:51], v[64:79]
    v_mfma_f32_32x32x16_bf16 v[80:95], v[60:63], v[48:51], v[80:95]
    v_mfma_f32_32x32x16_bf16 v[96:111], v[56:59], v[52:55], v[96:111]
    v_mfma_f32_32x32x16_bf16 v[112:127], v[60:63], v[52:55], v[112:127]
    s_waitcnt lgkmcnt(0)
    s_waitcnt vmcnt(0)
    v_mfma_f32_32x32x16_bf16 v[64:79], v[136:139], v[128:131], v[64:79]
    ds_write_b128 v2, v[16:19] offset:0
    ds_write_b128 v2, v[20:23] offset:4608
    v_mfma_f32_32x32x16_bf16 v[80:95], v[140:143], v[128:131], v[80:95]
    ds_write_b128 v2, v[24:27] offset:9216
    ds_write_b128 v2, v[28:31] offset:13824
    v_mfma_f32_32x32x16_bf16 v[96:111], v[136:139], v[132:135], v[96:111]
    ds_write_b128 v2, v[32:35] offset:18432
    ds_write_b128 v2, v[36:39] offset:23040
    v_mfma_f32_32x32x16_bf16 v[112:127], v[140:143], v[132:135], v[112:127]
    ds_write_b128 v2, v[40:43] offset:27648
    ds_write_b128 v2, v[44:47] offset:32256
    s_waitcnt lgkmcnt(0)
    s_barrier
    s_add_u32 s16, s16, 128
    s_add_u32 s17, s17, 128
    s_add_u32 s25, s16, 40960
    s_add_u32 s28, s17, 40960
    s_add_u32 s26, s16, 81920
    s_add_u32 s29, s17, 81920
    s_add_u32 s27, s16, 122880
    s_add_u32 s30, s17, 122880
    buffer_load_dwordx4 v[16:19], v1, s[8:11], s16 offen offset:0
    buffer_load_dwordx4 v[20:23], v1, s[8:11], s25 offen
    buffer_load_dwordx4 v[24:27], v1, s[8:11], s26 offen
    buffer_load_dwordx4 v[28:31], v1, s[8:11], s27 offen
    buffer_load_dwordx4 v[32:35], v1, s[12:15], s17 offen
    buffer_load_dwordx4 v[36:39], v1, s[12:15], s28 offen
    buffer_load_dwordx4 v[40:43], v1, s[12:15], s29 offen
    buffer_load_dwordx4 v[44:47], v1, s[12:15], s30 offen
    ds_read_b128 v[48:51], v3 offset:0
    ds_read_b128 v[52:55], v3 offset:4608
    ds_read_b128 v[56:59], v4 offset:0
    ds_read_b128 v[60:63], v4 offset:9216
    ds_read_b128 v[128:131], v3 offset:32
    ds_read_b128 v[132:135], v3 offset:4640
    ds_read_b128 v[136:139], v4 offset:32
    ds_read_b128 v[140:143], v4 offset:9248
    s_waitcnt lgkmcnt(4)
    v_mfma_f32_32x32x16_bf16 v[64:79], v[56:59], v[48:51], v[64:79]
    v_mfma_f32_32x32x16_bf16 v[80:95], v[60:63], v[48:51], v[80:95]
    v_mfma_f32_32x32x16_bf16 v[96:111], v[56:59], v[52:55], v[96:111]
    v_mfma_f32_32x32x16_bf16 v[112:127], v[60:63], v[52:55], v[112:127]
    ds_read_b128 v[48:51], v3 offset:64
    ds_read_b128 v[52:55], v3 offset:4672
    ds_read_b128 v[56:59], v4 offset:64
    ds_read_b128 v[60:63], v4 offset:9280
    s_waitcnt lgkmcnt(4)
    v_mfma_f32_32x32x16_bf16 v[64:79], v[136:139], v[128:131], v[64:79]
    v_mfma_f32_32x32x16_bf16 v[80:95], v[140:143], v[128:131], v[80:95]
    v_mfma_f32_32x32x16_bf16 v[96:111], v[136:139], v[132:135], v[96:111]
    v_mfma_f32_32x32x16_bf16 v[112:127], v[140:143], v[132:135], v[112:127]
    ds_read_b128 v[128:131], v3 offset:96
    ds_read_b128 v[132:135], v3 offset:4704
    ds_read_b128 v[136:139], v4 offset:96
    ds_read_b128 v[140:143], v4 offset:9312
    s_waitcnt lgkmcnt(4)
    v_mfma_f32_32x32x16_bf16 v[64:79], v[56:59], v[48:51], v[64:79]
    v_mfma_f32_32x32x16_bf16 v[80:95], v[60:63], v[48:51], v[80:95]
    v_mfma_f32_32x32x16_bf16 v[96:111], v[56:59], v[52:55], v[96:111]
    v_mfma_f32_32x32x16_bf16 v[112:127], v[60:63], v[52:55], v[112:127]
    s_waitcnt lgkmcnt(0)
    s_waitcnt vmcnt(0)
    v_mfma_f32_32x32x16_bf16 v[64:79], v[136:139], v[128:131], v[64:79]
    ds_write_b128 v10, v[16:19] offset:0
    ds_write_b128 v10, v[20:23] offset:4608
    v_mfma_f32_32x32x16_bf16 v[80:95], v[140:143], v[128:131], v[80:95]
    ds_write_b128 v10, v[24:27] offset:9216
    ds_write_b128 v10, v[28:31] offset:13824
    v_mfma_f32_32x32x16_bf16 v[96:111], v[136:139], v[132:135], v[96:111]
    ds_write_b128 v10, v[32:35] offset:18432
    ds_write_b128 v10, v[36:39] offset:23040
    v_mfma_f32_32x32x16_bf16 v[112:127], v[140:143], v[132:135], v[112:127]
    ds_write_b128 v10, v[40:43] offset:27648
    ds_write_b128 v10, v[44:47] offset:32256
    s_waitcnt lgkmcnt(0)
    s_barrier
    s_add_u32 s16, s16, 128
    s_add_u32 s17, s17, 128
    s_add_u32 s25, s16, 40960
    s_add_u32 s28, s17, 40960
    s_add_u32 s26, s16, 81920
    s_add_u32 s29, s17, 81920
    s_add_u32 s27, s16, 122880
    s_add_u32 s30, s17, 122880
    buffer_load_dwordx4 v[16:19], v1, s[8:11], s16 offen offset:0
    buffer_load_dwordx4 v[20:23], v1, s[8:11], s25 offen
    buffer_load_dwordx4 v[24:27], v1, s[8:11], s26 offen
    buffer_load_dwordx4 v[28:31], v1, s[8:11], s27 offen
    buffer_load_dwordx4 v[32:35], v1, s[12:15], s17 offen
    buffer_load_dwordx4 v[36:39], v1, s[12:15], s28 offen
    buffer_load_dwordx4 v[40:43], v1, s[12:15], s29 offen
    buffer_load_dwordx4 v[44:47], v1, s[12:15], s30 offen
    ds_read_b128 v[48:51], v11 offset:0
    ds_read_b128 v[52:55], v11 offset:4608
    ds_read_b128 v[56:59], v12 offset:0
    ds_read_b128 v[60:63], v12 offset:9216
    ds_read_b128 v[128:131], v11 offset:32
    ds_read_b128 v[132:135], v11 offset:4640
    ds_read_b128 v[136:139], v12 offset:32
    ds_read_b128 v[140:143], v12 offset:9248
    s_waitcnt lgkmcnt(4)
    v_mfma_f32_32x32x16_bf16 v[64:79], v[56:59], v[48:51], v[64:79]
    v_mfma_f32_32x32x16_bf16 v[80:95], v[60:63], v[48:51], v[80:95]
    v_mfma_f32_32x32x16_bf16 v[96:111], v[56:59], v[52:55], v[96:111]
    v_mfma_f32_32x32x16_bf16 v[112:127], v[60:63], v[52:55], v[112:127]
    ds_read_b128 v[48:51], v11 offset:64
    ds_read_b128 v[52:55], v11 offset:4672
    ds_read_b128 v[56:59], v12 offset:64
    ds_read_b128 v[60:63], v12 offset:9280
    s_waitcnt lgkmcnt(4)
    v_mfma_f32_32x32x16_bf16 v[64:79], v[136:139], v[128:131], v[64:79]
    v_mfma_f32_32x32x16_bf16 v[80:95], v[140:143], v[128:131], v[80:95]
    v_mfma_f32_32x32x16_bf16 v[96:111], v[136:139], v[132:135], v[96:111]
    v_mfma_f32_32x32x16_bf16 v[112:127], v[140:143], v[132:135], v[112:127]
    ds_read_b128 v[128:131], v11 offset:96
    ds_read_b128 v[132:135], v11 offset:4704
    ds_read_b128 v[136:139], v12 offset:96
    ds_read_b128 v[140:143], v12 offset:9312
    s_waitcnt lgkmcnt(4)
    v_mfma_f32_32x32x16_bf16 v[64:79], v[56:59], v[48:51], v[64:79]
    v_mfma_f32_32x32x16_bf16 v[80:95], v[60:63], v[48:51], v[80:95]
    v_mfma_f32_32x32x16_bf16 v[96:111], v[56:59], v[52:55], v[96:111]
    v_mfma_f32_32x32x16_bf16 v[112:127], v[60:63], v[52:55], v[112:127]
    s_waitcnt lgkmcnt(0)
    s_waitcnt vmcnt(0)
    v_mfma_f32_32x32x16_bf16 v[64:79], v[136:139], v[128:131], v[64:79]
    ds_write_b128 v2, v[16:19] offset:0
    ds_write_b128 v2, v[20:23] offset:4608
    v_mfma_f32_32x32x16_bf16 v[80:95], v[140:143], v[128:131], v[80:95]
    ds_write_b128 v2, v[24:27] offset:9216
    ds_write_b128 v2, v[28:31] offset:13824
    v_mfma_f32_32x32x16_bf16 v[96:111], v[136:139], v[132:135], v[96:111]
    ds_write_b128 v2, v[32:35] offset:18432
    ds_write_b128 v2, v[36:39] offset:23040
    v_mfma_f32_32x32x16_bf16 v[112:127], v[140:143], v[132:135], v[112:127]
    ds_write_b128 v2, v[40:43] offset:27648
    ds_write_b128 v2, v[44:47] offset:32256
    s_waitcnt lgkmcnt(0)
    s_barrier
    s_add_u32 s16, s16, 128
    s_add_u32 s17, s17, 128
    s_add_u32 s25, s16, 40960
    s_add_u32 s28, s17, 40960
    s_add_u32 s26, s16, 81920
    s_add_u32 s29, s17, 81920
    s_add_u32 s27, s16, 122880
    s_add_u32 s30, s17, 122880
    buffer_load_dwordx4 v[16:19], v1, s[8:11], s16 offen offset:0
    buffer_load_dwordx4 v[20:23], v1, s[8:11], s25 offen
    buffer_load_dwordx4 v[24:27], v1, s[8:11], s26 offen
    buffer_load_dwordx4 v[28:31], v1, s[8:11], s27 offen
    buffer_load_dwordx4 v[32:35], v1, s[12:15], s17 offen
    buffer_load_dwordx4 v[36:39], v1, s[12:15], s28 offen
    buffer_load_dwordx4 v[40:43], v1, s[12:15], s29 offen
    buffer_load_dwordx4 v[44:47], v1, s[12:15], s30 offen
    ds_read_b128 v[48:51], v3 offset:0
    ds_read_b128 v[52:55], v3 offset:4608
    ds_read_b128 v[56:59], v4 offset:0
    ds_read_b128 v[60:63], v4 offset:9216
    ds_read_b128 v[128:131], v3 offset:32
    ds_read_b128 v[132:135], v3 offset:4640
    ds_read_b128 v[136:139], v4 offset:32
    ds_read_b128 v[140:143], v4 offset:9248
    s_waitcnt lgkmcnt(4)
    v_mfma_f32_32x32x16_bf16 v[64:79], v[56:59], v[48:51], v[64:79]
    v_mfma_f32_32x32x16_bf16 v[80:95], v[60:63], v[48:51], v[80:95]
    v_mfma_f32_32x32x16_bf16 v[96:111], v[56:59], v[52:55], v[96:111]
    v_mfma_f32_32x32x16_bf16 v[112:127], v[60:63], v[52:55], v[112:127]
    ds_read_b128 v[48:51], v3 offset:64
    ds_read_b128 v[52:55], v3 offset:4672
    ds_read_b128 v[56:59], v4 offset:64
    ds_read_b128 v[60:63], v4 offset:9280
    s_waitcnt lgkmcnt(4)
    v_mfma_f32_32x32x16_bf16 v[64:79], v[136:139], v[128:131], v[64:79]
    v_mfma_f32_32x32x16_bf16 v[80:95], v[140:143], v[128:131], v[80:95]
    v_mfma_f32_32x32x16_bf16 v[96:111], v[136:139], v[132:135], v[96:111]
    v_mfma_f32_32x32x16_bf16 v[112:127], v[140:143], v[132:135], v[112:127]
    ds_read_b128 v[128:131], v3 offset:96
    ds_read_b128 v[132:135], v3 offset:4704
    ds_read_b128 v[136:139], v4 offset:96
    ds_read_b128 v[140:143], v4 offset:9312
    s_waitcnt lgkmcnt(4)
    v_mfma_f32_32x32x16_bf16 v[64:79], v[56:59], v[48:51], v[64:79]
    v_mfma_f32_32x32x16_bf16 v[80:95], v[60:63], v[48:51], v[80:95]
    v_mfma_f32_32x32x16_bf16 v[96:111], v[56:59], v[52:55], v[96:111]
    v_mfma_f32_32x32x16_bf16 v[112:127], v[60:63], v[52:55], v[112:127]
    s_waitcnt lgkmcnt(0)
    s_waitcnt vmcnt(0)
    v_mfma_f32_32x32x16_bf16 v[64:79], v[136:139], v[128:131], v[64:79]
    ds_write_b128 v10, v[16:19] offset:0
    ds_write_b128 v10, v[20:23] offset:4608
    v_mfma_f32_32x32x16_bf16 v[80:95], v[140:143], v[128:131], v[80:95]
    ds_write_b128 v10, v[24:27] offset:9216
    ds_write_b128 v10, v[28:31] offset:13824
    v_mfma_f32_32x32x16_bf16 v[96:111], v[136:139], v[132:135], v[96:111]
    ds_write_b128 v10, v[32:35] offset:18432
    ds_write_b128 v10, v[36:39] offset:23040
    v_mfma_f32_32x32x16_bf16 v[112:127], v[140:143], v[132:135], v[112:127]
    ds_write_b128 v10, v[40:43] offset:27648
    ds_write_b128 v10, v[44:47] offset:32256
    s_waitcnt lgkmcnt(0)
    s_barrier
    s_add_u32 s16, s16, 128
    s_add_u32 s17, s17, 128
    s_add_u32 s25, s16, 40960
    s_add_u32 s28, s17, 40960
    s_add_u32 s26, s16, 81920
    s_add_u32 s29, s17, 81920
    s_add_u32 s27, s16, 122880
    s_add_u32 s30, s17, 122880
    buffer_load_dwordx4 v[16:19], v1, s[8:11], s16 offen offset:0
    buffer_load_dwordx4 v[20:23], v1, s[8:11], s25 offen
    buffer_load_dwordx4 v[24:27], v1, s[8:11], s26 offen
    buffer_load_dwordx4 v[28:31], v1, s[8:11], s27 offen
    buffer_load_dwordx4 v[32:35], v1, s[12:15], s17 offen
    buffer_load_dwordx4 v[36:39], v1, s[12:15], s28 offen
    buffer_load_dwordx4 v[40:43], v1, s[12:15], s29 offen
    buffer_load_dwordx4 v[44:47], v1, s[12:15], s30 offen
    ds_read_b128 v[48:51], v11 offset:0
    ds_read_b128 v[52:55], v11 offset:4608
    ds_read_b128 v[56:59], v12 offset:0
    ds_read_b128 v[60:63], v12 offset:9216
    ds_read_b128 v[128:131], v11 offset:32
    ds_read_b128 v[132:135], v11 offset:4640
    ds_read_b128 v[136:139], v12 offset:32
    ds_read_b128 v[140:143], v12 offset:9248
    s_waitcnt lgkmcnt(4)
    v_mfma_f32_32x32x16_bf16 v[64:79], v[56:59], v[48:51], v[64:79]
    v_mfma_f32_32x32x16_bf16 v[80:95], v[60:63], v[48:51], v[80:95]
    v_mfma_f32_32x32x16_bf16 v[96:111], v[56:59], v[52:55], v[96:111]
    v_mfma_f32_32x32x16_bf16 v[112:127], v[60:63], v[52:55], v[112:127]
    ds_read_b128 v[48:51], v11 offset:64
    ds_read_b128 v[52:55], v11 offset:4672
    ds_read_b128 v[56:59], v12 offset:64
    ds_read_b128 v[60:63], v12 offset:9280
    s_waitcnt lgkmcnt(4)
    v_mfma_f32_32x32x16_bf16 v[64:79], v[136:139], v[128:131], v[64:79]
    v_mfma_f32_32x32x16_bf16 v[80:95], v[140:143], v[128:131], v[80:95]
    v_mfma_f32_32x32x16_bf16 v[96:111], v[136:139], v[132:135], v[96:111]
    v_mfma_f32_32x32x16_bf16 v[112:127], v[140:143], v[132:135], v[112:127]
    ds_read_b128 v[128:131], v11 offset:96
    ds_read_b128 v[132:135], v11 offset:4704
    ds_read_b128 v[136:139], v12 offset:96
    ds_read_b128 v[140:143], v12 offset:9312
    s_waitcnt lgkmcnt(4)
    v_mfma_f32_32x32x16_bf16 v[64:79], v[56:59], v[48:51], v[64:79]
    v_mfma_f32_32x32x16_bf16 v[80:95], v[60:63], v[48:51], v[80:95]
    v_mfma_f32_32x32x16_bf16 v[96:111], v[56:59], v[52:55], v[96:111]
    v_mfma_f32_32x32x16_bf16 v[112:127], v[60:63], v[52:55], v[112:127]
    s_waitcnt lgkmcnt(0)
    s_waitcnt vmcnt(0)
    v_mfma_f32_32x32x16_bf16 v[64:79], v[136:139], v[128:131], v[64:79]
    ds_write_b128 v2, v[16:19] offset:0
    ds_write_b128 v2, v[20:23] offset:4608
    v_mfma_f32_32x32x16_bf16 v[80:95], v[140:143], v[128:131], v[80:95]
    ds_write_b128 v2, v[24:27] offset:9216
    ds_write_b128 v2, v[28:31] offset:13824
    v_mfma_f32_32x32x16_bf16 v[96:111], v[136:139], v[132:135], v[96:111]
    ds_write_b128 v2, v[32:35] offset:18432
    ds_write_b128 v2, v[36:39] offset:23040
    v_mfma_f32_32x32x16_bf16 v[112:127], v[140:143], v[132:135], v[112:127]
    ds_write_b128 v2, v[40:43] offset:27648
    ds_write_b128 v2, v[44:47] offset:32256
    s_waitcnt lgkmcnt(0)
    s_barrier
    s_add_u32 s16, s16, 128
    s_add_u32 s17, s17, 128
    s_add_u32 s25, s16, 40960
    s_add_u32 s28, s17, 40960
    s_add_u32 s26, s16, 81920
    s_add_u32 s29, s17, 81920
    s_add_u32 s27, s16, 122880
    s_add_u32 s30, s17, 122880
    buffer_load_dwordx4 v[16:19], v1, s[8:11], s16 offen offset:0
    buffer_load_dwordx4 v[20:23], v1, s[8:11], s25 offen
    buffer_load_dwordx4 v[24:27], v1, s[8:11], s26 offen
    buffer_load_dwordx4 v[28:31], v1, s[8:11], s27 offen
    buffer_load_dwordx4 v[32:35], v1, s[12:15], s17 offen
    buffer_load_dwordx4 v[36:39], v1, s[12:15], s28 offen
    buffer_load_dwordx4 v[40:43], v1, s[12:15], s29 offen
    buffer_load_dwordx4 v[44:47], v1, s[12:15], s30 offen
    ds_read_b128 v[48:51], v3 offset:0
    ds_read_b128 v[52:55], v3 offset:4608
    ds_read_b128 v[56:59], v4 offset:0
    ds_read_b128 v[60:63], v4 offset:9216
    ds_read_b128 v[128:131], v3 offset:32
    ds_read_b128 v[132:135], v3 offset:4640
    ds_read_b128 v[136:139], v4 offset:32
    ds_read_b128 v[140:143], v4 offset:9248
    s_waitcnt lgkmcnt(4)
    v_mfma_f32_32x32x16_bf16 v[64:79], v[56:59], v[48:51], v[64:79]
    v_mfma_f32_32x32x16_bf16 v[80:95], v[60:63], v[48:51], v[80:95]
    v_mfma_f32_32x32x16_bf16 v[96:111], v[56:59], v[52:55], v[96:111]
    v_mfma_f32_32x32x16_bf16 v[112:127], v[60:63], v[52:55], v[112:127]
    ds_read_b128 v[48:51], v3 offset:64
    ds_read_b128 v[52:55], v3 offset:4672
    ds_read_b128 v[56:59], v4 offset:64
    ds_read_b128 v[60:63], v4 offset:9280
    s_waitcnt lgkmcnt(4)
    v_mfma_f32_32x32x16_bf16 v[64:79], v[136:139], v[128:131], v[64:79]
    v_mfma_f32_32x32x16_bf16 v[80:95], v[140:143], v[128:131], v[80:95]
    v_mfma_f32_32x32x16_bf16 v[96:111], v[136:139], v[132:135], v[96:111]
    v_mfma_f32_32x32x16_bf16 v[112:127], v[140:143], v[132:135], v[112:127]
    ds_read_b128 v[128:131], v3 offset:96
    ds_read_b128 v[132:135], v3 offset:4704
    ds_read_b128 v[136:139], v4 offset:96
    ds_read_b128 v[140:143], v4 offset:9312
    s_waitcnt lgkmcnt(4)
    v_mfma_f32_32x32x16_bf16 v[64:79], v[56:59], v[48:51], v[64:79]
    v_mfma_f32_32x32x16_bf16 v[80:95], v[60:63], v[48:51], v[80:95]
    v_mfma_f32_32x32x16_bf16 v[96:111], v[56:59], v[52:55], v[96:111]
    v_mfma_f32_32x32x16_bf16 v[112:127], v[60:63], v[52:55], v[112:127]
    s_waitcnt lgkmcnt(0)
    s_waitcnt vmcnt(0)
    v_mfma_f32_32x32x16_bf16 v[64:79], v[136:139], v[128:131], v[64:79]
    ds_write_b128 v10, v[16:19] offset:0
    ds_write_b128 v10, v[20:23] offset:4608
    v_mfma_f32_32x32x16_bf16 v[80:95], v[140:143], v[128:131], v[80:95]
    ds_write_b128 v10, v[24:27] offset:9216
    ds_write_b128 v10, v[28:31] offset:13824
    v_mfma_f32_32x32x16_bf16 v[96:111], v[136:139], v[132:135], v[96:111]
    ds_write_b128 v10, v[32:35] offset:18432
    ds_write_b128 v10, v[36:39] offset:23040
    v_mfma_f32_32x32x16_bf16 v[112:127], v[140:143], v[132:135], v[112:127]
    ds_write_b128 v10, v[40:43] offset:27648
    ds_write_b128 v10, v[44:47] offset:32256
    s_waitcnt lgkmcnt(0)
    s_barrier
    s_add_u32 s16, s16, 128
    s_add_u32 s17, s17, 128
    s_add_u32 s25, s16, 40960
    s_add_u32 s28, s17, 40960
    s_add_u32 s26, s16, 81920
    s_add_u32 s29, s17, 81920
    s_add_u32 s27, s16, 122880
    s_add_u32 s30, s17, 122880
    buffer_load_dwordx4 v[16:19], v1, s[8:11], s16 offen offset:0
    buffer_load_dwordx4 v[20:23], v1, s[8:11], s25 offen
    buffer_load_dwordx4 v[24:27], v1, s[8:11], s26 offen
    buffer_load_dwordx4 v[28:31], v1, s[8:11], s27 offen
    buffer_load_dwordx4 v[32:35], v1, s[12:15], s17 offen
    buffer_load_dwordx4 v[36:39], v1, s[12:15], s28 offen
    buffer_load_dwordx4 v[40:43], v1, s[12:15], s29 offen
    buffer_load_dwordx4 v[44:47], v1, s[12:15], s30 offen
    ds_read_b128 v[48:51], v11 offset:0
    ds_read_b128 v[52:55], v11 offset:4608
    ds_read_b128 v[56:59], v12 offset:0
    ds_read_b128 v[60:63], v12 offset:9216
    ds_read_b128 v[128:131], v11 offset:32
    ds_read_b128 v[132:135], v11 offset:4640
    ds_read_b128 v[136:139], v12 offset:32
    ds_read_b128 v[140:143], v12 offset:9248
    s_waitcnt lgkmcnt(4)
    v_mfma_f32_32x32x16_bf16 v[64:79], v[56:59], v[48:51], v[64:79]
    v_mfma_f32_32x32x16_bf16 v[80:95], v[60:63], v[48:51], v[80:95]
    v_mfma_f32_32x32x16_bf16 v[96:111], v[56:59], v[52:55], v[96:111]
    v_mfma_f32_32x32x16_bf16 v[112:127], v[60:63], v[52:55], v[112:127]
    ds_read_b128 v[48:51], v11 offset:64
    ds_read_b128 v[52:55], v11 offset:4672
    ds_read_b128 v[56:59], v12 offset:64
    ds_read_b128 v[60:63], v12 offset:9280
    s_waitcnt lgkmcnt(4)
    v_mfma_f32_32x32x16_bf16 v[64:79], v[136:139], v[128:131], v[64:79]
    v_mfma_f32_32x32x16_bf16 v[80:95], v[140:143], v[128:131], v[80:95]
    v_mfma_f32_32x32x16_bf16 v[96:111], v[136:139], v[132:135], v[96:111]
    v_mfma_f32_32x32x16_bf16 v[112:127], v[140:143], v[132:135], v[112:127]
    ds_read_b128 v[128:131], v11 offset:96
    ds_read_b128 v[132:135], v11 offset:4704
    ds_read_b128 v[136:139], v12 offset:96
    ds_read_b128 v[140:143], v12 offset:9312
    s_waitcnt lgkmcnt(4)
    v_mfma_f32_32x32x16_bf16 v[64:79], v[56:59], v[48:51], v[64:79]
    v_mfma_f32_32x32x16_bf16 v[80:95], v[60:63], v[48:51], v[80:95]
    v_mfma_f32_32x32x16_bf16 v[96:111], v[56:59], v[52:55], v[96:111]
    v_mfma_f32_32x32x16_bf16 v[112:127], v[60:63], v[52:55], v[112:127]
    s_waitcnt lgkmcnt(0)
    s_waitcnt vmcnt(0)
    v_mfma_f32_32x32x16_bf16 v[64:79], v[136:139], v[128:131], v[64:79]
    ds_write_b128 v2, v[16:19] offset:0
    ds_write_b128 v2, v[20:23] offset:4608
    v_mfma_f32_32x32x16_bf16 v[80:95], v[140:143], v[128:131], v[80:95]
    ds_write_b128 v2, v[24:27] offset:9216
    ds_write_b128 v2, v[28:31] offset:13824
    v_mfma_f32_32x32x16_bf16 v[96:111], v[136:139], v[132:135], v[96:111]
    ds_write_b128 v2, v[32:35] offset:18432
    ds_write_b128 v2, v[36:39] offset:23040
    v_mfma_f32_32x32x16_bf16 v[112:127], v[140:143], v[132:135], v[112:127]
    ds_write_b128 v2, v[40:43] offset:27648
    ds_write_b128 v2, v[44:47] offset:32256
    s_waitcnt lgkmcnt(0)
    s_barrier
    s_add_u32 s16, s16, 128
    s_add_u32 s17, s17, 128
    s_add_u32 s25, s16, 40960
    s_add_u32 s28, s17, 40960
    s_add_u32 s26, s16, 81920
    s_add_u32 s29, s17, 81920
    s_add_u32 s27, s16, 122880
    s_add_u32 s30, s17, 122880
    buffer_load_dwordx4 v[16:19], v1, s[8:11], s16 offen offset:0
    buffer_load_dwordx4 v[20:23], v1, s[8:11], s25 offen
    buffer_load_dwordx4 v[24:27], v1, s[8:11], s26 offen
    buffer_load_dwordx4 v[28:31], v1, s[8:11], s27 offen
    buffer_load_dwordx4 v[32:35], v1, s[12:15], s17 offen
    buffer_load_dwordx4 v[36:39], v1, s[12:15], s28 offen
    buffer_load_dwordx4 v[40:43], v1, s[12:15], s29 offen
    buffer_load_dwordx4 v[44:47], v1, s[12:15], s30 offen
    ds_read_b128 v[48:51], v3 offset:0
    ds_read_b128 v[52:55], v3 offset:4608
    ds_read_b128 v[56:59], v4 offset:0
    ds_read_b128 v[60:63], v4 offset:9216
    ds_read_b128 v[128:131], v3 offset:32
    ds_read_b128 v[132:135], v3 offset:4640
    ds_read_b128 v[136:139], v4 offset:32
    ds_read_b128 v[140:143], v4 offset:9248
    s_waitcnt lgkmcnt(4)
    v_mfma_f32_32x32x16_bf16 v[64:79], v[56:59], v[48:51], v[64:79]
    v_mfma_f32_32x32x16_bf16 v[80:95], v[60:63], v[48:51], v[80:95]
    v_mfma_f32_32x32x16_bf16 v[96:111], v[56:59], v[52:55], v[96:111]
    v_mfma_f32_32x32x16_bf16 v[112:127], v[60:63], v[52:55], v[112:127]
    ds_read_b128 v[48:51], v3 offset:64
    ds_read_b128 v[52:55], v3 offset:4672
    ds_read_b128 v[56:59], v4 offset:64
    ds_read_b128 v[60:63], v4 offset:9280
    s_waitcnt lgkmcnt(4)
    v_mfma_f32_32x32x16_bf16 v[64:79], v[136:139], v[128:131], v[64:79]
    v_mfma_f32_32x32x16_bf16 v[80:95], v[140:143], v[128:131], v[80:95]
    v_mfma_f32_32x32x16_bf16 v[96:111], v[136:139], v[132:135], v[96:111]
    v_mfma_f32_32x32x16_bf16 v[112:127], v[140:143], v[132:135], v[112:127]
    ds_read_b128 v[128:131], v3 offset:96
    ds_read_b128 v[132:135], v3 offset:4704
    ds_read_b128 v[136:139], v4 offset:96
    ds_read_b128 v[140:143], v4 offset:9312
    s_waitcnt lgkmcnt(4)
    v_mfma_f32_32x32x16_bf16 v[64:79], v[56:59], v[48:51], v[64:79]
    v_mfma_f32_32x32x16_bf16 v[80:95], v[60:63], v[48:51], v[80:95]
    v_mfma_f32_32x32x16_bf16 v[96:111], v[56:59], v[52:55], v[96:111]
    v_mfma_f32_32x32x16_bf16 v[112:127], v[60:63], v[52:55], v[112:127]
    s_waitcnt lgkmcnt(0)
    s_waitcnt vmcnt(0)
    v_mfma_f32_32x32x16_bf16 v[64:79], v[136:139], v[128:131], v[64:79]
    ds_write_b128 v10, v[16:19] offset:0
    ds_write_b128 v10, v[20:23] offset:4608
    v_mfma_f32_32x32x16_bf16 v[80:95], v[140:143], v[128:131], v[80:95]
    ds_write_b128 v10, v[24:27] offset:9216
    ds_write_b128 v10, v[28:31] offset:13824
    v_mfma_f32_32x32x16_bf16 v[96:111], v[136:139], v[132:135], v[96:111]
    ds_write_b128 v10, v[32:35] offset:18432
    ds_write_b128 v10, v[36:39] offset:23040
    v_mfma_f32_32x32x16_bf16 v[112:127], v[140:143], v[132:135], v[112:127]
    ds_write_b128 v10, v[40:43] offset:27648
    ds_write_b128 v10, v[44:47] offset:32256
    s_waitcnt lgkmcnt(0)
    s_barrier
    ds_read_b128 v[48:51], v11 offset:0
    ds_read_b128 v[52:55], v11 offset:4608
    ds_read_b128 v[56:59], v12 offset:0
    ds_read_b128 v[60:63], v12 offset:9216
    ds_read_b128 v[128:131], v11 offset:32
    ds_read_b128 v[132:135], v11 offset:4640
    ds_read_b128 v[136:139], v12 offset:32
    ds_read_b128 v[140:143], v12 offset:9248
    s_waitcnt lgkmcnt(4)
    v_mfma_f32_32x32x16_bf16 v[64:79], v[56:59], v[48:51], v[64:79]
    v_mfma_f32_32x32x16_bf16 v[80:95], v[60:63], v[48:51], v[80:95]
    v_mfma_f32_32x32x16_bf16 v[96:111], v[56:59], v[52:55], v[96:111]
    v_mfma_f32_32x32x16_bf16 v[112:127], v[60:63], v[52:55], v[112:127]
    ds_read_b128 v[48:51], v11 offset:64
    ds_read_b128 v[52:55], v11 offset:4672
    ds_read_b128 v[56:59], v12 offset:64
    ds_read_b128 v[60:63], v12 offset:9280
    s_waitcnt lgkmcnt(4)
    v_mfma_f32_32x32x16_bf16 v[64:79], v[136:139], v[128:131], v[64:79]
    v_mfma_f32_32x32x16_bf16 v[80:95], v[140:143], v[128:131], v[80:95]
    v_mfma_f32_32x32x16_bf16 v[96:111], v[136:139], v[132:135], v[96:111]
    v_mfma_f32_32x32x16_bf16 v[112:127], v[140:143], v[132:135], v[112:127]
    ds_read_b128 v[128:131], v11 offset:96
    ds_read_b128 v[132:135], v11 offset:4704
    ds_read_b128 v[136:139], v12 offset:96
    ds_read_b128 v[140:143], v12 offset:9312
    s_waitcnt lgkmcnt(4)
    v_mfma_f32_32x32x16_bf16 v[64:79], v[56:59], v[48:51], v[64:79]
    v_mfma_f32_32x32x16_bf16 v[80:95], v[60:63], v[48:51], v[80:95]
    v_mfma_f32_32x32x16_bf16 v[96:111], v[56:59], v[52:55], v[96:111]
    v_mfma_f32_32x32x16_bf16 v[112:127], v[60:63], v[52:55], v[112:127]
    s_waitcnt lgkmcnt(0)
    v_mfma_f32_32x32x16_bf16 v[64:79], v[136:139], v[128:131], v[64:79]
    v_mfma_f32_32x32x16_bf16 v[80:95], v[140:143], v[128:131], v[80:95]
    v_mfma_f32_32x32x16_bf16 v[96:111], v[136:139], v[132:135], v[96:111]
    v_mfma_f32_32x32x16_bf16 v[112:127], v[140:143], v[132:135], v[112:127]
    s_nop 7
    s_nop 7
    v_lshrrev_b32 v5, 6, v0
    v_and_b32 v6, 31, v0
    v_lshrrev_b32 v7, 5, v0
    v_and_b32 v7, 1, v7
    v_lshrrev_b32 v8, 1, v5
    v_and_b32 v9, 1, v5
    v_lshl_add_u32 v8, v8, 6, v6
    s_mov_b32 s3, 18874368
    s_add_u32 s8, s4, s3
    s_addc_u32 s9, s5, 0
    s_mov_b32 s10, 7077888
    s_mov_b32 s11, 0x00020000
    s_mov_b32 s19, 3456
    v_mul_lo_u32 v8, v8, s19
    v_lshl_add_u32 v9, v9, 0, v9
    v_and_b32 v9, 1, v5
    v_lshlrev_b32 v9, 6, v9
    v_lshl_add_u32 v9, v7, 3, v9
    v_add_u32 v8, v8, v9
    s_mul_i32 s16, s20, 442368
    s_lshl_b32 s17, s21, 7
    s_add_u32 s16, s16, s17
    v_cvt_pk_bf16_f32 v64, v64, v64
    v_lshlrev_b32 v64, 16, v64
    v_cvt_pk_bf16_f32 v80, v80, v80
    v_lshlrev_b32 v80, 16, v80
    v_mul_f32 v12, 0xbfb8aa3b, v64
    v_exp_f32 v12, v12
    s_nop 0
    v_add_f32 v12, 1.0, v12
    v_rcp_f32 v12, v12
    s_nop 0
    v_mul_f32 v12, v64, v12
    v_cvt_pk_bf16_f32 v12, v12, v12
    v_lshlrev_b32 v12, 16, v12
    v_mul_f32 v12, v12, v80
    v_cvt_pk_bf16_f32 v65, v65, v65
    v_lshlrev_b32 v65, 16, v65
    v_cvt_pk_bf16_f32 v81, v81, v81
    v_lshlrev_b32 v81, 16, v81
    v_mul_f32 v13, 0xbfb8aa3b, v65
    v_exp_f32 v13, v13
    s_nop 0
    v_add_f32 v13, 1.0, v13
    v_rcp_f32 v13, v13
    s_nop 0
    v_mul_f32 v13, v65, v13
    v_cvt_pk_bf16_f32 v13, v13, v13
    v_lshlrev_b32 v13, 16, v13
    v_mul_f32 v13, v13, v81
    v_cvt_pk_bf16_f32 v66, v66, v66
    v_lshlrev_b32 v66, 16, v66
    v_cvt_pk_bf16_f32 v82, v82, v82
    v_lshlrev_b32 v82, 16, v82
    v_mul_f32 v14, 0xbfb8aa3b, v66
    v_exp_f32 v14, v14
    s_nop 0
    v_add_f32 v14, 1.0, v14
    v_rcp_f32 v14, v14
    s_nop 0
    v_mul_f32 v14, v66, v14
    v_cvt_pk_bf16_f32 v14, v14, v14
    v_lshlrev_b32 v14, 16, v14
    v_mul_f32 v14, v14, v82
    v_cvt_pk_bf16_f32 v67, v67, v67
    v_lshlrev_b32 v67, 16, v67
    v_cvt_pk_bf16_f32 v83, v83, v83
    v_lshlrev_b32 v83, 16, v83
    v_mul_f32 v15, 0xbfb8aa3b, v67
    v_exp_f32 v15, v15
    s_nop 0
    v_add_f32 v15, 1.0, v15
    v_rcp_f32 v15, v15
    s_nop 0
    v_mul_f32 v15, v67, v15
    v_cvt_pk_bf16_f32 v15, v15, v15
    v_lshlrev_b32 v15, 16, v15
    v_mul_f32 v15, v15, v83
    v_cvt_pk_bf16_f32 v16, v12, v13
    v_cvt_pk_bf16_f32 v17, v14, v15
    s_add_u32 s17, s16, 0
    buffer_store_dwordx2 v[16:17], v8, s[8:11], s17 offen
    s_nop 0
    v_cvt_pk_bf16_f32 v68, v68, v68
    v_lshlrev_b32 v68, 16, v68
    v_cvt_pk_bf16_f32 v84, v84, v84
    v_lshlrev_b32 v84, 16, v84
    v_mul_f32 v12, 0xbfb8aa3b, v68
    v_exp_f32 v12, v12
    s_nop 0
    v_add_f32 v12, 1.0, v12
    v_rcp_f32 v12, v12
    s_nop 0
    v_mul_f32 v12, v68, v12
    v_cvt_pk_bf16_f32 v12, v12, v12
    v_lshlrev_b32 v12, 16, v12
    v_mul_f32 v12, v12, v84
    v_cvt_pk_bf16_f32 v69, v69, v69
    v_lshlrev_b32 v69, 16, v69
    v_cvt_pk_bf16_f32 v85, v85, v85
    v_lshlrev_b32 v85, 16, v85
    v_mul_f32 v13, 0xbfb8aa3b, v69
    v_exp_f32 v13, v13
    s_nop 0
    v_add_f32 v13, 1.0, v13
    v_rcp_f32 v13, v13
    s_nop 0
    v_mul_f32 v13, v69, v13
    v_cvt_pk_bf16_f32 v13, v13, v13
    v_lshlrev_b32 v13, 16, v13
    v_mul_f32 v13, v13, v85
    v_cvt_pk_bf16_f32 v70, v70, v70
    v_lshlrev_b32 v70, 16, v70
    v_cvt_pk_bf16_f32 v86, v86, v86
    v_lshlrev_b32 v86, 16, v86
    v_mul_f32 v14, 0xbfb8aa3b, v70
    v_exp_f32 v14, v14
    s_nop 0
    v_add_f32 v14, 1.0, v14
    v_rcp_f32 v14, v14
    s_nop 0
    v_mul_f32 v14, v70, v14
    v_cvt_pk_bf16_f32 v14, v14, v14
    v_lshlrev_b32 v14, 16, v14
    v_mul_f32 v14, v14, v86
    v_cvt_pk_bf16_f32 v71, v71, v71
    v_lshlrev_b32 v71, 16, v71
    v_cvt_pk_bf16_f32 v87, v87, v87
    v_lshlrev_b32 v87, 16, v87
    v_mul_f32 v15, 0xbfb8aa3b, v71
    v_exp_f32 v15, v15
    s_nop 0
    v_add_f32 v15, 1.0, v15
    v_rcp_f32 v15, v15
    s_nop 0
    v_mul_f32 v15, v71, v15
    v_cvt_pk_bf16_f32 v15, v15, v15
    v_lshlrev_b32 v15, 16, v15
    v_mul_f32 v15, v15, v87
    v_cvt_pk_bf16_f32 v16, v12, v13
    v_cvt_pk_bf16_f32 v17, v14, v15
    s_add_u32 s17, s16, 16
    buffer_store_dwordx2 v[16:17], v8, s[8:11], s17 offen
    s_nop 0
    v_cvt_pk_bf16_f32 v72, v72, v72
    v_lshlrev_b32 v72, 16, v72
    v_cvt_pk_bf16_f32 v88, v88, v88
    v_lshlrev_b32 v88, 16, v88
    v_mul_f32 v12, 0xbfb8aa3b, v72
    v_exp_f32 v12, v12
    s_nop 0
    v_add_f32 v12, 1.0, v12
    v_rcp_f32 v12, v12
    s_nop 0
    v_mul_f32 v12, v72, v12
    v_cvt_pk_bf16_f32 v12, v12, v12
    v_lshlrev_b32 v12, 16, v12
    v_mul_f32 v12, v12, v88
    v_cvt_pk_bf16_f32 v73, v73, v73
    v_lshlrev_b32 v73, 16, v73
    v_cvt_pk_bf16_f32 v89, v89, v89
    v_lshlrev_b32 v89, 16, v89
    v_mul_f32 v13, 0xbfb8aa3b, v73
    v_exp_f32 v13, v13
    s_nop 0
    v_add_f32 v13, 1.0, v13
    v_rcp_f32 v13, v13
    s_nop 0
    v_mul_f32 v13, v73, v13
    v_cvt_pk_bf16_f32 v13, v13, v13
    v_lshlrev_b32 v13, 16, v13
    v_mul_f32 v13, v13, v89
    v_cvt_pk_bf16_f32 v74, v74, v74
    v_lshlrev_b32 v74, 16, v74
    v_cvt_pk_bf16_f32 v90, v90, v90
    v_lshlrev_b32 v90, 16, v90
    v_mul_f32 v14, 0xbfb8aa3b, v74
    v_exp_f32 v14, v14
    s_nop 0
    v_add_f32 v14, 1.0, v14
    v_rcp_f32 v14, v14
    s_nop 0
    v_mul_f32 v14, v74, v14
    v_cvt_pk_bf16_f32 v14, v14, v14
    v_lshlrev_b32 v14, 16, v14
    v_mul_f32 v14, v14, v90
    v_cvt_pk_bf16_f32 v75, v75, v75
    v_lshlrev_b32 v75, 16, v75
    v_cvt_pk_bf16_f32 v91, v91, v91
    v_lshlrev_b32 v91, 16, v91
    v_mul_f32 v15, 0xbfb8aa3b, v75
    v_exp_f32 v15, v15
    s_nop 0
    v_add_f32 v15, 1.0, v15
    v_rcp_f32 v15, v15
    s_nop 0
    v_mul_f32 v15, v75, v15
    v_cvt_pk_bf16_f32 v15, v15, v15
    v_lshlrev_b32 v15, 16, v15
    v_mul_f32 v15, v15, v91
    v_cvt_pk_bf16_f32 v16, v12, v13
    v_cvt_pk_bf16_f32 v17, v14, v15
    s_add_u32 s17, s16, 32
    buffer_store_dwordx2 v[16:17], v8, s[8:11], s17 offen
    s_nop 0
    v_cvt_pk_bf16_f32 v76, v76, v76
    v_lshlrev_b32 v76, 16, v76
    v_cvt_pk_bf16_f32 v92, v92, v92
    v_lshlrev_b32 v92, 16, v92
    v_mul_f32 v12, 0xbfb8aa3b, v76
    v_exp_f32 v12, v12
    s_nop 0
    v_add_f32 v12, 1.0, v12
    v_rcp_f32 v12, v12
    s_nop 0
    v_mul_f32 v12, v76, v12
    v_cvt_pk_bf16_f32 v12, v12, v12
    v_lshlrev_b32 v12, 16, v12
    v_mul_f32 v12, v12, v92
    v_cvt_pk_bf16_f32 v77, v77, v77
    v_lshlrev_b32 v77, 16, v77
    v_cvt_pk_bf16_f32 v93, v93, v93
    v_lshlrev_b32 v93, 16, v93
    v_mul_f32 v13, 0xbfb8aa3b, v77
    v_exp_f32 v13, v13
    s_nop 0
    v_add_f32 v13, 1.0, v13
    v_rcp_f32 v13, v13
    s_nop 0
    v_mul_f32 v13, v77, v13
    v_cvt_pk_bf16_f32 v13, v13, v13
    v_lshlrev_b32 v13, 16, v13
    v_mul_f32 v13, v13, v93
    v_cvt_pk_bf16_f32 v78, v78, v78
    v_lshlrev_b32 v78, 16, v78
    v_cvt_pk_bf16_f32 v94, v94, v94
    v_lshlrev_b32 v94, 16, v94
    v_mul_f32 v14, 0xbfb8aa3b, v78
    v_exp_f32 v14, v14
    s_nop 0
    v_add_f32 v14, 1.0, v14
    v_rcp_f32 v14, v14
    s_nop 0
    v_mul_f32 v14, v78, v14
    v_cvt_pk_bf16_f32 v14, v14, v14
    v_lshlrev_b32 v14, 16, v14
    v_mul_f32 v14, v14, v94
    v_cvt_pk_bf16_f32 v79, v79, v79
    v_lshlrev_b32 v79, 16, v79
    v_cvt_pk_bf16_f32 v95, v95, v95
    v_lshlrev_b32 v95, 16, v95
    v_mul_f32 v15, 0xbfb8aa3b, v79
    v_exp_f32 v15, v15
    s_nop 0
    v_add_f32 v15, 1.0, v15
    v_rcp_f32 v15, v15
    s_nop 0
    v_mul_f32 v15, v79, v15
    v_cvt_pk_bf16_f32 v15, v15, v15
    v_lshlrev_b32 v15, 16, v15
    v_mul_f32 v15, v15, v95
    v_cvt_pk_bf16_f32 v16, v12, v13
    v_cvt_pk_bf16_f32 v17, v14, v15
    s_add_u32 s17, s16, 48
    buffer_store_dwordx2 v[16:17], v8, s[8:11], s17 offen
    s_nop 0
    v_cvt_pk_bf16_f32 v96, v96, v96
    v_lshlrev_b32 v96, 16, v96
    v_cvt_pk_bf16_f32 v112, v112, v112
    v_lshlrev_b32 v112, 16, v112
    v_mul_f32 v12, 0xbfb8aa3b, v96
    v_exp_f32 v12, v12
    s_nop 0
    v_add_f32 v12, 1.0, v12
    v_rcp_f32 v12, v12
    s_nop 0
    v_mul_f32 v12, v96, v12
    v_cvt_pk_bf16_f32 v12, v12, v12
    v_lshlrev_b32 v12, 16, v12
    v_mul_f32 v12, v12, v112
    v_cvt_pk_bf16_f32 v97, v97, v97
    v_lshlrev_b32 v97, 16, v97
    v_cvt_pk_bf16_f32 v113, v113, v113
    v_lshlrev_b32 v113, 16, v113
    v_mul_f32 v13, 0xbfb8aa3b, v97
    v_exp_f32 v13, v13
    s_nop 0
    v_add_f32 v13, 1.0, v13
    v_rcp_f32 v13, v13
    s_nop 0
    v_mul_f32 v13, v97, v13
    v_cvt_pk_bf16_f32 v13, v13, v13
    v_lshlrev_b32 v13, 16, v13
    v_mul_f32 v13, v13, v113
    v_cvt_pk_bf16_f32 v98, v98, v98
    v_lshlrev_b32 v98, 16, v98
    v_cvt_pk_bf16_f32 v114, v114, v114
    v_lshlrev_b32 v114, 16, v114
    v_mul_f32 v14, 0xbfb8aa3b, v98
    v_exp_f32 v14, v14
    s_nop 0
    v_add_f32 v14, 1.0, v14
    v_rcp_f32 v14, v14
    s_nop 0
    v_mul_f32 v14, v98, v14
    v_cvt_pk_bf16_f32 v14, v14, v14
    v_lshlrev_b32 v14, 16, v14
    v_mul_f32 v14, v14, v114
    v_cvt_pk_bf16_f32 v99, v99, v99
    v_lshlrev_b32 v99, 16, v99
    v_cvt_pk_bf16_f32 v115, v115, v115
    v_lshlrev_b32 v115, 16, v115
    v_mul_f32 v15, 0xbfb8aa3b, v99
    v_exp_f32 v15, v15
    s_nop 0
    v_add_f32 v15, 1.0, v15
    v_rcp_f32 v15, v15
    s_nop 0
    v_mul_f32 v15, v99, v15
    v_cvt_pk_bf16_f32 v15, v15, v15
    v_lshlrev_b32 v15, 16, v15
    v_mul_f32 v15, v15, v115
    v_cvt_pk_bf16_f32 v16, v12, v13
    v_cvt_pk_bf16_f32 v17, v14, v15
    s_add_u32 s17, s16, 110592
    buffer_store_dwordx2 v[16:17], v8, s[8:11], s17 offen
    s_nop 0
    v_cvt_pk_bf16_f32 v100, v100, v100
    v_lshlrev_b32 v100, 16, v100
    v_cvt_pk_bf16_f32 v116, v116, v116
    v_lshlrev_b32 v116, 16, v116
    v_mul_f32 v12, 0xbfb8aa3b, v100
    v_exp_f32 v12, v12
    s_nop 0
    v_add_f32 v12, 1.0, v12
    v_rcp_f32 v12, v12
    s_nop 0
    v_mul_f32 v12, v100, v12
    v_cvt_pk_bf16_f32 v12, v12, v12
    v_lshlrev_b32 v12, 16, v12
    v_mul_f32 v12, v12, v116
    v_cvt_pk_bf16_f32 v101, v101, v101
    v_lshlrev_b32 v101, 16, v101
    v_cvt_pk_bf16_f32 v117, v117, v117
    v_lshlrev_b32 v117, 16, v117
    v_mul_f32 v13, 0xbfb8aa3b, v101
    v_exp_f32 v13, v13
    s_nop 0
    v_add_f32 v13, 1.0, v13
    v_rcp_f32 v13, v13
    s_nop 0
    v_mul_f32 v13, v101, v13
    v_cvt_pk_bf16_f32 v13, v13, v13
    v_lshlrev_b32 v13, 16, v13
    v_mul_f32 v13, v13, v117
    v_cvt_pk_bf16_f32 v102, v102, v102
    v_lshlrev_b32 v102, 16, v102
    v_cvt_pk_bf16_f32 v118, v118, v118
    v_lshlrev_b32 v118, 16, v118
    v_mul_f32 v14, 0xbfb8aa3b, v102
    v_exp_f32 v14, v14
    s_nop 0
    v_add_f32 v14, 1.0, v14
    v_rcp_f32 v14, v14
    s_nop 0
    v_mul_f32 v14, v102, v14
    v_cvt_pk_bf16_f32 v14, v14, v14
    v_lshlrev_b32 v14, 16, v14
    v_mul_f32 v14, v14, v118
    v_cvt_pk_bf16_f32 v103, v103, v103
    v_lshlrev_b32 v103, 16, v103
    v_cvt_pk_bf16_f32 v119, v119, v119
    v_lshlrev_b32 v119, 16, v119
    v_mul_f32 v15, 0xbfb8aa3b, v103
    v_exp_f32 v15, v15
    s_nop 0
    v_add_f32 v15, 1.0, v15
    v_rcp_f32 v15, v15
    s_nop 0
    v_mul_f32 v15, v103, v15
    v_cvt_pk_bf16_f32 v15, v15, v15
    v_lshlrev_b32 v15, 16, v15
    v_mul_f32 v15, v15, v119
    v_cvt_pk_bf16_f32 v16, v12, v13
    v_cvt_pk_bf16_f32 v17, v14, v15
    s_add_u32 s17, s16, 110608
    buffer_store_dwordx2 v[16:17], v8, s[8:11], s17 offen
    s_nop 0
    v_cvt_pk_bf16_f32 v104, v104, v104
    v_lshlrev_b32 v104, 16, v104
    v_cvt_pk_bf16_f32 v120, v120, v120
    v_lshlrev_b32 v120, 16, v120
    v_mul_f32 v12, 0xbfb8aa3b, v104
    v_exp_f32 v12, v12
    s_nop 0
    v_add_f32 v12, 1.0, v12
    v_rcp_f32 v12, v12
    s_nop 0
    v_mul_f32 v12, v104, v12
    v_cvt_pk_bf16_f32 v12, v12, v12
    v_lshlrev_b32 v12, 16, v12
    v_mul_f32 v12, v12, v120
    v_cvt_pk_bf16_f32 v105, v105, v105
    v_lshlrev_b32 v105, 16, v105
    v_cvt_pk_bf16_f32 v121, v121, v121
    v_lshlrev_b32 v121, 16, v121
    v_mul_f32 v13, 0xbfb8aa3b, v105
    v_exp_f32 v13, v13
    s_nop 0
    v_add_f32 v13, 1.0, v13
    v_rcp_f32 v13, v13
    s_nop 0
    v_mul_f32 v13, v105, v13
    v_cvt_pk_bf16_f32 v13, v13, v13
    v_lshlrev_b32 v13, 16, v13
    v_mul_f32 v13, v13, v121
    v_cvt_pk_bf16_f32 v106, v106, v106
    v_lshlrev_b32 v106, 16, v106
    v_cvt_pk_bf16_f32 v122, v122, v122
    v_lshlrev_b32 v122, 16, v122
    v_mul_f32 v14, 0xbfb8aa3b, v106
    v_exp_f32 v14, v14
    s_nop 0
    v_add_f32 v14, 1.0, v14
    v_rcp_f32 v14, v14
    s_nop 0
    v_mul_f32 v14, v106, v14
    v_cvt_pk_bf16_f32 v14, v14, v14
    v_lshlrev_b32 v14, 16, v14
    v_mul_f32 v14, v14, v122
    v_cvt_pk_bf16_f32 v107, v107, v107
    v_lshlrev_b32 v107, 16, v107
    v_cvt_pk_bf16_f32 v123, v123, v123
    v_lshlrev_b32 v123, 16, v123
    v_mul_f32 v15, 0xbfb8aa3b, v107
    v_exp_f32 v15, v15
    s_nop 0
    v_add_f32 v15, 1.0, v15
    v_rcp_f32 v15, v15
    s_nop 0
    v_mul_f32 v15, v107, v15
    v_cvt_pk_bf16_f32 v15, v15, v15
    v_lshlrev_b32 v15, 16, v15
    v_mul_f32 v15, v15, v123
    v_cvt_pk_bf16_f32 v16, v12, v13
    v_cvt_pk_bf16_f32 v17, v14, v15
    s_add_u32 s17, s16, 110624
    buffer_store_dwordx2 v[16:17], v8, s[8:11], s17 offen
    s_nop 0
    v_cvt_pk_bf16_f32 v108, v108, v108
    v_lshlrev_b32 v108, 16, v108
    v_cvt_pk_bf16_f32 v124, v124, v124
    v_lshlrev_b32 v124, 16, v124
    v_mul_f32 v12, 0xbfb8aa3b, v108
    v_exp_f32 v12, v12
    s_nop 0
    v_add_f32 v12, 1.0, v12
    v_rcp_f32 v12, v12
    s_nop 0
    v_mul_f32 v12, v108, v12
    v_cvt_pk_bf16_f32 v12, v12, v12
    v_lshlrev_b32 v12, 16, v12
    v_mul_f32 v12, v12, v124
    v_cvt_pk_bf16_f32 v109, v109, v109
    v_lshlrev_b32 v109, 16, v109
    v_cvt_pk_bf16_f32 v125, v125, v125
    v_lshlrev_b32 v125, 16, v125
    v_mul_f32 v13, 0xbfb8aa3b, v109
    v_exp_f32 v13, v13
    s_nop 0
    v_add_f32 v13, 1.0, v13
    v_rcp_f32 v13, v13
    s_nop 0
    v_mul_f32 v13, v109, v13
    v_cvt_pk_bf16_f32 v13, v13, v13
    v_lshlrev_b32 v13, 16, v13
    v_mul_f32 v13, v13, v125
    v_cvt_pk_bf16_f32 v110, v110, v110
    v_lshlrev_b32 v110, 16, v110
    v_cvt_pk_bf16_f32 v126, v126, v126
    v_lshlrev_b32 v126, 16, v126
    v_mul_f32 v14, 0xbfb8aa3b, v110
    v_exp_f32 v14, v14
    s_nop 0
    v_add_f32 v14, 1.0, v14
    v_rcp_f32 v14, v14
    s_nop 0
    v_mul_f32 v14, v110, v14
    v_cvt_pk_bf16_f32 v14, v14, v14
    v_lshlrev_b32 v14, 16, v14
    v_mul_f32 v14, v14, v126
    v_cvt_pk_bf16_f32 v111, v111, v111
    v_lshlrev_b32 v111, 16, v111
    v_cvt_pk_bf16_f32 v127, v127, v127
    v_lshlrev_b32 v127, 16, v127
    v_mul_f32 v15, 0xbfb8aa3b, v111
    v_exp_f32 v15, v15
    s_nop 0
    v_add_f32 v15, 1.0, v15
    v_rcp_f32 v15, v15
    s_nop 0
    v_mul_f32 v15, v111, v15
    v_cvt_pk_bf16_f32 v15, v15, v15
    v_lshlrev_b32 v15, 16, v15
    v_mul_f32 v15, v15, v127
    v_cvt_pk_bf16_f32 v16, v12, v13
    v_cvt_pk_bf16_f32 v17, v14, v15
    s_add_u32 s17, s16, 110640
    buffer_store_dwordx2 v[16:17], v8, s[8:11], s17 offen
    s_nop 0
.Lg1b_kernel_end:
    s_endpgm
.globl g2b_kernel
.p2align 8
.type g2b_kernel,@function
g2b_kernel:
    s_cmp_ge_u32 s2, 240
    s_cbranch_scc1 .Lg2b_kernel_end
    s_load_dwordx2 s[4:5], s[0:1], 72
    s_and_b32 s18, s2, 7
    s_mul_i32 s18, s18, 30
    s_lshr_b32 s19, s2, 3
    s_add_u32 s18, s18, s19
    s_mul_i32 s20, s18, 4370
    s_lshr_b32 s20, s20, 16
    s_mul_i32 s21, s20, 15
    s_sub_u32 s21, s18, s21
    s_mul_i32 s22, s21, 21846
    s_lshr_b32 s22, s22, 16
    s_mul_i32 s23, s22, 3
    s_sub_u32 s23, s21, s23
    s_mov_b32 s21, s22
    s_waitcnt lgkmcnt(0)
    s_mov_b32 s3, 18874368
    s_add_u32 s8, s4, s3
    s_addc_u32 s9, s5, 0
    s_mov_b32 s10, 7077888
    s_mov_b32 s11, 0x00020000
    s_mov_b32 s3, 49283072
    s_add_u32 s12, s4, s3
    s_addc_u32 s13, s5, 0
    s_mov_b32 s14, 2211840
    s_mov_b32 s15, 0x00020000
    s_mul_i32 s16, s20, 442368
    s_mul_i32 s17, s21, 442368
    s_mul_i32 s18, s23, 1152
    s_add_u32 s16, s16, s18
    s_add_u32 s17, s17, s18
    v_lshrrev_b32 v5, 3, v0
    v_and_b32 v6, 7, v0
    s_mov_b32 s19, 3456
    v_mul_lo_u32 v1, v5, s19
    v_lshl_add_u32 v1, v6, 4, v1
    v_mul_u32_u24 v2, 144, v5
    v_lshl_add_u32 v2, v6, 4, v2
    v_lshrrev_b32 v5, 6, v0
    v_and_b32 v6, 31, v0
    v_lshrrev_b32 v7, 5, v0
    v_and_b32 v7, 1, v7
    v_lshrrev_b32 v8, 1, v5
    v_and_b32 v9, 1, v5
    v_lshl_add_u32 v8, v8, 6, v6
    v_mul_u32_u24 v3, 144, v8
    v_lshl_add_u32 v3, v7, 4, v3
    v_lshl_add_u32 v9, v9, 5, v6
    v_mul_u32_u24 v4, 144, v9
    v_lshl_add_u32 v4, v7, 4, v4
    v_add_u32 v4, 18432, v4
    v_add_u32 v10, 36864, v2
    v_add_u32 v11, 36864, v3
    v_add_u32 v12, 36864, v4
    v_mov_b32 v64, 0
    v_mov_b32 v65, 0
    v_mov_b32 v66, 0
    v_mov_b32 v67, 0
    v_mov_b32 v68, 0
    v_mov_b32 v69, 0
    v_mov_b32 v70, 0
    v_mov_b32 v71, 0
    v_mov_b32 v72, 0
    v_mov_b32 v73, 0
    v_mov_b32 v74, 0
    v_mov_b32 v75, 0
    v_mov_b32 v76, 0
    v_mov_b32 v77, 0
    v_mov_b32 v78, 0
    v_mov_b32 v79, 0
    v_mov_b32 v80, 0
    v_mov_b32 v81, 0
    v_mov_b32 v82, 0
    v_mov_b32 v83, 0
    v_mov_b32 v84, 0
    v_mov_b32 v85, 0
    v_mov_b32 v86, 0
    v_mov_b32 v87, 0
    v_mov_b32 v88, 0
    v_mov_b32 v89, 0
    v_mov_b32 v90, 0
    v_mov_b32 v91, 0
    v_mov_b32 v92, 0
    v_mov_b32 v93, 0
    v_mov_b32 v94, 0
    v_mov_b32 v95, 0
    v_mov_b32 v96, 0
    v_mov_b32 v97, 0
    v_mov_b32 v98, 0
    v_mov_b32 v99, 0
    v_mov_b32 v100, 0
    v_mov_b32 v101, 0
    v_mov_b32 v102, 0
    v_mov_b32 v103, 0
    v_mov_b32 v104, 0
    v_mov_b32 v105, 0
    v_mov_b32 v106, 0
    v_mov_b32 v107, 0
    v_mov_b32 v108, 0
    v_mov_b32 v109, 0
    v_mov_b32 v110, 0
    v_mov_b32 v111, 0
    v_mov_b32 v112, 0
    v_mov_b32 v113, 0
    v_mov_b32 v114, 0
    v_mov_b32 v115, 0
    v_mov_b32 v116, 0
    v_mov_b32 v117, 0
    v_mov_b32 v118, 0
    v_mov_b32 v119, 0
    v_mov_b32 v120, 0
    v_mov_b32 v121, 0
    v_mov_b32 v122, 0
    v_mov_b32 v123, 0
    v_mov_b32 v124, 0
    v_mov_b32 v125, 0
    v_mov_b32 v126, 0
    v_mov_b32 v127, 0
    s_add_u32 s25, s16, 110592
    s_add_u32 s28, s17, 110592
    s_add_u32 s26, s16, 221184
    s_add_u32 s29, s17, 221184
    s_add_u32 s27, s16, 331776
    s_add_u32 s30, s17, 331776
    buffer_load_dwordx4 v[16:19], v1, s[8:11], s16 offen offset:0
    buffer_load_dwordx4 v[20:23], v1, s[8:11], s25 offen
    buffer_load_dwordx4 v[24:27], v1, s[8:11], s26 offen
    buffer_load_dwordx4 v[28:31], v1, s[8:11], s27 offen
    buffer_load_dwordx4 v[32:35], v1, s[12:15], s17 offen
    buffer_load_dwordx4 v[36:39], v1, s[12:15], s28 offen
    buffer_load_dwordx4 v[40:43], v1, s[12:15], s29 offen
    buffer_load_dwordx4 v[44:47], v1, s[12:15], s30 offen
    s_waitcnt vmcnt(0)
    ds_write_b128 v2, v[16:19] offset:0
    ds_write_b128 v2, v[20:23] offset:4608
    ds_write_b128 v2, v[24:27] offset:9216
    ds_write_b128 v2, v[28:31] offset:13824
    ds_write_b128 v2, v[32:35] offset:18432
    ds_write_b128 v2, v[36:39] offset:23040
    ds_write_b128 v2, v[40:43] offset:27648
    ds_write_b128 v2, v[44:47] offset:32256
    s_waitcnt lgkmcnt(0)
    s_barrier
    s_add_u32 s16, s16, 128
    s_add_u32 s17, s17, 128
    s_add_u32 s25, s16, 110592
    s_add_u32 s28, s17, 110592
    s_add_u32 s26, s16, 221184
    s_add_u32 s29, s17, 221184
    s_add_u32 s27, s16, 331776
    s_add_u32 s30, s17, 331776
    buffer_load_dwordx4 v[16:19], v1, s[8:11], s16 offen offset:0
    buffer_load_dwordx4 v[20:23], v1, s[8:11], s25 offen
    buffer_load_dwordx4 v[24:27], v1, s[8:11], s26 offen
    buffer_load_dwordx4 v[28:31], v1, s[8:11], s27 offen
    buffer_load_dwordx4 v[32:35], v1, s[12:15], s17 offen
    buffer_load_dwordx4 v[36:39], v1, s[12:15], s28 offen
    buffer_load_dwordx4 v[40:43], v1, s[12:15], s29 offen
    buffer_load_dwordx4 v[44:47], v1, s[12:15], s30 offen
    ds_read_b128 v[48:51], v3 offset:0
    ds_read_b128 v[52:55], v3 offset:4608
    ds_read_b128 v[56:59], v4 offset:0
    ds_read_b128 v[60:63], v4 offset:9216
    ds_read_b128 v[128:131], v3 offset:32
    ds_read_b128 v[132:135], v3 offset:4640
    ds_read_b128 v[136:139], v4 offset:32
    ds_read_b128 v[140:143], v4 offset:9248
    s_waitcnt lgkmcnt(4)
    v_mfma_f32_32x32x16_bf16 v[64:79], v[56:59], v[48:51], v[64:79]
    v_mfma_f32_32x32x16_bf16 v[80:95], v[60:63], v[48:51], v[80:95]
    v_mfma_f32_32x32x16_bf16 v[96:111], v[56:59], v[52:55], v[96:111]
    v_mfma_f32_32x32x16_bf16 v[112:127], v[60:63], v[52:55], v[112:127]
    ds_read_b128 v[48:51], v3 offset:64
    ds_read_b128 v[52:55], v3 offset:4672
    ds_read_b128 v[56:59], v4 offset:64
    ds_read_b128 v[60:63], v4 offset:9280
    s_waitcnt lgkmcnt(4)
    v_mfma_f32_32x32x16_bf16 v[64:79], v[136:139], v[128:131], v[64:79]
    v_mfma_f32_32x32x16_bf16 v[80:95], v[140:143], v[128:131], v[80:95]
    v_mfma_f32_32x32x16_bf16 v[96:111], v[136:139], v[132:135], v[96:111]
    v_mfma_f32_32x32x16_bf16 v[112:127], v[140:143], v[132:135], v[112:127]
    ds_read_b128 v[128:131], v3 offset:96
    ds_read_b128 v[132:135], v3 offset:4704
    ds_read_b128 v[136:139], v4 offset:96
    ds_read_b128 v[140:143], v4 offset:9312
    s_waitcnt lgkmcnt(4)
    v_mfma_f32_32x32x16_bf16 v[64:79], v[56:59], v[48:51], v[64:79]
    v_mfma_f32_32x32x16_bf16 v[80:95], v[60:63], v[48:51], v[80:95]
    v_mfma_f32_32x32x16_bf16 v[96:111], v[56:59], v[52:55], v[96:111]
    v_mfma_f32_32x32x16_bf16 v[112:127], v[60:63], v[52:55], v[112:127]
    s_waitcnt lgkmcnt(0)
    s_waitcnt vmcnt(0)
    v_mfma_f32_32x32x16_bf16 v[64:79], v[136:139], v[128:131], v[64:79]
    ds_write_b128 v10, v[16:19] offset:0
    ds_write_b128 v10, v[20:23] offset:4608
    v_mfma_f32_32x32x16_bf16 v[80:95], v[140:143], v[128:131], v[80:95]
    ds_write_b128 v10, v[24:27] offset:9216
    ds_write_b128 v10, v[28:31] offset:13824
    v_mfma_f32_32x32x16_bf16 v[96:111], v[136:139], v[132:135], v[96:111]
    ds_write_b128 v10, v[32:35] offset:18432
    ds_write_b128 v10, v[36:39] offset:23040
    v_mfma_f32_32x32x16_bf16 v[112:127], v[140:143], v[132:135], v[112:127]
    ds_write_b128 v10, v[40:43] offset:27648
    ds_write_b128 v10, v[44:47] offset:32256
    s_waitcnt lgkmcnt(0)
    s_barrier
    s_add_u32 s16, s16, 128
    s_add_u32 s17, s17, 128
    s_add_u32 s25, s16, 110592
    s_add_u32 s28, s17, 110592
    s_add_u32 s26, s16, 221184
    s_add_u32 s29, s17, 221184
    s_add_u32 s27, s16, 331776
    s_add_u32 s30, s17, 331776
    buffer_load_dwordx4 v[16:19], v1, s[8:11], s16 offen offset:0
    buffer_load_dwordx4 v[20:23], v1, s[8:11], s25 offen
    buffer_load_dwordx4 v[24:27], v1, s[8:11], s26 offen
    buffer_load_dwordx4 v[28:31], v1, s[8:11], s27 offen
    buffer_load_dwordx4 v[32:35], v1, s[12:15], s17 offen
    buffer_load_dwordx4 v[36:39], v1, s[12:15], s28 offen
    buffer_load_dwordx4 v[40:43], v1, s[12:15], s29 offen
    buffer_load_dwordx4 v[44:47], v1, s[12:15], s30 offen
    ds_read_b128 v[48:51], v11 offset:0
    ds_read_b128 v[52:55], v11 offset:4608
    ds_read_b128 v[56:59], v12 offset:0
    ds_read_b128 v[60:63], v12 offset:9216
    ds_read_b128 v[128:131], v11 offset:32
    ds_read_b128 v[132:135], v11 offset:4640
    ds_read_b128 v[136:139], v12 offset:32
    ds_read_b128 v[140:143], v12 offset:9248
    s_waitcnt lgkmcnt(4)
    v_mfma_f32_32x32x16_bf16 v[64:79], v[56:59], v[48:51], v[64:79]
    v_mfma_f32_32x32x16_bf16 v[80:95], v[60:63], v[48:51], v[80:95]
    v_mfma_f32_32x32x16_bf16 v[96:111], v[56:59], v[52:55], v[96:111]
    v_mfma_f32_32x32x16_bf16 v[112:127], v[60:63], v[52:55], v[112:127]
    ds_read_b128 v[48:51], v11 offset:64
    ds_read_b128 v[52:55], v11 offset:4672
    ds_read_b128 v[56:59], v12 offset:64
    ds_read_b128 v[60:63], v12 offset:9280
    s_waitcnt lgkmcnt(4)
    v_mfma_f32_32x32x16_bf16 v[64:79], v[136:139], v[128:131], v[64:79]
    v_mfma_f32_32x32x16_bf16 v[80:95], v[140:143], v[128:131], v[80:95]
    v_mfma_f32_32x32x16_bf16 v[96:111], v[136:139], v[132:135], v[96:111]
    v_mfma_f32_32x32x16_bf16 v[112:127], v[140:143], v[132:135], v[112:127]
    ds_read_b128 v[128:131], v11 offset:96
    ds_read_b128 v[132:135], v11 offset:4704
    ds_read_b128 v[136:139], v12 offset:96
    ds_read_b128 v[140:143], v12 offset:9312
    s_waitcnt lgkmcnt(4)
    v_mfma_f32_32x32x16_bf16 v[64:79], v[56:59], v[48:51], v[64:79]
    v_mfma_f32_32x32x16_bf16 v[80:95], v[60:63], v[48:51], v[80:95]
    v_mfma_f32_32x32x16_bf16 v[96:111], v[56:59], v[52:55], v[96:111]
    v_mfma_f32_32x32x16_bf16 v[112:127], v[60:63], v[52:55], v[112:127]
    s_waitcnt lgkmcnt(0)
    s_waitcnt vmcnt(0)
    v_mfma_f32_32x32x16_bf16 v[64:79], v[136:139], v[128:131], v[64:79]
    ds_write_b128 v2, v[16:19] offset:0
    ds_write_b128 v2, v[20:23] offset:4608
    v_mfma_f32_32x32x16_bf16 v[80:95], v[140:143], v[128:131], v[80:95]
    ds_write_b128 v2, v[24:27] offset:9216
    ds_write_b128 v2, v[28:31] offset:13824
    v_mfma_f32_32x32x16_bf16 v[96:111], v[136:139], v[132:135], v[96:111]
    ds_write_b128 v2, v[32:35] offset:18432
    ds_write_b128 v2, v[36:39] offset:23040
    v_mfma_f32_32x32x16_bf16 v[112:127], v[140:143], v[132:135], v[112:127]
    ds_write_b128 v2, v[40:43] offset:27648
    ds_write_b128 v2, v[44:47] offset:32256
    s_waitcnt lgkmcnt(0)
    s_barrier
    s_add_u32 s16, s16, 128
    s_add_u32 s17, s17, 128
    s_add_u32 s25, s16, 110592
    s_add_u32 s28, s17, 110592
    s_add_u32 s26, s16, 221184
    s_add_u32 s29, s17, 221184
    s_add_u32 s27, s16, 331776
    s_add_u32 s30, s17, 331776
    buffer_load_dwordx4 v[16:19], v1, s[8:11], s16 offen offset:0
    buffer_load_dwordx4 v[20:23], v1, s[8:11], s25 offen
    buffer_load_dwordx4 v[24:27], v1, s[8:11], s26 offen
    buffer_load_dwordx4 v[28:31], v1, s[8:11], s27 offen
    buffer_load_dwordx4 v[32:35], v1, s[12:15], s17 offen
    buffer_load_dwordx4 v[36:39], v1, s[12:15], s28 offen
    buffer_load_dwordx4 v[40:43], v1, s[12:15], s29 offen
    buffer_load_dwordx4 v[44:47], v1, s[12:15], s30 offen
    ds_read_b128 v[48:51], v3 offset:0
    ds_read_b128 v[52:55], v3 offset:4608
    ds_read_b128 v[56:59], v4 offset:0
    ds_read_b128 v[60:63], v4 offset:9216
    ds_read_b128 v[128:131], v3 offset:32
    ds_read_b128 v[132:135], v3 offset:4640
    ds_read_b128 v[136:139], v4 offset:32
    ds_read_b128 v[140:143], v4 offset:9248
    s_waitcnt lgkmcnt(4)
    v_mfma_f32_32x32x16_bf16 v[64:79], v[56:59], v[48:51], v[64:79]
    v_mfma_f32_32x32x16_bf16 v[80:95], v[60:63], v[48:51], v[80:95]
    v_mfma_f32_32x32x16_bf16 v[96:111], v[56:59], v[52:55], v[96:111]
    v_mfma_f32_32x32x16_bf16 v[112:127], v[60:63], v[52:55], v[112:127]
    ds_read_b128 v[48:51], v3 offset:64
    ds_read_b128 v[52:55], v3 offset:4672
    ds_read_b128 v[56:59], v4 offset:64
    ds_read_b128 v[60:63], v4 offset:9280
    s_waitcnt lgkmcnt(4)
    v_mfma_f32_32x32x16_bf16 v[64:79], v[136:139], v[128:131], v[64:79]
    v_mfma_f32_32x32x16_bf16 v[80:95], v[140:143], v[128:131], v[80:95]
    v_mfma_f32_32x32x16_bf16 v[96:111], v[136:139], v[132:135], v[96:111]
    v_mfma_f32_32x32x16_bf16 v[112:127], v[140:143], v[132:135], v[112:127]
    ds_read_b128 v[128:131], v3 offset:96
    ds_read_b128 v[132:135], v3 offset:4704
    ds_read_b128 v[136:139], v4 offset:96
    ds_read_b128 v[140:143], v4 offset:9312
    s_waitcnt lgkmcnt(4)
    v_mfma_f32_32x32x16_bf16 v[64:79], v[56:59], v[48:51], v[64:79]
    v_mfma_f32_32x32x16_bf16 v[80:95], v[60:63], v[48:51], v[80:95]
    v_mfma_f32_32x32x16_bf16 v[96:111], v[56:59], v[52:55], v[96:111]
    v_mfma_f32_32x32x16_bf16 v[112:127], v[60:63], v[52:55], v[112:127]
    s_waitcnt lgkmcnt(0)
    s_waitcnt vmcnt(0)
    v_mfma_f32_32x32x16_bf16 v[64:79], v[136:139], v[128:131], v[64:79]
    ds_write_b128 v10, v[16:19] offset:0
    ds_write_b128 v10, v[20:23] offset:4608
    v_mfma_f32_32x32x16_bf16 v[80:95], v[140:143], v[128:131], v[80:95]
    ds_write_b128 v10, v[24:27] offset:9216
    ds_write_b128 v10, v[28:31] offset:13824
    v_mfma_f32_32x32x16_bf16 v[96:111], v[136:139], v[132:135], v[96:111]
    ds_write_b128 v10, v[32:35] offset:18432
    ds_write_b128 v10, v[36:39] offset:23040
    v_mfma_f32_32x32x16_bf16 v[112:127], v[140:143], v[132:135], v[112:127]
    ds_write_b128 v10, v[40:43] offset:27648
    ds_write_b128 v10, v[44:47] offset:32256
    s_waitcnt lgkmcnt(0)
    s_barrier
    s_add_u32 s16, s16, 128
    s_add_u32 s17, s17, 128
    s_add_u32 s25, s16, 110592
    s_add_u32 s28, s17, 110592
    s_add_u32 s26, s16, 221184
    s_add_u32 s29, s17, 221184
    s_add_u32 s27, s16, 331776
    s_add_u32 s30, s17, 331776
    buffer_load_dwordx4 v[16:19], v1, s[8:11], s16 offen offset:0
    buffer_load_dwordx4 v[20:23], v1, s[8:11], s25 offen
    buffer_load_dwordx4 v[24:27], v1, s[8:11], s26 offen
    buffer_load_dwordx4 v[28:31], v1, s[8:11], s27 offen
    buffer_load_dwordx4 v[32:35], v1, s[12:15], s17 offen
    buffer_load_dwordx4 v[36:39], v1, s[12:15], s28 offen
    buffer_load_dwordx4 v[40:43], v1, s[12:15], s29 offen
    buffer_load_dwordx4 v[44:47], v1, s[12:15], s30 offen
    ds_read_b128 v[48:51], v11 offset:0
    ds_read_b128 v[52:55], v11 offset:4608
    ds_read_b128 v[56:59], v12 offset:0
    ds_read_b128 v[60:63], v12 offset:9216
    ds_read_b128 v[128:131], v11 offset:32
    ds_read_b128 v[132:135], v11 offset:4640
    ds_read_b128 v[136:139], v12 offset:32
    ds_read_b128 v[140:143], v12 offset:9248
    s_waitcnt lgkmcnt(4)
    v_mfma_f32_32x32x16_bf16 v[64:79], v[56:59], v[48:51], v[64:79]
    v_mfma_f32_32x32x16_bf16 v[80:95], v[60:63], v[48:51], v[80:95]
    v_mfma_f32_32x32x16_bf16 v[96:111], v[56:59], v[52:55], v[96:111]
    v_mfma_f32_32x32x16_bf16 v[112:127], v[60:63], v[52:55], v[112:127]
    ds_read_b128 v[48:51], v11 offset:64
    ds_read_b128 v[52:55], v11 offset:4672
    ds_read_b128 v[56:59], v12 offset:64
    ds_read_b128 v[60:63], v12 offset:9280
    s_waitcnt lgkmcnt(4)
    v_mfma_f32_32x32x16_bf16 v[64:79], v[136:139], v[128:131], v[64:79]
    v_mfma_f32_32x32x16_bf16 v[80:95], v[140:143], v[128:131], v[80:95]
    v_mfma_f32_32x32x16_bf16 v[96:111], v[136:139], v[132:135], v[96:111]
    v_mfma_f32_32x32x16_bf16 v[112:127], v[140:143], v[132:135], v[112:127]
    ds_read_b128 v[128:131], v11 offset:96
    ds_read_b128 v[132:135], v11 offset:4704
    ds_read_b128 v[136:139], v12 offset:96
    ds_read_b128 v[140:143], v12 offset:9312
    s_waitcnt lgkmcnt(4)
    v_mfma_f32_32x32x16_bf16 v[64:79], v[56:59], v[48:51], v[64:79]
    v_mfma_f32_32x32x16_bf16 v[80:95], v[60:63], v[48:51], v[80:95]
    v_mfma_f32_32x32x16_bf16 v[96:111], v[56:59], v[52:55], v[96:111]
    v_mfma_f32_32x32x16_bf16 v[112:127], v[60:63], v[52:55], v[112:127]
    s_waitcnt lgkmcnt(0)
    s_waitcnt vmcnt(0)
    v_mfma_f32_32x32x16_bf16 v[64:79], v[136:139], v[128:131], v[64:79]
    ds_write_b128 v2, v[16:19] offset:0
    ds_write_b128 v2, v[20:23] offset:4608
    v_mfma_f32_32x32x16_bf16 v[80:95], v[140:143], v[128:131], v[80:95]
    ds_write_b128 v2, v[24:27] offset:9216
    ds_write_b128 v2, v[28:31] offset:13824
    v_mfma_f32_32x32x16_bf16 v[96:111], v[136:139], v[132:135], v[96:111]
    ds_write_b128 v2, v[32:35] offset:18432
    ds_write_b128 v2, v[36:39] offset:23040
    v_mfma_f32_32x32x16_bf16 v[112:127], v[140:143], v[132:135], v[112:127]
    ds_write_b128 v2, v[40:43] offset:27648
    ds_write_b128 v2, v[44:47] offset:32256
    s_waitcnt lgkmcnt(0)
    s_barrier
    s_add_u32 s16, s16, 128
    s_add_u32 s17, s17, 128
    s_add_u32 s25, s16, 110592
    s_add_u32 s28, s17, 110592
    s_add_u32 s26, s16, 221184
    s_add_u32 s29, s17, 221184
    s_add_u32 s27, s16, 331776
    s_add_u32 s30, s17, 331776
    buffer_load_dwordx4 v[16:19], v1, s[8:11], s16 offen offset:0
    buffer_load_dwordx4 v[20:23], v1, s[8:11], s25 offen
    buffer_load_dwordx4 v[24:27], v1, s[8:11], s26 offen
    buffer_load_dwordx4 v[28:31], v1, s[8:11], s27 offen
    buffer_load_dwordx4 v[32:35], v1, s[12:15], s17 offen
    buffer_load_dwordx4 v[36:39], v1, s[12:15], s28 offen
    buffer_load_dwordx4 v[40:43], v1, s[12:15], s29 offen
    buffer_load_dwordx4 v[44:47], v1, s[12:15], s30 offen
    ds_read_b128 v[48:51], v3 offset:0
    ds_read_b128 v[52:55], v3 offset:4608
    ds_read_b128 v[56:59], v4 offset:0
    ds_read_b128 v[60:63], v4 offset:9216
    ds_read_b128 v[128:131], v3 offset:32
    ds_read_b128 v[132:135], v3 offset:4640
    ds_read_b128 v[136:139], v4 offset:32
    ds_read_b128 v[140:143], v4 offset:9248
    s_waitcnt lgkmcnt(4)
    v_mfma_f32_32x32x16_bf16 v[64:79], v[56:59], v[48:51], v[64:79]
    v_mfma_f32_32x32x16_bf16 v[80:95], v[60:63], v[48:51], v[80:95]
    v_mfma_f32_32x32x16_bf16 v[96:111], v[56:59], v[52:55], v[96:111]
    v_mfma_f32_32x32x16_bf16 v[112:127], v[60:63], v[52:55], v[112:127]
    ds_read_b128 v[48:51], v3 offset:64
    ds_read_b128 v[52:55], v3 offset:4672
    ds_read_b128 v[56:59], v4 offset:64
    ds_read_b128 v[60:63], v4 offset:9280
    s_waitcnt lgkmcnt(4)
    v_mfma_f32_32x32x16_bf16 v[64:79], v[136:139], v[128:131], v[64:79]
    v_mfma_f32_32x32x16_bf16 v[80:95], v[140:143], v[128:131], v[80:95]
    v_mfma_f32_32x32x16_bf16 v[96:111], v[136:139], v[132:135], v[96:111]
    v_mfma_f32_32x32x16_bf16 v[112:127], v[140:143], v[132:135], v[112:127]
    ds_read_b128 v[128:131], v3 offset:96
    ds_read_b128 v[132:135], v3 offset:4704
    ds_read_b128 v[136:139], v4 offset:96
    ds_read_b128 v[140:143], v4 offset:9312
    s_waitcnt lgkmcnt(4)
    v_mfma_f32_32x32x16_bf16 v[64:79], v[56:59], v[48:51], v[64:79]
    v_mfma_f32_32x32x16_bf16 v[80:95], v[60:63], v[48:51], v[80:95]
    v_mfma_f32_32x32x16_bf16 v[96:111], v[56:59], v[52:55], v[96:111]
    v_mfma_f32_32x32x16_bf16 v[112:127], v[60:63], v[52:55], v[112:127]
    s_waitcnt lgkmcnt(0)
    s_waitcnt vmcnt(0)
    v_mfma_f32_32x32x16_bf16 v[64:79], v[136:139], v[128:131], v[64:79]
    ds_write_b128 v10, v[16:19] offset:0
    ds_write_b128 v10, v[20:23] offset:4608
    v_mfma_f32_32x32x16_bf16 v[80:95], v[140:143], v[128:131], v[80:95]
    ds_write_b128 v10, v[24:27] offset:9216
    ds_write_b128 v10, v[28:31] offset:13824
    v_mfma_f32_32x32x16_bf16 v[96:111], v[136:139], v[132:135], v[96:111]
    ds_write_b128 v10, v[32:35] offset:18432
    ds_write_b128 v10, v[36:39] offset:23040
    v_mfma_f32_32x32x16_bf16 v[112:127], v[140:143], v[132:135], v[112:127]
    ds_write_b128 v10, v[40:43] offset:27648
    ds_write_b128 v10, v[44:47] offset:32256
    s_waitcnt lgkmcnt(0)
    s_barrier
    s_add_u32 s16, s16, 128
    s_add_u32 s17, s17, 128
    s_add_u32 s25, s16, 110592
    s_add_u32 s28, s17, 110592
    s_add_u32 s26, s16, 221184
    s_add_u32 s29, s17, 221184
    s_add_u32 s27, s16, 331776
    s_add_u32 s30, s17, 331776
    buffer_load_dwordx4 v[16:19], v1, s[8:11], s16 offen offset:0
    buffer_load_dwordx4 v[20:23], v1, s[8:11], s25 offen
    buffer_load_dwordx4 v[24:27], v1, s[8:11], s26 offen
    buffer_load_dwordx4 v[28:31], v1, s[8:11], s27 offen
    buffer_load_dwordx4 v[32:35], v1, s[12:15], s17 offen
    buffer_load_dwordx4 v[36:39], v1, s[12:15], s28 offen
    buffer_load_dwordx4 v[40:43], v1, s[12:15], s29 offen
    buffer_load_dwordx4 v[44:47], v1, s[12:15], s30 offen
    ds_read_b128 v[48:51], v11 offset:0
    ds_read_b128 v[52:55], v11 offset:4608
    ds_read_b128 v[56:59], v12 offset:0
    ds_read_b128 v[60:63], v12 offset:9216
    ds_read_b128 v[128:131], v11 offset:32
    ds_read_b128 v[132:135], v11 offset:4640
    ds_read_b128 v[136:139], v12 offset:32
    ds_read_b128 v[140:143], v12 offset:9248
    s_waitcnt lgkmcnt(4)
    v_mfma_f32_32x32x16_bf16 v[64:79], v[56:59], v[48:51], v[64:79]
    v_mfma_f32_32x32x16_bf16 v[80:95], v[60:63], v[48:51], v[80:95]
    v_mfma_f32_32x32x16_bf16 v[96:111], v[56:59], v[52:55], v[96:111]
    v_mfma_f32_32x32x16_bf16 v[112:127], v[60:63], v[52:55], v[112:127]
    ds_read_b128 v[48:51], v11 offset:64
    ds_read_b128 v[52:55], v11 offset:4672
    ds_read_b128 v[56:59], v12 offset:64
    ds_read_b128 v[60:63], v12 offset:9280
    s_waitcnt lgkmcnt(4)
    v_mfma_f32_32x32x16_bf16 v[64:79], v[136:139], v[128:131], v[64:79]
    v_mfma_f32_32x32x16_bf16 v[80:95], v[140:143], v[128:131], v[80:95]
    v_mfma_f32_32x32x16_bf16 v[96:111], v[136:139], v[132:135], v[96:111]
    v_mfma_f32_32x32x16_bf16 v[112:127], v[140:143], v[132:135], v[112:127]
    ds_read_b128 v[128:131], v11 offset:96
    ds_read_b128 v[132:135], v11 offset:4704
    ds_read_b128 v[136:139], v12 offset:96
    ds_read_b128 v[140:143], v12 offset:9312
    s_waitcnt lgkmcnt(4)
    v_mfma_f32_32x32x16_bf16 v[64:79], v[56:59], v[48:51], v[64:79]
    v_mfma_f32_32x32x16_bf16 v[80:95], v[60:63], v[48:51], v[80:95]
    v_mfma_f32_32x32x16_bf16 v[96:111], v[56:59], v[52:55], v[96:111]
    v_mfma_f32_32x32x16_bf16 v[112:127], v[60:63], v[52:55], v[112:127]
    s_waitcnt lgkmcnt(0)
    s_waitcnt vmcnt(0)
    v_mfma_f32_32x32x16_bf16 v[64:79], v[136:139], v[128:131], v[64:79]
    ds_write_b128 v2, v[16:19] offset:0
    ds_write_b128 v2, v[20:23] offset:4608
    v_mfma_f32_32x32x16_bf16 v[80:95], v[140:143], v[128:131], v[80:95]
    ds_write_b128 v2, v[24:27] offset:9216
    ds_write_b128 v2, v[28:31] offset:13824
    v_mfma_f32_32x32x16_bf16 v[96:111], v[136:139], v[132:135], v[96:111]
    ds_write_b128 v2, v[32:35] offset:18432
    ds_write_b128 v2, v[36:39] offset:23040
    v_mfma_f32_32x32x16_bf16 v[112:127], v[140:143], v[132:135], v[112:127]
    ds_write_b128 v2, v[40:43] offset:27648
    ds_write_b128 v2, v[44:47] offset:32256
    s_waitcnt lgkmcnt(0)
    s_barrier
    s_add_u32 s16, s16, 128
    s_add_u32 s17, s17, 128
    s_add_u32 s25, s16, 110592
    s_add_u32 s28, s17, 110592
    s_add_u32 s26, s16, 221184
    s_add_u32 s29, s17, 221184
    s_add_u32 s27, s16, 331776
    s_add_u32 s30, s17, 331776
    buffer_load_dwordx4 v[16:19], v1, s[8:11], s16 offen offset:0
    buffer_load_dwordx4 v[20:23], v1, s[8:11], s25 offen
    buffer_load_dwordx4 v[24:27], v1, s[8:11], s26 offen
    buffer_load_dwordx4 v[28:31], v1, s[8:11], s27 offen
    buffer_load_dwordx4 v[32:35], v1, s[12:15], s17 offen
    buffer_load_dwordx4 v[36:39], v1, s[12:15], s28 offen
    buffer_load_dwordx4 v[40:43], v1, s[12:15], s29 offen
    buffer_load_dwordx4 v[44:47], v1, s[12:15], s30 offen
    ds_read_b128 v[48:51], v3 offset:0
    ds_read_b128 v[52:55], v3 offset:4608
    ds_read_b128 v[56:59], v4 offset:0
    ds_read_b128 v[60:63], v4 offset:9216
    ds_read_b128 v[128:131], v3 offset:32
    ds_read_b128 v[132:135], v3 offset:4640
    ds_read_b128 v[136:139], v4 offset:32
    ds_read_b128 v[140:143], v4 offset:9248
    s_waitcnt lgkmcnt(4)
    v_mfma_f32_32x32x16_bf16 v[64:79], v[56:59], v[48:51], v[64:79]
    v_mfma_f32_32x32x16_bf16 v[80:95], v[60:63], v[48:51], v[80:95]
    v_mfma_f32_32x32x16_bf16 v[96:111], v[56:59], v[52:55], v[96:111]
    v_mfma_f32_32x32x16_bf16 v[112:127], v[60:63], v[52:55], v[112:127]
    ds_read_b128 v[48:51], v3 offset:64
    ds_read_b128 v[52:55], v3 offset:4672
    ds_read_b128 v[56:59], v4 offset:64
    ds_read_b128 v[60:63], v4 offset:9280
    s_waitcnt lgkmcnt(4)
    v_mfma_f32_32x32x16_bf16 v[64:79], v[136:139], v[128:131], v[64:79]
    v_mfma_f32_32x32x16_bf16 v[80:95], v[140:143], v[128:131], v[80:95]
    v_mfma_f32_32x32x16_bf16 v[96:111], v[136:139], v[132:135], v[96:111]
    v_mfma_f32_32x32x16_bf16 v[112:127], v[140:143], v[132:135], v[112:127]
    ds_read_b128 v[128:131], v3 offset:96
    ds_read_b128 v[132:135], v3 offset:4704
    ds_read_b128 v[136:139], v4 offset:96
    ds_read_b128 v[140:143], v4 offset:9312
    s_waitcnt lgkmcnt(4)
    v_mfma_f32_32x32x16_bf16 v[64:79], v[56:59], v[48:51], v[64:79]
    v_mfma_f32_32x32x16_bf16 v[80:95], v[60:63], v[48:51], v[80:95]
    v_mfma_f32_32x32x16_bf16 v[96:111], v[56:59], v[52:55], v[96:111]
    v_mfma_f32_32x32x16_bf16 v[112:127], v[60:63], v[52:55], v[112:127]
    s_waitcnt lgkmcnt(0)
    s_waitcnt vmcnt(0)
    v_mfma_f32_32x32x16_bf16 v[64:79], v[136:139], v[128:131], v[64:79]
    ds_write_b128 v10, v[16:19] offset:0
    ds_write_b128 v10, v[20:23] offset:4608
    v_mfma_f32_32x32x16_bf16 v[80:95], v[140:143], v[128:131], v[80:95]
    ds_write_b128 v10, v[24:27] offset:9216
    ds_write_b128 v10, v[28:31] offset:13824
    v_mfma_f32_32x32x16_bf16 v[96:111], v[136:139], v[132:135], v[96:111]
    ds_write_b128 v10, v[32:35] offset:18432
    ds_write_b128 v10, v[36:39] offset:23040
    v_mfma_f32_32x32x16_bf16 v[112:127], v[140:143], v[132:135], v[112:127]
    ds_write_b128 v10, v[40:43] offset:27648
    ds_write_b128 v10, v[44:47] offset:32256
    s_waitcnt lgkmcnt(0)
    s_barrier
    s_add_u32 s16, s16, 128
    s_add_u32 s17, s17, 128
    s_add_u32 s25, s16, 110592
    s_add_u32 s28, s17, 110592
    s_add_u32 s26, s16, 221184
    s_add_u32 s29, s17, 221184
    s_add_u32 s27, s16, 331776
    s_add_u32 s30, s17, 331776
    buffer_load_dwordx4 v[16:19], v1, s[8:11], s16 offen offset:0
    buffer_load_dwordx4 v[20:23], v1, s[8:11], s25 offen
    buffer_load_dwordx4 v[24:27], v1, s[8:11], s26 offen
    buffer_load_dwordx4 v[28:31], v1, s[8:11], s27 offen
    buffer_load_dwordx4 v[32:35], v1, s[12:15], s17 offen
    buffer_load_dwordx4 v[36:39], v1, s[12:15], s28 offen
    buffer_load_dwordx4 v[40:43], v1, s[12:15], s29 offen
    buffer_load_dwordx4 v[44:47], v1, s[12:15], s30 offen
    ds_read_b128 v[48:51], v11 offset:0
    ds_read_b128 v[52:55], v11 offset:4608
    ds_read_b128 v[56:59], v12 offset:0
    ds_read_b128 v[60:63], v12 offset:9216
    ds_read_b128 v[128:131], v11 offset:32
    ds_read_b128 v[132:135], v11 offset:4640
    ds_read_b128 v[136:139], v12 offset:32
    ds_read_b128 v[140:143], v12 offset:9248
    s_waitcnt lgkmcnt(4)
    v_mfma_f32_32x32x16_bf16 v[64:79], v[56:59], v[48:51], v[64:79]
    v_mfma_f32_32x32x16_bf16 v[80:95], v[60:63], v[48:51], v[80:95]
    v_mfma_f32_32x32x16_bf16 v[96:111], v[56:59], v[52:55], v[96:111]
    v_mfma_f32_32x32x16_bf16 v[112:127], v[60:63], v[52:55], v[112:127]
    ds_read_b128 v[48:51], v11 offset:64
    ds_read_b128 v[52:55], v11 offset:4672
    ds_read_b128 v[56:59], v12 offset:64
    ds_read_b128 v[60:63], v12 offset:9280
    s_waitcnt lgkmcnt(4)
    v_mfma_f32_32x32x16_bf16 v[64:79], v[136:139], v[128:131], v[64:79]
    v_mfma_f32_32x32x16_bf16 v[80:95], v[140:143], v[128:131], v[80:95]
    v_mfma_f32_32x32x16_bf16 v[96:111], v[136:139], v[132:135], v[96:111]
    v_mfma_f32_32x32x16_bf16 v[112:127], v[140:143], v[132:135], v[112:127]
    ds_read_b128 v[128:131], v11 offset:96
    ds_read_b128 v[132:135], v11 offset:4704
    ds_read_b128 v[136:139], v12 offset:96
    ds_read_b128 v[140:143], v12 offset:9312
    s_waitcnt lgkmcnt(4)
    v_mfma_f32_32x32x16_bf16 v[64:79], v[56:59], v[48:51], v[64:79]
    v_mfma_f32_32x32x16_bf16 v[80:95], v[60:63], v[48:51], v[80:95]
    v_mfma_f32_32x32x16_bf16 v[96:111], v[56:59], v[52:55], v[96:111]
    v_mfma_f32_32x32x16_bf16 v[112:127], v[60:63], v[52:55], v[112:127]
    s_waitcnt lgkmcnt(0)
    s_waitcnt vmcnt(0)
    v_mfma_f32_32x32x16_bf16 v[64:79], v[136:139], v[128:131], v[64:79]
    ds_write_b128 v2, v[16:19] offset:0
    ds_write_b128 v2, v[20:23] offset:4608
    v_mfma_f32_32x32x16_bf16 v[80:95], v[140:143], v[128:131], v[80:95]
    ds_write_b128 v2, v[24:27] offset:9216
    ds_write_b128 v2, v[28:31] offset:13824
    v_mfma_f32_32x32x16_bf16 v[96:111], v[136:139], v[132:135], v[96:111]
    ds_write_b128 v2, v[32:35] offset:18432
    ds_write_b128 v2, v[36:39] offset:23040
    v_mfma_f32_32x32x16_bf16 v[112:127], v[140:143], v[132:135], v[112:127]
    ds_write_b128 v2, v[40:43] offset:27648
    ds_write_b128 v2, v[44:47] offset:32256
    s_waitcnt lgkmcnt(0)
    s_barrier
    ds_read_b128 v[48:51], v3 offset:0
    ds_read_b128 v[52:55], v3 offset:4608
    ds_read_b128 v[56:59], v4 offset:0
    ds_read_b128 v[60:63], v4 offset:9216
    ds_read_b128 v[128:131], v3 offset:32
    ds_read_b128 v[132:135], v3 offset:4640
    ds_read_b128 v[136:139], v4 offset:32
    ds_read_b128 v[140:143], v4 offset:9248
    s_waitcnt lgkmcnt(4)
    v_mfma_f32_32x32x16_bf16 v[64:79], v[56:59], v[48:51], v[64:79]
    v_mfma_f32_32x32x16_bf16 v[80:95], v[60:63], v[48:51], v[80:95]
    v_mfma_f32_32x32x16_bf16 v[96:111], v[56:59], v[52:55], v[96:111]
    v_mfma_f32_32x32x16_bf16 v[112:127], v[60:63], v[52:55], v[112:127]
    ds_read_b128 v[48:51], v3 offset:64
    ds_read_b128 v[52:55], v3 offset:4672
    ds_read_b128 v[56:59], v4 offset:64
    ds_read_b128 v[60:63], v4 offset:9280
    s_waitcnt lgkmcnt(4)
    v_mfma_f32_32x32x16_bf16 v[64:79], v[136:139], v[128:131], v[64:79]
    v_mfma_f32_32x32x16_bf16 v[80:95], v[140:143], v[128:131], v[80:95]
    v_mfma_f32_32x32x16_bf16 v[96:111], v[136:139], v[132:135], v[96:111]
    v_mfma_f32_32x32x16_bf16 v[112:127], v[140:143], v[132:135], v[112:127]
    ds_read_b128 v[128:131], v3 offset:96
    ds_read_b128 v[132:135], v3 offset:4704
    ds_read_b128 v[136:139], v4 offset:96
    ds_read_b128 v[140:143], v4 offset:9312
    s_waitcnt lgkmcnt(4)
    v_mfma_f32_32x32x16_bf16 v[64:79], v[56:59], v[48:51], v[64:79]
    v_mfma_f32_32x32x16_bf16 v[80:95], v[60:63], v[48:51], v[80:95]
    v_mfma_f32_32x32x16_bf16 v[96:111], v[56:59], v[52:55], v[96:111]
    v_mfma_f32_32x32x16_bf16 v[112:127], v[60:63], v[52:55], v[112:127]
    s_waitcnt lgkmcnt(0)
    v_mfma_f32_32x32x16_bf16 v[64:79], v[136:139], v[128:131], v[64:79]
    v_mfma_f32_32x32x16_bf16 v[80:95], v[140:143], v[128:131], v[80:95]
    v_mfma_f32_32x32x16_bf16 v[96:111], v[136:139], v[132:135], v[96:111]
    v_mfma_f32_32x32x16_bf16 v[112:127], v[140:143], v[132:135], v[112:127]
    s_nop 7
    s_nop 7
    v_lshrrev_b32 v5, 6, v0
    v_and_b32 v6, 31, v0
    v_lshrrev_b32 v7, 5, v0
    v_and_b32 v7, 1, v7
    v_lshrrev_b32 v8, 1, v5
    v_and_b32 v9, 1, v5
    v_lshl_add_u32 v8, v8, 6, v6
    s_mul_i32 s3, s23, 5242880
    s_add_u32 s3, s3, 27262976
    s_add_u32 s8, s4, s3
    s_addc_u32 s9, s5, 0
    s_mov_b32 s10, 5242880
    s_mov_b32 s11, 0x00020000
    v_mul_u32_u24 v8, 2560, v8
    v_and_b32 v9, 1, v5
    v_lshlrev_b32 v9, 7, v9
    v_lshl_add_u32 v9, v7, 4, v9
    v_add_u32 v8, v8, v9
    s_mul_i32 s16, s20, 327680
    s_lshl_b32 s17, s21, 9
    s_add_u32 s16, s16, s17
    s_add_u32 s17, s16, 0
    buffer_store_dwordx4 v[64:67], v8, s[8:11], s17 offen
    s_add_u32 s17, s16, 32
    buffer_store_dwordx4 v[68:71], v8, s[8:11], s17 offen
    s_add_u32 s17, s16, 64
    buffer_store_dwordx4 v[72:75], v8, s[8:11], s17 offen
    s_add_u32 s17, s16, 96
    buffer_store_dwordx4 v[76:79], v8, s[8:11], s17 offen
    s_add_u32 s17, s16, 256
    buffer_store_dwordx4 v[80:83], v8, s[8:11], s17 offen
    s_add_u32 s17, s16, 288
    buffer_store_dwordx4 v[84:87], v8, s[8:11], s17 offen
    s_add_u32 s17, s16, 320
    buffer_store_dwordx4 v[88:91], v8, s[8:11], s17 offen
    s_add_u32 s17, s16, 352
    buffer_store_dwordx4 v[92:95], v8, s[8:11], s17 offen
    s_add_u32 s17, s16, 81920
    buffer_store_dwordx4 v[96:99], v8, s[8:11], s17 offen
    s_add_u32 s17, s16, 81952
    buffer_store_dwordx4 v[100:103], v8, s[8:11], s17 offen
    s_add_u32 s17, s16, 81984
    buffer_store_dwordx4 v[104:107], v8, s[8:11], s17 offen
    s_add_u32 s17, s16, 82016
    buffer_store_dwordx4 v[108:111], v8, s[8:11], s17 offen
    s_add_u32 s17, s16, 82176
    buffer_store_dwordx4 v[112:115], v8, s[8:11], s17 offen
    s_add_u32 s17, s16, 82208
    buffer_store_dwordx4 v[116:119], v8, s[8:11], s17 offen
    s_add_u32 s17, s16, 82240
    buffer_store_dwordx4 v[120:123], v8, s[8:11], s17 offen
    s_add_u32 s17, s16, 82272
    buffer_store_dwordx4 v[124:127], v8, s[8:11], s17 offen
.Lg2b_kernel_end:
    s_endpgm
.globl finb_kernel
.p2align 8
.type finb_kernel,@function
finb_kernel:
    s_cmp_ge_u32 s2, 1280
    s_cbranch_scc1 .Lfinb_kernel_end
    s_load_dwordx2 s[4:5], s[0:1], 72
    s_load_dwordx2 s[6:7], s[0:1], 56
    s_waitcnt lgkmcnt(0)
    s_mov_b32 s3, 27262976
    s_add_u32 s8, s4, s3
    s_addc_u32 s9, s5, 0
    s_mov_b32 s10, 15728640
    s_mov_b32 s11, 0x00020000
    s_mov_b32 s3, 12582912
    s_add_u32 s12, s4, s3
    s_addc_u32 s13, s5, 0
    s_mov_b32 s14, 2621440
    s_mov_b32 s15, 0x00020000
    s_mov_b32 s16, s6
    s_mov_b32 s17, s7
    s_mov_b32 s18, 2621440
    s_mov_b32 s19, 0x00020000
    s_lshl_b32 s3, s2, 8
    v_add_u32 v1, s3, v0
    v_lshlrev_b32 v2, 4, v1
    v_lshlrev_b32 v3, 3, v1
    s_mov_b32 s20, 5242880
    s_mov_b32 s21, 10485760
    buffer_load_dwordx4 v[4:7], v2, s[8:11], 0 offen
    buffer_load_dwordx4 v[8:11], v2, s[8:11], s20 offen
    buffer_load_dwordx4 v[12:15], v2, s[8:11], s21 offen
    buffer_load_dwordx2 v[16:17], v3, s[12:15], 0 offen
    s_waitcnt vmcnt(0)
    v_add_f32 v4, v4, v8
    v_add_f32 v4, v4, v12
    v_cvt_pk_bf16_f32 v4, v4, v4
    v_lshlrev_b32 v4, 16, v4
    v_add_f32 v5, v5, v9
    v_add_f32 v5, v5, v13
    v_cvt_pk_bf16_f32 v5, v5, v5
    v_lshlrev_b32 v5, 16, v5
    v_add_f32 v6, v6, v10
    v_add_f32 v6, v6, v14
    v_cvt_pk_bf16_f32 v6, v6, v6
    v_lshlrev_b32 v6, 16, v6
    v_add_f32 v7, v7, v11
    v_add_f32 v7, v7, v15
    v_cvt_pk_bf16_f32 v7, v7, v7
    v_lshlrev_b32 v7, 16, v7
    v_lshlrev_b32 v8, 16, v16
    v_and_b32 v9, 0xffff0000, v16
    v_lshlrev_b32 v10, 16, v17
    v_and_b32 v11, 0xffff0000, v17
    v_add_f32 v4, v4, v8
    v_add_f32 v5, v5, v9
    v_add_f32 v6, v6, v10
    v_add_f32 v7, v7, v11
    v_cvt_pk_bf16_f32 v12, v4, v5
    v_cvt_pk_bf16_f32 v13, v6, v7
    buffer_store_dwordx2 v[12:13], v3, s[16:19], 0 offen
.Lfinb_kernel_end:
    s_endpgm
.section .rodata,"a"
.p2align 6
.amdhsa_kernel k1a_kernel
  .amdhsa_next_free_vgpr 112
  .amdhsa_next_free_sgpr 60
  .amdhsa_accum_offset 112
  .amdhsa_group_segment_fixed_size 0
  .amdhsa_kernarg_size 80
  .amdhsa_user_sgpr_count 2
  .amdhsa_user_sgpr_kernarg_segment_ptr 1
  .amdhsa_system_sgpr_workgroup_id_x 1
.end_amdhsa_kernel
.p2align 6
.amdhsa_kernel wp_kernel
  .amdhsa_next_free_vgpr 16
  .amdhsa_next_free_sgpr 32
  .amdhsa_accum_offset 16
  .amdhsa_group_segment_fixed_size 0
  .amdhsa_kernarg_size 80
  .amdhsa_user_sgpr_count 2
  .amdhsa_user_sgpr_kernarg_segment_ptr 1
  .amdhsa_system_sgpr_workgroup_id_x 1
.end_amdhsa_kernel
.p2align 6
.amdhsa_kernel k2a_kernel
  .amdhsa_next_free_vgpr 106
  .amdhsa_next_free_sgpr 24
  .amdhsa_accum_offset 108
  .amdhsa_group_segment_fixed_size 0
  .amdhsa_kernarg_size 80
  .amdhsa_user_sgpr_count 2
  .amdhsa_user_sgpr_kernarg_segment_ptr 1
  .amdhsa_system_sgpr_workgroup_id_x 1
.end_amdhsa_kernel
.p2align 6
.amdhsa_kernel k3a_kernel
  .amdhsa_next_free_vgpr 112
  .amdhsa_next_free_sgpr 60
  .amdhsa_accum_offset 112
  .amdhsa_group_segment_fixed_size 0
  .amdhsa_kernarg_size 80
  .amdhsa_user_sgpr_count 2
  .amdhsa_user_sgpr_kernarg_segment_ptr 1
  .amdhsa_system_sgpr_workgroup_id_x 1
.end_amdhsa_kernel
.p2align 6
.amdhsa_kernel g1a_kernel
  .amdhsa_next_free_vgpr 144
  .amdhsa_next_free_sgpr 32
  .amdhsa_accum_offset 144
  .amdhsa_group_segment_fixed_size 0
  .amdhsa_kernarg_size 80
  .amdhsa_user_sgpr_count 2
  .amdhsa_user_sgpr_kernarg_segment_ptr 1
  .amdhsa_system_sgpr_workgroup_id_x 1
.end_amdhsa_kernel
.p2align 6
.amdhsa_kernel g2a_kernel
  .amdhsa_next_free_vgpr 144
  .amdhsa_next_free_sgpr 32
  .amdhsa_accum_offset 144
  .amdhsa_group_segment_fixed_size 0
  .amdhsa_kernarg_size 80
  .amdhsa_user_sgpr_count 2
  .amdhsa_user_sgpr_kernarg_segment_ptr 1
  .amdhsa_system_sgpr_workgroup_id_x 1
.end_amdhsa_kernel
.p2align 6
.amdhsa_kernel fina_kernel
  .amdhsa_next_free_vgpr 20
  .amdhsa_next_free_sgpr 24
  .amdhsa_accum_offset 20
  .amdhsa_group_segment_fixed_size 0
  .amdhsa_kernarg_size 80
  .amdhsa_user_sgpr_count 2
  .amdhsa_user_sgpr_kernarg_segment_ptr 1
  .amdhsa_system_sgpr_workgroup_id_x 1
.end_amdhsa_kernel
.p2align 6
.amdhsa_kernel k1b_kernel
  .amdhsa_next_free_vgpr 112
  .amdhsa_next_free_sgpr 60
  .amdhsa_accum_offset 112
  .amdhsa_group_segment_fixed_size 0
  .amdhsa_kernarg_size 80
  .amdhsa_user_sgpr_count 2
  .amdhsa_user_sgpr_kernarg_segment_ptr 1
  .amdhsa_system_sgpr_workgroup_id_x 1
.end_amdhsa_kernel
.p2align 6
.amdhsa_kernel k2b_kernel
  .amdhsa_next_free_vgpr 106
  .amdhsa_next_free_sgpr 24
  .amdhsa_accum_offset 108
  .amdhsa_group_segment_fixed_size 0
  .amdhsa_kernarg_size 80
  .amdhsa_user_sgpr_count 2
  .amdhsa_user_sgpr_kernarg_segment_ptr 1
  .amdhsa_system_sgpr_workgroup_id_x 1
.end_amdhsa_kernel
.p2align 6
.amdhsa_kernel k3b_kernel
  .amdhsa_next_free_vgpr 112
  .amdhsa_next_free_sgpr 60
  .amdhsa_accum_offset 112
  .amdhsa_group_segment_fixed_size 0
  .amdhsa_kernarg_size 80
  .amdhsa_user_sgpr_count 2
  .amdhsa_user_sgpr_kernarg_segment_ptr 1
  .amdhsa_system_sgpr_workgroup_id_x 1
.end_amdhsa_kernel
.p2align 6
.amdhsa_kernel g1b_kernel
  .amdhsa_next_free_vgpr 144
  .amdhsa_next_free_sgpr 32
  .amdhsa_accum_offset 144
  .amdhsa_group_segment_fixed_size 0
  .amdhsa_kernarg_size 80
  .amdhsa_user_sgpr_count 2
  .amdhsa_user_sgpr_kernarg_segment_ptr 1
  .amdhsa_system_sgpr_workgroup_id_x 1
.end_amdhsa_kernel
.p2align 6
.amdhsa_kernel g2b_kernel
  .amdhsa_next_free_vgpr 144
  .amdhsa_next_free_sgpr 32
  .amdhsa_accum_offset 144
  .amdhsa_group_segment_fixed_size 0
  .amdhsa_kernarg_size 80
  .amdhsa_user_sgpr_count 2
  .amdhsa_user_sgpr_kernarg_segment_ptr 1
  .amdhsa_system_sgpr_workgroup_id_x 1
.end_amdhsa_kernel
.p2align 6
.amdhsa_kernel finb_kernel
  .amdhsa_next_free_vgpr 20
  .amdhsa_next_free_sgpr 24
  .amdhsa_accum_offset 20
  .amdhsa_group_segment_fixed_size 0
  .amdhsa_kernarg_size 80
  .amdhsa_user_sgpr_count 2
  .amdhsa_user_sgpr_kernarg_segment_ptr 1
  .amdhsa_system_sgpr_workgroup_id_x 1
.end_amdhsa_kernel
```
